```python
import torch

def _softmax(x, axis=-1):
    return torch.softmax(x, dim=axis)
def _gelu(x):
    return torch.nn.functional.gelu(x, approximate="tanh")
def _silu(x):
    return torch.nn.functional.silu(x)
def _sigmoid(x):
    return torch.sigmoid(x)
def _layernorm(x, axis=-1, eps=1e-5):
    m = x.mean(dim=axis, keepdim=True)
    v = x.var(dim=axis, keepdim=True, unbiased=False)
    return (x - m) / torch.sqrt(v + eps)
def _scatter_add(tgt, idx, src, axis=0):
    return tgt.clone().index_add_(axis, idx, src)
def _segment_sum(src, seg, n):
    out = torch.zeros((n,) + src.shape[1:], dtype=src.dtype)
    return out.index_add_(0, seg, src)
def _pad(x, pw):
    flat = tuple(v for pair in reversed(pw) for v in pair)
    return torch.nn.functional.pad(x, flat)

kernel_name = 'gated_mix__sliding_local_dilated__glu_gated_glu__prompt'

def setup_inputs():

    _w = (lambda a: (lambda t: t.to(torch.bfloat16) if t.is_floating_point() else t)(torch.as_tensor(a)))
    def _A_setup():
        B, S, D = 1, 2048, 448
        return {
            "x": _w((lambda *s: torch.randn(*s, dtype=torch.bfloat16) * 0.05)(B, S, D)),
            "wqkv": _w((lambda *s: torch.randn(*s, dtype=torch.bfloat16) * 0.8)(D, 3 * D)),
            "wo": _w((lambda *s: torch.randn(*s, dtype=torch.bfloat16) * 0.05)(D, D)),
        }
    _A_in = _A_setup()

    def _B_setup():
        B, S, D, F = 1, 2048, 448, 1792
        return {
            "x": _w((lambda *s: torch.randn(*s, dtype=torch.bfloat16) * 0.05)(B, S, D)),
            "w_gate": _w((lambda *s: torch.randn(*s, dtype=torch.bfloat16) * 1.6)(D, F)),
            "w_up": _w((lambda *s: torch.randn(*s, dtype=torch.bfloat16) * 0.1)(D, F)),
            "w_down": _w((lambda *s: torch.randn(*s, dtype=torch.bfloat16) * 0.1)(F, D)),
        }
    _B_in = _B_setup()

    return {
        "A_x": _A_in["x"],
        "A_wqkv": _A_in["wqkv"],
        "A_wo": _A_in["wo"],
        "B_x": _B_in["x"],
        "B_w_gate": _B_in["w_gate"],
        "B_w_up": _B_in["w_up"],
        "B_w_down": _B_in["w_down"],
        "gate_w": _w((lambda *s: torch.randn(*s, dtype=torch.bfloat16) * 0.05)(448) * 16.0),
    }

def reference(A_x, A_wqkv, A_wo, B_x, B_w_gate, B_w_up, B_w_down, gate_w):
    def _A_ref(x, wqkv, wo):
        B, S, D = x.shape
        H = 16; Dh = D // H
        W, dil = 8, 2
        qkv = (lambda x, *d: x.permute(*d))((x @ wqkv).reshape(B, S, 3, H, Dh), 2, 0, 3, 1, 4)
        q, k, v = qkv[0], qkv[1], qkv[2]
        scale = Dh ** -0.5
        pos = torch.arange(S)
        off = torch.arange(W) * dil
        idx = pos[:, None] - off[None, :]
        mask = idx >= 0
        idx_c = torch.where(mask, idx, 0).reshape(-1)
        kg = k[:, :, idx_c, :].reshape(B, H, S, W, Dh)
        vg = v[:, :, idx_c, :].reshape(B, H, S, W, Dh)
        logits = torch.einsum("bhsd,bhswd->bhsw", q, kg) * scale
        logits = torch.where(mask[None, None, :, :], logits, -1e9)
        attn = _softmax(logits, axis=-1)
        o = torch.einsum("bhsw,bhswd->bhsd", attn, vg)
        return (lambda x, *d: x.permute(*d))(o, 0, 2, 1, 3).reshape(B, S, D) @ wo

    def _B_ref(x, w_gate, w_up, w_down):
        g = torch.einsum("bsd,df->bsf", x, w_gate)
        u = torch.einsum("bsd,df->bsf", x, w_up)
        h = _sigmoid(g) * u
        return torch.einsum("bsf,fd->bsd", h, w_down)

    x = A_x
    g = _sigmoid((x * gate_w).sum(-1, keepdims=True))
    a = _A_ref(x, A_wqkv, A_wo)
    b = _B_ref(x, B_w_gate, B_w_up, B_w_down)
    return g * a + (1 - g) * b
```

```asm
; @launch grid=(256,1,1) block=(256,1,1) lds=163840
.amdgcn_target "amdgcn-amd-amdhsa--gfx950"
.text
.globl gated_mix__sliding_local_dilated__glu_gated_glu__prompt_kernel
.p2align 8
.type gated_mix__sliding_local_dilated__glu_gated_glu__prompt_kernel,@function
gated_mix__sliding_local_dilated__glu_gated_glu__prompt_kernel:
    s_cmp_ge_u32 s2, 0x100
    s_cbranch_scc1 L_end
    s_load_dwordx16 s[4:19], s[0:1], 0x0
    s_load_dwordx4 s[20:23], s[0:1], 0x40
    s_load_dwordx2 s[24:25], s[0:1], 0x50
    s_getpc_b64 s[84:85]
L_pc:
    v_and_b32 v247, 63, v0
    v_lshrrev_b32 v1, 6, v0
    s_lshr_b32 s64, s2, 3
    v_readfirstlane_b32 s60, v1
    s_and_b32 s65, s64, 3
    v_lshlrev_b32 v2, 2, v0
    v_add_u32 v2, s65, v2
    v_lshlrev_b32 v2, 7, v2
    v_cmp_gt_u32 vcc, L_codeend-L_pc, v2
    s_nop 0
    s_and_saveexec_b64 s[66:67], vcc
    s_cbranch_execz L_nopf
    global_load_dword v3, v2, s[84:85]
L_nopf:
    s_mov_b64 exec, -1
    v_lshlrev_b32 v224, 4, v247
    s_and_b32 s65, s2, 1
    s_lshl_b32 s65, s65, 2
    s_lshr_b32 s66, s64, 3
    s_add_u32 s61, s65, s66
    s_and_b32 s65, s2, 7
    s_lshr_b32 s62, s65, 1
    s_and_b32 s63, s64, 7
    v_lshrrev_b32 v200, 3, v247
    v_and_b32 v201, 7, v247
    v_lshrrev_b32 v202, 1, v200
    v_xor_b32 v202, v202, v201
    s_lshl_b32 s64, s61, 8
    s_lshl_b32 s65, s60, 6
    s_add_u32 s64, s64, s65
    v_add_u32 v203, s64, v200
    v_mul_u32_u24 v203, 0x380, v203
    v_lshl_add_u32 v225, v202, 4, v203
    v_xor_b32 v204, 4, v202
    v_lshl_add_u32 v226, v204, 4, v203
    v_add_u32 v226, 0x1c00, v226
    s_mul_i32 s70, s60, 0x6000
    s_and_b32 s69, s61, 3
    s_lshl_b32 s69, s69, 1
    s_add_u32 s69, s69, s63
    s_cmp_ge_u32 s69, 7
    s_cselect_b32 s65, 7, 0
    s_sub_u32 s69, s69, s65
    s_movk_i32 s67, 0x55a3
    s_lshl_b32 s74, s62, 2
    s_add_u32 s74, s74, s63
    s_sub_u32 s74, s74, 4
    s_waitcnt lgkmcnt(0)
    s_mov_b32 s28, s4
    s_mov_b32 s29, s5
    s_mov_b32 s30, 0x1c0000
    s_mov_b32 s31, 0x20000
    s_lshl_b32 s4, s69, 7
    s_add_u32 m0, s70, 0
    s_nop 0
    buffer_load_dwordx4 v225, s[28:31], s4 offen lds
    s_add_u32 m0, s70, 0x400
    s_nop 0
    buffer_load_dwordx4 v226, s[28:31], s4 offen lds
    s_add_u32 m0, s70, 0x800
    s_add_u32 s75, s4, 0x3800
    buffer_load_dwordx4 v225, s[28:31], s75 offen lds
    s_add_u32 m0, s70, 0xc00
    s_add_u32 s75, s4, 0x3800
    buffer_load_dwordx4 v226, s[28:31], s75 offen lds
    s_add_u32 m0, s70, 0x1000
    s_add_u32 s75, s4, 0x7000
    buffer_load_dwordx4 v225, s[28:31], s75 offen lds
    s_add_u32 m0, s70, 0x1400
    s_add_u32 s75, s4, 0x7000
    buffer_load_dwordx4 v226, s[28:31], s75 offen lds
    s_add_u32 m0, s70, 0x1800
    s_add_u32 s75, s4, 0xa800
    buffer_load_dwordx4 v225, s[28:31], s75 offen lds
    s_add_u32 m0, s70, 0x1c00
    s_add_u32 s75, s4, 0xa800
    buffer_load_dwordx4 v226, s[28:31], s75 offen lds
    s_cmp_lt_u32 s63, 4
    s_cbranch_scc1 L_early_glu
    s_mul_i32 s68, s62, 0x380
    s_mul_i32 s64, s60, 0xc0
    s_mul_i32 s65, s74, 56
    v_add_u32 v205, s64, v247
    v_mul_u32_u24 v206, 0xaaab, v205
    v_lshrrev_b32 v206, 19, v206
    v_mul_u32_u24 v207, 12, v206
    v_sub_u32 v207, v205, v207
    v_mul_u32_u24 v206, 0xa80, v206
    v_lshrrev_b32 v205, 2, v207
    v_mul_u32_u24 v205, 0x380, v205
    v_add_u32 v206, v206, v205
    v_and_b32 v207, 3, v207
    v_lshl_add_u32 v206, v207, 4, v206
    v_add_u32 v227, s65, v206
    v_add_u32 v205, s64, v247
    v_add_u32 v205, 64, v205
    v_mul_u32_u24 v206, 0xaaab, v205
    v_lshrrev_b32 v206, 19, v206
    v_mul_u32_u24 v207, 12, v206
    v_sub_u32 v207, v205, v207
    v_mul_u32_u24 v206, 0xa80, v206
    v_lshrrev_b32 v205, 2, v207
    v_mul_u32_u24 v205, 0x380, v205
    v_add_u32 v206, v206, v205
    v_and_b32 v207, 3, v207
    v_lshl_add_u32 v206, v207, 4, v206
    v_add_u32 v228, s65, v206
    v_add_u32 v205, s64, v247
    v_add_u32 v205, 0x80, v205
    v_mul_u32_u24 v206, 0xaaab, v205
    v_lshrrev_b32 v206, 19, v206
    v_mul_u32_u24 v207, 12, v206
    v_sub_u32 v207, v205, v207
    v_mul_u32_u24 v206, 0xa80, v206
    v_lshrrev_b32 v205, 2, v207
    v_mul_u32_u24 v205, 0x380, v205
    v_add_u32 v206, v206, v205
    v_and_b32 v207, 3, v207
    v_lshl_add_u32 v206, v207, 4, v206
    v_add_u32 v229, s65, v206
    s_mul_i32 s71, s60, 0xc00
    s_add_u32 s71, s71, 0x18000
    s_lshl_b32 s64, s61, 8
    s_lshl_b32 s65, s60, 3
    s_add_u32 s64, s64, s65
    s_sub_u32 s64, s64, 32
    v_add_u32 v205, s64, v200
    s_movk_i32 s66, 0x380
    v_mul_lo_u32 v205, v205, s66
    s_and_b32 s65, s60, 1
    s_lshl_b32 s65, s65, 2
    v_xor_b32 v206, s65, v202
    v_lshl_add_u32 v231, v206, 4, v205
    s_lshl_b32 s73, s60, 10
    s_add_u32 s73, s73, 0x21300
    s_lshr_b32 s65, 0x4482, s74
    s_and_b32 s77, s65, 1
    s_lshl_b32 s65, s77, 6
    s_add_u32 s68, s68, s65
    s_add_u32 s68, s68, 0x300
    s_mov_b32 s32, s6
    s_mov_b32 s33, s7
    s_mov_b32 s34, 0x126000
    s_mov_b32 s35, 0x20000
    s_add_u32 m0, s71, 0
    s_mul_i32 s75, s4, 0x540
    buffer_load_dwordx4 v227, s[32:35], s75 offen lds
    s_add_u32 m0, s71, 0x400
    s_mul_i32 s75, s4, 0x540
    buffer_load_dwordx4 v228, s[32:35], s75 offen lds
    s_add_u32 m0, s71, 0x800
    s_mul_i32 s75, s4, 0x540
    buffer_load_dwordx4 v229, s[32:35], s75 offen lds
    s_add_u32 m0, s73, 0
    s_nop 0
    buffer_load_dwordx4 v231, s[28:31], s4 offen lds
    s_mov_b32 s44, s18
    s_mov_b32 s45, s19
    s_mov_b32 s46, 0x380
    s_mov_b32 s47, 0x20000
    s_mov_b32 m0, 0x24300
    s_nop 0
    buffer_load_dwordx4 v224, s[44:47], 0 offen lds
    s_cmp_lt_u32 s60, 2
    s_cselect_b32 s36, s12, s14
    s_cselect_b32 s37, s13, s15
    s_mov_b32 s38, 0x188000
    s_mov_b32 s39, 0x20000
    s_mov_b32 s40, s8
    s_mov_b32 s41, s9
    s_mov_b32 s42, 0x62000
    s_mov_b32 s43, 0x20000
    s_add_u32 s5, s4, 0x80
    s_cmp_eq_u32 s5, 0x380
    s_cselect_b32 s5, 0, s5
    s_add_u32 s6, s5, 0x80
    s_cmp_eq_u32 s6, 0x380
    s_cselect_b32 s6, 0, s6
    s_add_u32 s7, s6, 0x80
    s_cmp_eq_u32 s7, 0x380
    s_cselect_b32 s7, 0, s7
    s_add_u32 s8, s7, 0x80
    s_cmp_eq_u32 s8, 0x380
    s_cselect_b32 s8, 0, s8
    s_add_u32 s9, s8, 0x80
    s_cmp_eq_u32 s9, 0x380
    s_cselect_b32 s9, 0, s9
    s_add_u32 s10, s9, 0x80
    s_cmp_eq_u32 s10, 0x380
    s_cselect_b32 s10, 0, s10
    s_mov_b32 s52, s24
    s_mov_b32 s53, s25
    s_mov_b32 s54, 0x1000000
    s_mov_b32 s55, 0x20000
    s_lshl_b32 s64, s61, 7
    s_add_u32 s64, s64, 0xd04000
    v_mov_b32 v222, s64
    buffer_load_dwordx2 v[220:221], v222, s[52:55], 0 offen offset:0 sc1
    s_add_u32 m0, s71, 0x3100
    s_mul_i32 s75, s5, 0x540
    buffer_load_dwordx4 v227, s[32:35], s75 offen lds
    s_add_u32 m0, s70, 0x2000
    s_nop 0
    buffer_load_dwordx4 v225, s[28:31], s5 offen lds
    s_add_u32 m0, s70, 0x2400
    s_nop 0
    buffer_load_dwordx4 v226, s[28:31], s5 offen lds
    s_add_u32 m0, s71, 0x3500
    s_mul_i32 s75, s5, 0x540
    buffer_load_dwordx4 v228, s[32:35], s75 offen lds
    s_add_u32 m0, s70, 0x2800
    s_add_u32 s75, s5, 0x3800
    buffer_load_dwordx4 v225, s[28:31], s75 offen lds
    s_add_u32 m0, s70, 0x2c00
    s_add_u32 s75, s5, 0x3800
    buffer_load_dwordx4 v226, s[28:31], s75 offen lds
    s_add_u32 m0, s71, 0x3900
    s_mul_i32 s75, s5, 0x540
    buffer_load_dwordx4 v229, s[32:35], s75 offen lds
    v_and_b32 v205, 31, v247
    v_lshrrev_b32 v206, 5, v247
    v_bfe_u32 v207, v205, 1, 3
    v_lshlrev_b32 v208, 7, v205
    v_xor_b32 v207, v207, v206
    v_xor_b32 v209, 0, v207
    v_lshl_add_u32 v209, v209, 4, v208
    v_add_u32 v232, s70, v209
    v_xor_b32 v209, 2, v207
    v_lshl_add_u32 v209, v209, 4, v208
    v_add_u32 v233, s70, v209
    v_xor_b32 v209, 4, v207
    v_lshl_add_u32 v209, v209, 4, v208
    v_add_u32 v234, s70, v209
    v_xor_b32 v209, 6, v207
    v_lshl_add_u32 v209, v209, 4, v208
    v_add_u32 v235, s70, v209
    s_lshl_b32 s64, s60, 1
    v_xor_b32 v209, s64, v207
    v_lshl_add_u32 v209, v209, 4, v208
    v_add_u32 v238, 0x21300, v209
    v_bfe_u32 v205, v247, 4, 1
    v_bfe_u32 v207, v247, 2, 2
    v_and_b32 v208, 3, v247
    v_lshl_add_u32 v209, v206, 3, v207
    v_mul_u32_u24 v210, 0xc0, v209
    v_lshl_add_u32 v210, v205, 5, v210
    v_lshl_add_u32 v210, v208, 3, v210
    v_add_u32 v236, 0x18000, v210
    s_mul_i32 s64, s60, 0xc00
    v_add_u32 v237, s64, v236
    v_lshlrev_b32 v210, 4, v206
    v_add_u32 v243, 0x24300, v210
    s_mov_b32 s78, 0x10000000
    s_mov_b32 s79, 0x10000000
    v_lshlrev_b32 v210, 6, v209
    v_lshl_add_u32 v210, v208, 3, v210
    v_lshl_add_u32 v210, v205, 12, v210
    v_lshl_add_u32 v239, v205, 5, v210
    v_xor_b32 v211, 1, v205
    v_lshl_add_u32 v241, v211, 5, v210
    v_add_u32 v240, 0xc000, v239
    v_add_u32 v242, 0xc000, v241
    s_waitcnt vmcnt(7)
    s_barrier
    v_add_u32 v255, s4, v243
    ds_read_b128 a[0:3], v232 offset:0
    ds_read_b64_tr_b16 a[224:225], v236 offset:0
    ds_read_b64_tr_b16 a[226:227], v236 offset:768
    s_mov_b64 exec, s[78:79]
    ds_read_b128 a[224:227], v255 offset:0
    s_mov_b64 exec, -1
    ds_read_b128 a[4:7], v232 offset:4096
    ds_read_b64_tr_b16 a[228:229], v236 offset:64
    ds_read_b64_tr_b16 a[230:231], v236 offset:832
    ds_read_b64_tr_b16 a[232:233], v236 offset:128
    ds_read_b64_tr_b16 a[234:235], v236 offset:896
    s_bitcmp1_b32 s67, s74
    s_cbranch_scc1 L_h2
    s_branch L_h0
L_early_glu:
    s_mul_i32 s68, s62, 0x380
    s_lshl_b32 s65, s63, 7
    s_add_u32 s65, s68, s65
    s_and_b32 s64, s60, 1
    s_lshl_b32 s64, s64, 5
    v_add_u32 v205, s64, v200
    v_mul_u32_u24 v205, 0xe00, v205
    v_bfe_u32 v206, v247, 4, 1
    v_lshlrev_b32 v206, 1, v206
    v_xor_b32 v206, v206, v201
    s_and_b32 s64, s60, 2
    s_lshl_b32 s64, s64, 1
    v_xor_b32 v206, s64, v206
    v_lshl_add_u32 v205, v206, 4, v205
    v_add_u32 v227, s65, v205
    s_lshl_b32 s71, s60, 12
    s_add_u32 s71, s71, 0x18000
    s_lshl_b32 s65, s63, 6
    s_add_u32 s68, s68, s65
    s_add_u32 s68, s68, 0x200
    s_cmp_lt_u32 s60, 2
    s_cselect_b32 s36, s12, s14
    s_cselect_b32 s37, s13, s15
    s_mov_b32 s38, 0x188000
    s_mov_b32 s39, 0x20000
    s_add_u32 m0, s71, 0
    s_mul_i32 s75, s4, 0x700
    buffer_load_dwordx4 v227, s[36:39], s75 offen lds
    s_add_u32 m0, s71, 0x400
    s_mul_i32 s75, s4, 0x700
    s_add_u32 s75, s75, 0x7000
    buffer_load_dwordx4 v227, s[36:39], s75 offen lds
    s_add_u32 m0, s71, 0x800
    s_mul_i32 s75, s4, 0x700
    s_add_u32 s75, s75, 0xe000
    buffer_load_dwordx4 v227, s[36:39], s75 offen lds
    s_add_u32 m0, s71, 0xc00
    s_mul_i32 s75, s4, 0x700
    s_add_u32 s75, s75, 0x15000
    buffer_load_dwordx4 v227, s[36:39], s75 offen lds
    s_mov_b32 s40, s8
    s_mov_b32 s41, s9
    s_mov_b32 s42, 0x62000
    s_mov_b32 s43, 0x20000
    s_add_u32 s5, s4, 0x80
    s_cmp_eq_u32 s5, 0x380
    s_cselect_b32 s5, 0, s5
    s_add_u32 s6, s5, 0x80
    s_cmp_eq_u32 s6, 0x380
    s_cselect_b32 s6, 0, s6
    s_add_u32 s7, s6, 0x80
    s_cmp_eq_u32 s7, 0x380
    s_cselect_b32 s7, 0, s7
    s_add_u32 s8, s7, 0x80
    s_cmp_eq_u32 s8, 0x380
    s_cselect_b32 s8, 0, s8
    s_add_u32 s9, s8, 0x80
    s_cmp_eq_u32 s9, 0x380
    s_cselect_b32 s9, 0, s9
    s_add_u32 s10, s9, 0x80
    s_cmp_eq_u32 s10, 0x380
    s_cselect_b32 s10, 0, s10
    s_mov_b32 s52, s24
    s_mov_b32 s53, s25
    s_mov_b32 s54, 0x1000000
    s_mov_b32 s55, 0x20000
    s_lshl_b32 s64, s61, 7
    s_add_u32 s64, s64, 0xd04000
    v_mov_b32 v222, s64
    buffer_load_dwordx2 v[220:221], v222, s[52:55], 0 offen offset:0 sc1
    s_add_u32 m0, s71, 0x4000
    s_mul_i32 s75, s5, 0x700
    buffer_load_dwordx4 v227, s[36:39], s75 offen lds
    s_add_u32 m0, s70, 0x2000
    s_nop 0
    buffer_load_dwordx4 v225, s[28:31], s5 offen lds
    s_add_u32 m0, s70, 0x2400
    s_nop 0
    buffer_load_dwordx4 v226, s[28:31], s5 offen lds
    s_add_u32 m0, s71, 0x4400
    s_mul_i32 s75, s5, 0x700
    s_add_u32 s75, s75, 0x7000
    buffer_load_dwordx4 v227, s[36:39], s75 offen lds
    s_add_u32 m0, s70, 0x2800
    s_add_u32 s75, s5, 0x3800
    buffer_load_dwordx4 v225, s[28:31], s75 offen lds
    s_add_u32 m0, s70, 0x2c00
    s_add_u32 s75, s5, 0x3800
    buffer_load_dwordx4 v226, s[28:31], s75 offen lds
    s_add_u32 m0, s71, 0x4800
    s_mul_i32 s75, s5, 0x700
    s_add_u32 s75, s75, 0xe000
    buffer_load_dwordx4 v227, s[36:39], s75 offen lds
    v_and_b32 v205, 31, v247
    v_lshrrev_b32 v206, 5, v247
    v_bfe_u32 v207, v205, 1, 3
    v_lshlrev_b32 v208, 7, v205
    v_xor_b32 v207, v207, v206
    v_xor_b32 v209, 0, v207
    v_lshl_add_u32 v209, v209, 4, v208
    v_add_u32 v232, s70, v209
    v_xor_b32 v209, 2, v207
    v_lshl_add_u32 v209, v209, 4, v208
    v_add_u32 v233, s70, v209
    v_xor_b32 v209, 4, v207
    v_lshl_add_u32 v209, v209, 4, v208
    v_add_u32 v234, s70, v209
    v_xor_b32 v209, 6, v207
    v_lshl_add_u32 v209, v209, 4, v208
    v_add_u32 v235, s70, v209
    v_bfe_u32 v205, v247, 4, 1
    v_bfe_u32 v207, v247, 2, 2
    v_and_b32 v208, 3, v247
    v_lshl_add_u32 v209, v206, 3, v207
    v_lshlrev_b32 v210, 7, v209
    v_lshl_add_u32 v210, v205, 13, v210
    v_lshl_add_u32 v210, v208, 3, v210
    v_add_u32 v210, 0x18000, v210
    v_lshrrev_b32 v211, 1, v207
    v_lshl_add_u32 v211, v205, 1, v211
    v_xor_b32 v203, 0, v211
    v_lshl_add_u32 v236, v203, 5, v210
    v_xor_b32 v203, 1, v211
    v_lshl_add_u32 v237, v203, 5, v210
    v_xor_b32 v203, 2, v211
    v_lshl_add_u32 v238, v203, 5, v210
    v_xor_b32 v203, 3, v211
    v_lshl_add_u32 v243, v203, 5, v210
    v_lshlrev_b32 v210, 6, v209
    v_lshl_add_u32 v210, v208, 3, v210
    v_lshl_add_u32 v210, v205, 12, v210
    v_lshl_add_u32 v239, v205, 5, v210
    v_xor_b32 v211, 1, v205
    v_lshl_add_u32 v241, v211, 5, v210
    v_add_u32 v240, 0xc000, v239
    v_add_u32 v242, 0xc000, v241
    s_waitcnt vmcnt(7)
    s_barrier
    ds_read_b128 a[0:3], v232 offset:0
    ds_read_b64_tr_b16 a[224:225], v236 offset:0
    ds_read_b64_tr_b16 a[226:227], v236 offset:512
    ds_read_b128 a[4:7], v232 offset:4096
    ds_read_b64_tr_b16 a[228:229], v237 offset:0
    ds_read_b64_tr_b16 a[230:231], v237 offset:512
    ds_read_b64_tr_b16 a[232:233], v238 offset:0
    ds_read_b64_tr_b16 a[234:235], v238 offset:512
    ds_read_b64_tr_b16 a[236:237], v243 offset:0
    ds_read_b64_tr_b16 a[238:239], v243 offset:512
    s_waitcnt lgkmcnt(7)
    v_mfma_f32_32x32x16_bf16 v[0:15], a[224:227], a[0:3], 0
    ds_read_b128 a[8:11], v233 offset:0
    ds_read_b64_tr_b16 a[240:241], v236 offset:2048
    s_add_u32 m0, s70, 0x3000
    s_add_u32 s75, s5, 0x7000
    buffer_load_dwordx4 v225, s[28:31], s75 offen lds
    s_waitcnt lgkmcnt(8)
    v_mfma_f32_32x32x16_bf16 v[16:31], a[224:227], a[4:7], 0
    ds_read_b64_tr_b16 a[242:243], v236 offset:2560
    ds_read_b128 a[12:15], v233 offset:4096
    s_mov_b32 s56, s16
    s_mov_b32 s57, s17
    s_mov_b32 s58, 0x188000
    s_waitcnt lgkmcnt(8)
    v_mfma_f32_32x32x16_bf16 v[32:47], a[228:231], a[0:3], 0
    ds_read_b64_tr_b16 a[244:245], v237 offset:2048
    ds_read_b64_tr_b16 a[246:247], v237 offset:2560
    s_add_u32 m0, s70, 0x3400
    s_add_u32 s75, s5, 0x7000
    buffer_load_dwordx4 v226, s[28:31], s75 offen lds
    v_mfma_f32_32x32x16_bf16 v[48:63], a[228:231], a[4:7], 0
    ds_read_b64_tr_b16 a[248:249], v238 offset:2048
    ds_read_b64_tr_b16 a[250:251], v238 offset:2560
    s_add_u32 m0, s71, 0x4c00
    s_mul_i32 s75, s5, 0x700
    s_add_u32 s75, s75, 0x15000
    buffer_load_dwordx4 v227, s[36:39], s75 offen lds
    s_waitcnt lgkmcnt(10)
    v_mfma_f32_32x32x16_bf16 v[64:79], a[232:235], a[0:3], 0
    ds_read_b64_tr_b16 a[252:253], v243 offset:2048
    ds_read_b64_tr_b16 a[254:255], v243 offset:2560
    s_add_u32 m0, s70, 0x3800
    s_add_u32 s75, s5, 0xa800
    buffer_load_dwordx4 v225, s[28:31], s75 offen lds
    v_mfma_f32_32x32x16_bf16 v[80:95], a[232:235], a[4:7], 0
    s_mov_b32 s59, 0x20000
    s_lshr_b32 s64, s2, 3
    s_and_b32 s65, s2, 7
    s_lshl_b32 s65, s65, 2
    s_add_u32 s64, s64, s65
    s_waitcnt lgkmcnt(10)
    v_mfma_f32_32x32x16_bf16 v[96:111], a[236:239], a[0:3], 0
    s_add_u32 m0, s70, 0x3c00
    s_add_u32 s75, s5, 0xa800
    buffer_load_dwordx4 v226, s[28:31], s75 offen lds
    s_and_b32 s64, s64, 31
    s_lshl_b32 s64, s64, 2
    v_mfma_f32_32x32x16_bf16 v[112:127], a[236:239], a[4:7], 0
    s_add_u32 m0, s71, 0x8000
    s_mul_i32 s75, s6, 0x700
    buffer_load_dwordx4 v227, s[36:39], s75 offen lds
    s_add_u32 s64, s64, s60
    v_min_u32 v206, 24, v247
    s_waitcnt lgkmcnt(7)
    v_mfma_f32_32x32x16_bf16 v[0:15], a[240:243], a[8:11], v[0:15]
    ds_read_b128 a[16:19], v234 offset:0
    ds_read_b64_tr_b16 a[224:225], v236 offset:4096
    s_add_u32 m0, s70, 0x4000
    s_nop 0
    buffer_load_dwordx4 v225, s[28:31], s6 offen lds
    v_lshlrev_b32 v206, 7, v206
    s_waitcnt lgkmcnt(8)
    v_mfma_f32_32x32x16_bf16 v[16:31], a[240:243], a[12:15], v[16:31]
    ds_read_b64_tr_b16 a[226:227], v236 offset:4608
    ds_read_b128 a[20:23], v234 offset:4096
    s_mul_i32 s65, s64, 0x3100
    v_add_u32 v213, s65, v206
    s_mul_i32 s65, s64, 0xc80
    s_waitcnt lgkmcnt(8)
    v_mfma_f32_32x32x16_bf16 v[32:47], a[244:247], a[8:11], v[32:47]
    ds_read_b64_tr_b16 a[228:229], v237 offset:4096
    ds_read_b64_tr_b16 a[230:231], v237 offset:4608
    s_add_u32 m0, s70, 0x4400
    s_nop 0
    buffer_load_dwordx4 v226, s[28:31], s6 offen lds
    v_add_u32 v214, s65, v206
    v_mfma_f32_32x32x16_bf16 v[48:63], a[244:247], a[12:15], v[48:63]
    ds_read_b64_tr_b16 a[232:233], v238 offset:4096
    ds_read_b64_tr_b16 a[234:235], v238 offset:4608
    s_add_u32 m0, s71, 0x8400
    s_mul_i32 s75, s6, 0x700
    s_add_u32 s75, s75, 0x7000
    buffer_load_dwordx4 v227, s[36:39], s75 offen lds
    s_waitcnt lgkmcnt(10)
    v_mfma_f32_32x32x16_bf16 v[64:79], a[248:251], a[8:11], v[64:79]
    ds_read_b64_tr_b16 a[236:237], v243 offset:4096
    ds_read_b64_tr_b16 a[238:239], v243 offset:4608
    s_add_u32 m0, s70, 0x4800
    s_add_u32 s75, s6, 0x3800
    buffer_load_dwordx4 v225, s[28:31], s75 offen lds
    v_mfma_f32_32x32x16_bf16 v[80:95], a[248:251], a[12:15], v[80:95]
    s_and_b32 s64, s60, 1
    s_lshl_b32 s64, s64, 5
    s_and_b32 s65, s60, 2
    v_lshrrev_b32 v205, 2, v247
    v_add_u32 v205, s64, v205
    s_waitcnt lgkmcnt(10)
    v_mfma_f32_32x32x16_bf16 v[96:111], a[252:255], a[8:11], v[96:111]
    s_add_u32 m0, s70, 0x4c00
    s_add_u32 s75, s6, 0x3800
    buffer_load_dwordx4 v226, s[28:31], s75 offen lds
    v_mul_u32_u24 v205, 0xe00, v205
    v_and_b32 v206, 3, v247
    v_mfma_f32_32x32x16_bf16 v[112:127], a[252:255], a[12:15], v[112:127]
    s_add_u32 m0, s71, 0x8800
    s_mul_i32 s75, s6, 0x700
    s_add_u32 s75, s75, 0xe000
    buffer_load_dwordx4 v227, s[36:39], s75 offen lds
    v_xor_b32 v206, s65, v206
    s_waitcnt lgkmcnt(7)
    v_mfma_f32_32x32x16_bf16 v[0:15], a[224:227], a[16:19], v[0:15]
    ds_read_b128 a[24:27], v235 offset:0
    ds_read_b64_tr_b16 a[240:241], v236 offset:6144
    ds_read_b64_tr_b16 a[242:243], v236 offset:6656
    s_add_u32 m0, s70, 0x5000
    s_add_u32 s75, s6, 0x7000
    buffer_load_dwordx4 v225, s[28:31], s75 offen lds
    s_waitcnt lgkmcnt(9)
    v_mfma_f32_32x32x16_bf16 v[16:31], a[224:227], a[20:23], v[16:31]
    ds_read_b128 a[28:31], v235 offset:4096
    ds_read_b64_tr_b16 a[244:245], v237 offset:6144
    ds_read_b64_tr_b16 a[246:247], v237 offset:6656
    v_lshl_add_u32 v205, v206, 4, v205
    v_add_u32 v230, s68, v205
    s_waitcnt lgkmcnt(10)
    v_mfma_f32_32x32x16_bf16 v[32:47], a[228:231], a[16:19], v[32:47]
    ds_read_b64_tr_b16 a[248:249], v238 offset:6144
    ds_read_b64_tr_b16 a[250:251], v238 offset:6656
    ds_read_b64_tr_b16 a[252:253], v243 offset:6144
    s_add_u32 m0, s70, 0x5400
    s_add_u32 s75, s6, 0x7000
    buffer_load_dwordx4 v226, s[28:31], s75 offen lds
    v_mfma_f32_32x32x16_bf16 v[48:63], a[228:231], a[20:23], v[48:63]
    ds_read_b64_tr_b16 a[254:255], v243 offset:6656
    s_lshl_b32 s76, s2, 2
    s_add_u32 s76, s76, s60
    s_mul_i32 s76, s76, 0x680
    v_min_u32 v217, 12, v247
    v_lshlrev_b32 v217, 7, v217
    buffer_load_dword v217, v217, s[56:59], s76 offen offset:0
    s_waitcnt lgkmcnt(12)
    v_mfma_f32_32x32x16_bf16 v[64:79], a[232:235], a[16:19], v[64:79]
    s_lshl_b32 s76, s2, 2
    s_add_u32 s76, s76, s60
    s_lshl_b32 s76, s76, 9
    v_min_u32 v215, 3, v247
    v_lshlrev_b32 v215, 7, v215
    buffer_load_dword v215, v215, s[40:43], s76 offen offset:0
    s_add_u32 m0, s71, 0x8c00
    s_mul_i32 s75, s6, 0x700
    s_add_u32 s75, s75, 0x15000
    buffer_load_dwordx4 v227, s[36:39], s75 offen lds
    v_mfma_f32_32x32x16_bf16 v[80:95], a[232:235], a[20:23], v[80:95]
    s_add_u32 m0, s70, 0x5800
    s_add_u32 s75, s6, 0xa800
    buffer_load_dwordx4 v225, s[28:31], s75 offen lds
    s_lshl_b32 s72, s60, 11
    s_lshl_b32 s27, s63, 12
    s_waitcnt lgkmcnt(10)
    v_mfma_f32_32x32x16_bf16 v[96:111], a[236:239], a[16:19], v[96:111]
    s_sub_u32 s27, 0xc000, s27
    s_lshl_b32 s64, s61, 2
    s_add_u32 s64, s64, s60
    s_mul_i32 s64, s64, 0x90
    s_mul_i32 s65, s62, 36
    v_mfma_f32_32x32x16_bf16 v[112:127], a[236:239], a[20:23], v[112:127]
    s_add_u32 m0, s70, 0x5c00
    s_add_u32 s75, s6, 0xa800
    buffer_load_dwordx4 v226, s[28:31], s75 offen lds
    s_add_u32 s64, s64, s65
    s_lshl_b32 s65, s63, 2
    s_waitcnt lgkmcnt(7)
    v_mfma_f32_32x32x16_bf16 v[0:15], a[240:243], a[24:27], v[0:15]
    s_add_u32 s64, s64, s65
    s_lshl_b32 s64, s64, 11
    v_add_u32 v246, s64, v224
    s_lshl_b32 s64, s61, 2
    s_add_u32 s64, s64, s60
    s_waitcnt lgkmcnt(6)
    v_mfma_f32_32x32x16_bf16 v[16:31], a[240:243], a[28:31], v[16:31]
    s_waitcnt lgkmcnt(0)
    s_waitcnt vmcnt(14)
    s_barrier
    ds_read_b128 a[32:35], v232 offset:8192
    ds_read_b64_tr_b16 a[224:225], v236 offset:16384
    s_lshl_b32 s64, s64, 2
    s_add_u32 s64, s64, s62
    s_lshl_b32 s64, s64, 4
    v_mfma_f32_32x32x16_bf16 v[32:47], a[244:247], a[24:27], v[32:47]
    ds_read_b64_tr_b16 a[226:227], v236 offset:16896
    ds_read_b128 a[36:39], v232 offset:12288
    s_add_u32 m0, s71, 0
    s_mul_i32 s75, s7, 0x700
    buffer_load_dwordx4 v227, s[36:39], s75 offen lds
    v_mfma_f32_32x32x16_bf16 v[48:63], a[244:247], a[28:31], v[48:63]
    ds_read_b64_tr_b16 a[228:229], v237 offset:16384
    ds_read_b64_tr_b16 a[230:231], v237 offset:16896
    s_add_u32 s64, s64, s63
    s_lshl_b32 s64, s64, 3
    s_add_u32 s64, s64, 0xd00000
    v_mfma_f32_32x32x16_bf16 v[64:79], a[248:251], a[24:27], v[64:79]
    ds_read_b64_tr_b16 a[232:233], v238 offset:16384
    ds_read_b64_tr_b16 a[234:235], v238 offset:16896
    s_add_u32 m0, s70, 0
    s_nop 0
    buffer_load_dwordx4 v225, s[28:31], s7 offen lds
    v_and_b32 v205, 1, v247
    v_mfma_f32_32x32x16_bf16 v[80:95], a[248:251], a[28:31], v[80:95]
    ds_read_b64_tr_b16 a[236:237], v243 offset:16384
    ds_read_b64_tr_b16 a[238:239], v243 offset:16896
    v_lshlrev_b32 v205, 6, v205
    v_add_u32 v244, s64, v205
    v_mfma_f32_32x32x16_bf16 v[96:111], a[252:255], a[24:27], v[96:111]
    s_add_u32 m0, s70, 0x400
    s_nop 0
    buffer_load_dwordx4 v226, s[28:31], s7 offen lds
    s_mov_b32 s64, 0x19660d
    v_mul_lo_u32 v220, v220, s64
    v_add_u32 v220, 0x3c6ef35f, v220
    v_mfma_f32_32x32x16_bf16 v[112:127], a[252:255], a[28:31], v[112:127]
    s_mov_b32 s64, 0x15a4e35
    v_mul_lo_u32 v221, v221, s64
    v_add_u32 v221, 1, v221
    s_waitcnt lgkmcnt(7)
    v_mfma_f32_32x32x16_bf16 v[0:15], a[224:227], a[32:35], v[0:15]
    ds_read_b128 a[40:43], v233 offset:8192
    ds_read_b64_tr_b16 a[240:241], v236 offset:18432
    s_cmp_gt_u32 s63, 3
    s_cselect_b32 s64, 1, 0
    s_sub_u32 s85, s63, s64
    s_waitcnt lgkmcnt(8)
    v_mfma_f32_32x32x16_bf16 v[16:31], a[224:227], a[36:39], v[16:31]
    ds_read_b64_tr_b16 a[242:243], v236 offset:18944
    ds_read_b128 a[44:47], v233 offset:12288
    s_add_u32 m0, s71, 0x400
    s_mul_i32 s75, s7, 0x700
    s_add_u32 s75, s75, 0x7000
    buffer_load_dwordx4 v227, s[36:39], s75 offen lds
    s_waitcnt lgkmcnt(8)
    v_mfma_f32_32x32x16_bf16 v[32:47], a[228:231], a[32:35], v[32:47]
    ds_read_b64_tr_b16 a[244:245], v237 offset:18432
    ds_read_b64_tr_b16 a[246:247], v237 offset:18944
    v_bfe_u32 v205, v247, 4, 1
    v_lshlrev_b32 v205, 2, v205
    v_xor_b32 v205, v205, v201
    v_mfma_f32_32x32x16_bf16 v[48:63], a[228:231], a[36:39], v[48:63]
    ds_read_b64_tr_b16 a[248:249], v238 offset:18432
    ds_read_b64_tr_b16 a[250:251], v238 offset:18944
    v_mul_u32_u24 v206, 0x380, v200
    v_lshl_add_u32 v206, v205, 4, v206
    s_lshl_b32 s64, s85, 7
    s_waitcnt lgkmcnt(10)
    v_mfma_f32_32x32x16_bf16 v[64:79], a[232:235], a[32:35], v[64:79]
    ds_read_b64_tr_b16 a[252:253], v243 offset:18432
    ds_read_b64_tr_b16 a[254:255], v243 offset:18944
    s_add_u32 m0, s70, 0x800
    s_add_u32 s75, s7, 0x3800
    buffer_load_dwordx4 v225, s[28:31], s75 offen lds
    v_mfma_f32_32x32x16_bf16 v[80:95], a[232:235], a[36:39], v[80:95]
    s_mul_i32 s65, s60, 0x18800
    s_add_u32 s65, s65, s64
    v_add_u32 v245, s65, v206
    s_mul_i32 s65, s60, 0x62000
    s_add_u32 s65, s65, s64
    s_waitcnt lgkmcnt(10)
    v_mfma_f32_32x32x16_bf16 v[96:111], a[236:239], a[32:35], v[96:111]
    s_add_u32 m0, s70, 0xc00
    s_add_u32 s75, s7, 0x3800
    buffer_load_dwordx4 v226, s[28:31], s75 offen lds
    v_add_u32 v223, s65, v206
    s_lshl_b32 s64, s61, 2
    v_mfma_f32_32x32x16_bf16 v[112:127], a[236:239], a[36:39], v[112:127]
    s_add_u32 s64, s64, s62
    s_lshl_b32 s64, s64, 2
    s_add_u32 s64, s64, s60
    s_lshl_b32 s64, s64, 7
    s_add_u32 s64, s64, 0xd00000
    s_waitcnt lgkmcnt(7)
    v_mfma_f32_32x32x16_bf16 v[0:15], a[240:243], a[40:43], v[0:15]
    ds_read_b128 a[48:51], v234 offset:8192
    ds_read_b64_tr_b16 a[224:225], v236 offset:20480
    v_and_b32 v205, 15, v247
    v_lshlrev_b32 v205, 3, v205
    v_add_u32 v216, s64, v205
    s_waitcnt lgkmcnt(8)
    v_mfma_f32_32x32x16_bf16 v[16:31], a[240:243], a[44:47], v[16:31]
    ds_read_b64_tr_b16 a[226:227], v236 offset:20992
    ds_read_b128 a[52:55], v234 offset:12288
    s_add_u32 m0, s71, 0x800
    s_mul_i32 s75, s7, 0x700
    s_add_u32 s75, s75, 0xe000
    buffer_load_dwordx4 v227, s[36:39], s75 offen lds
    s_waitcnt lgkmcnt(8)
    v_mfma_f32_32x32x16_bf16 v[32:47], a[244:247], a[40:43], v[32:47]
    ds_read_b64_tr_b16 a[228:229], v237 offset:20480
    ds_read_b64_tr_b16 a[230:231], v237 offset:20992
    s_lshl_b32 s64, s61, 2
    s_add_u32 s64, s64, s62
    s_mul_i32 s64, s64, 0x90
    v_mfma_f32_32x32x16_bf16 v[48:63], a[244:247], a[44:47], v[48:63]
    ds_read_b64_tr_b16 a[232:233], v238 offset:20480
    ds_read_b64_tr_b16 a[234:235], v238 offset:20992
    s_mul_i32 s65, s60, 36
    s_add_u32 s64, s64, s65
    s_lshl_b32 s64, s64, 11
    s_waitcnt lgkmcnt(10)
    v_mfma_f32_32x32x16_bf16 v[64:79], a[248:251], a[40:43], v[64:79]
    ds_read_b64_tr_b16 a[236:237], v243 offset:20480
    ds_read_b64_tr_b16 a[238:239], v243 offset:20992
    s_add_u32 m0, s70, 0x1000
    s_add_u32 s75, s7, 0x7000
    buffer_load_dwordx4 v225, s[28:31], s75 offen lds
    v_mfma_f32_32x32x16_bf16 v[80:95], a[248:251], a[44:47], v[80:95]
    s_mul_i32 s65, s85, 37
    v_min_u32 v205, 36, v247
    v_add_u32 v205, s65, v205
    v_min_u32 v205, 0xff, v205
    v_lshlrev_b32 v205, 7, v205
    s_waitcnt lgkmcnt(10)
    v_mfma_f32_32x32x16_bf16 v[96:111], a[252:255], a[40:43], v[96:111]
    s_add_u32 m0, s70, 0x1400
    s_add_u32 s75, s7, 0x7000
    buffer_load_dwordx4 v226, s[28:31], s75 offen lds
    s_waitcnt vmcnt(12)
    v_add_u32 v215, s64, v205
    s_mul_i32 s26, s60, 0xe00
    v_mfma_f32_32x32x16_bf16 v[112:127], a[252:255], a[44:47], v[112:127]
    s_add_u32 s26, s26, 0x24800
    s_mul_i32 s3, s60, 0x3000
    s_add_u32 s3, s3, 0x18000
    s_mov_b32 s48, s20
    s_mov_b32 s49, s21
    s_waitcnt lgkmcnt(7)
    v_mfma_f32_32x32x16_bf16 v[0:15], a[224:227], a[48:51], v[0:15]
    ds_read_b128 a[56:59], v235 offset:8192
    ds_read_b64_tr_b16 a[240:241], v236 offset:22528
    s_mov_b32 s50, 0x1c0000
    s_mov_b32 s51, 0x20000
    s_waitcnt lgkmcnt(8)
    v_mfma_f32_32x32x16_bf16 v[16:31], a[224:227], a[52:55], v[16:31]
    ds_read_b64_tr_b16 a[242:243], v236 offset:23040
    ds_read_b128 a[60:63], v235 offset:12288
    s_add_u32 m0, s71, 0xc00
    s_mul_i32 s75, s7, 0x700
    s_add_u32 s75, s75, 0x15000
    buffer_load_dwordx4 v227, s[36:39], s75 offen lds
    s_waitcnt lgkmcnt(8)
    v_mfma_f32_32x32x16_bf16 v[32:47], a[228:231], a[48:51], v[32:47]
    ds_read_b64_tr_b16 a[244:245], v237 offset:22528
    ds_read_b64_tr_b16 a[246:247], v237 offset:23040
    v_mfma_f32_32x32x16_bf16 v[48:63], a[228:231], a[52:55], v[48:63]
    ds_read_b64_tr_b16 a[248:249], v238 offset:22528
    ds_read_b64_tr_b16 a[250:251], v238 offset:23040
    s_waitcnt lgkmcnt(10)
    v_mfma_f32_32x32x16_bf16 v[64:79], a[232:235], a[48:51], v[64:79]
    ds_read_b64_tr_b16 a[252:253], v243 offset:22528
    ds_read_b64_tr_b16 a[254:255], v243 offset:23040
    s_add_u32 m0, s70, 0x1800
    s_add_u32 s75, s7, 0xa800
    buffer_load_dwordx4 v225, s[28:31], s75 offen lds
    v_mfma_f32_32x32x16_bf16 v[80:95], a[232:235], a[52:55], v[80:95]
    s_waitcnt lgkmcnt(10)
    v_mfma_f32_32x32x16_bf16 v[96:111], a[236:239], a[48:51], v[96:111]
    s_add_u32 m0, s70, 0x1c00
    s_add_u32 s75, s7, 0xa800
    buffer_load_dwordx4 v226, s[28:31], s75 offen lds
    v_mfma_f32_32x32x16_bf16 v[112:127], a[236:239], a[52:55], v[112:127]
    s_waitcnt lgkmcnt(7)
    v_mfma_f32_32x32x16_bf16 v[0:15], a[240:243], a[56:59], v[0:15]
    s_waitcnt lgkmcnt(6)
    v_mfma_f32_32x32x16_bf16 v[16:31], a[240:243], a[60:63], v[16:31]
    s_waitcnt lgkmcnt(0)
    s_waitcnt vmcnt(12)
    s_barrier
    ds_read_b128 a[64:67], v232 offset:16384
    ds_read_b64_tr_b16 a[224:225], v236 offset:32768
    v_mfma_f32_32x32x16_bf16 v[32:47], a[244:247], a[56:59], v[32:47]
    ds_read_b64_tr_b16 a[226:227], v236 offset:33280
    ds_read_b128 a[68:71], v232 offset:20480
    s_add_u32 m0, s71, 0x4000
    s_mul_i32 s75, s8, 0x700
    buffer_load_dwordx4 v227, s[36:39], s75 offen lds
    v_mfma_f32_32x32x16_bf16 v[48:63], a[244:247], a[60:63], v[48:63]
    ds_read_b64_tr_b16 a[228:229], v237 offset:32768
    ds_read_b64_tr_b16 a[230:231], v237 offset:33280
    v_mfma_f32_32x32x16_bf16 v[64:79], a[248:251], a[56:59], v[64:79]
    ds_read_b64_tr_b16 a[232:233], v238 offset:32768
    ds_read_b64_tr_b16 a[234:235], v238 offset:33280
    s_add_u32 m0, s70, 0x2000
    s_nop 0
    buffer_load_dwordx4 v225, s[28:31], s8 offen lds
    v_mfma_f32_32x32x16_bf16 v[80:95], a[248:251], a[60:63], v[80:95]
    ds_read_b64_tr_b16 a[236:237], v243 offset:32768
    ds_read_b64_tr_b16 a[238:239], v243 offset:33280
    v_mfma_f32_32x32x16_bf16 v[96:111], a[252:255], a[56:59], v[96:111]
    s_add_u32 m0, s70, 0x2400
    s_nop 0
    buffer_load_dwordx4 v226, s[28:31], s8 offen lds
    v_mfma_f32_32x32x16_bf16 v[112:127], a[252:255], a[60:63], v[112:127]
    s_waitcnt lgkmcnt(7)
    v_mfma_f32_32x32x16_bf16 v[0:15], a[224:227], a[64:67], v[0:15]
    ds_read_b128 a[72:75], v233 offset:16384
    ds_read_b64_tr_b16 a[240:241], v236 offset:34816
    s_waitcnt lgkmcnt(8)
    v_mfma_f32_32x32x16_bf16 v[16:31], a[224:227], a[68:71], v[16:31]
    ds_read_b64_tr_b16 a[242:243], v236 offset:35328
    ds_read_b128 a[76:79], v233 offset:20480
    s_add_u32 m0, s71, 0x4400
    s_mul_i32 s75, s8, 0x700
    s_add_u32 s75, s75, 0x7000
    buffer_load_dwordx4 v227, s[36:39], s75 offen lds
    s_waitcnt lgkmcnt(8)
    v_mfma_f32_32x32x16_bf16 v[32:47], a[228:231], a[64:67], v[32:47]
    ds_read_b64_tr_b16 a[244:245], v237 offset:34816
    ds_read_b64_tr_b16 a[246:247], v237 offset:35328
    v_mfma_f32_32x32x16_bf16 v[48:63], a[228:231], a[68:71], v[48:63]
    ds_read_b64_tr_b16 a[248:249], v238 offset:34816
    ds_read_b64_tr_b16 a[250:251], v238 offset:35328
    s_waitcnt lgkmcnt(10)
    v_mfma_f32_32x32x16_bf16 v[64:79], a[232:235], a[64:67], v[64:79]
    ds_read_b64_tr_b16 a[252:253], v243 offset:34816
    ds_read_b64_tr_b16 a[254:255], v243 offset:35328
    s_add_u32 m0, s70, 0x2800
    s_add_u32 s75, s8, 0x3800
    buffer_load_dwordx4 v225, s[28:31], s75 offen lds
    v_mfma_f32_32x32x16_bf16 v[80:95], a[232:235], a[68:71], v[80:95]
    s_waitcnt lgkmcnt(10)
    v_mfma_f32_32x32x16_bf16 v[96:111], a[236:239], a[64:67], v[96:111]
    s_add_u32 m0, s70, 0x2c00
    s_add_u32 s75, s8, 0x3800
    buffer_load_dwordx4 v226, s[28:31], s75 offen lds
    v_mfma_f32_32x32x16_bf16 v[112:127], a[236:239], a[68:71], v[112:127]
    s_waitcnt lgkmcnt(7)
    v_mfma_f32_32x32x16_bf16 v[0:15], a[240:243], a[72:75], v[0:15]
    ds_read_b128 a[80:83], v234 offset:16384
    ds_read_b64_tr_b16 a[224:225], v236 offset:36864
    s_waitcnt lgkmcnt(8)
    v_mfma_f32_32x32x16_bf16 v[16:31], a[240:243], a[76:79], v[16:31]
    ds_read_b64_tr_b16 a[226:227], v236 offset:37376
    ds_read_b128 a[84:87], v234 offset:20480
    s_add_u32 m0, s71, 0x4800
    s_mul_i32 s75, s8, 0x700
    s_add_u32 s75, s75, 0xe000
    buffer_load_dwordx4 v227, s[36:39], s75 offen lds
    s_waitcnt lgkmcnt(8)
    v_mfma_f32_32x32x16_bf16 v[32:47], a[244:247], a[72:75], v[32:47]
    ds_read_b64_tr_b16 a[228:229], v237 offset:36864
    ds_read_b64_tr_b16 a[230:231], v237 offset:37376
    v_mfma_f32_32x32x16_bf16 v[48:63], a[244:247], a[76:79], v[48:63]
    ds_read_b64_tr_b16 a[232:233], v238 offset:36864
    ds_read_b64_tr_b16 a[234:235], v238 offset:37376
    s_waitcnt lgkmcnt(10)
    v_mfma_f32_32x32x16_bf16 v[64:79], a[248:251], a[72:75], v[64:79]
    ds_read_b64_tr_b16 a[236:237], v243 offset:36864
    ds_read_b64_tr_b16 a[238:239], v243 offset:37376
    s_add_u32 m0, s70, 0x3000
    s_add_u32 s75, s8, 0x7000
    buffer_load_dwordx4 v225, s[28:31], s75 offen lds
    v_mfma_f32_32x32x16_bf16 v[80:95], a[248:251], a[76:79], v[80:95]
    s_waitcnt lgkmcnt(10)
    v_mfma_f32_32x32x16_bf16 v[96:111], a[252:255], a[72:75], v[96:111]
    s_add_u32 m0, s70, 0x3400
    s_add_u32 s75, s8, 0x7000
    buffer_load_dwordx4 v226, s[28:31], s75 offen lds
    v_mfma_f32_32x32x16_bf16 v[112:127], a[252:255], a[76:79], v[112:127]
    s_waitcnt lgkmcnt(7)
    v_mfma_f32_32x32x16_bf16 v[0:15], a[224:227], a[80:83], v[0:15]
    ds_read_b128 a[88:91], v235 offset:16384
    ds_read_b64_tr_b16 a[240:241], v236 offset:38912
    s_waitcnt lgkmcnt(8)
    v_mfma_f32_32x32x16_bf16 v[16:31], a[224:227], a[84:87], v[16:31]
    ds_read_b64_tr_b16 a[242:243], v236 offset:39424
    ds_read_b128 a[92:95], v235 offset:20480
    s_add_u32 m0, s71, 0x4c00
    s_mul_i32 s75, s8, 0x700
    s_add_u32 s75, s75, 0x15000
    buffer_load_dwordx4 v227, s[36:39], s75 offen lds
    s_waitcnt lgkmcnt(8)
    v_mfma_f32_32x32x16_bf16 v[32:47], a[228:231], a[80:83], v[32:47]
    ds_read_b64_tr_b16 a[244:245], v237 offset:38912
    ds_read_b64_tr_b16 a[246:247], v237 offset:39424
    v_mfma_f32_32x32x16_bf16 v[48:63], a[228:231], a[84:87], v[48:63]
    ds_read_b64_tr_b16 a[248:249], v238 offset:38912
    ds_read_b64_tr_b16 a[250:251], v238 offset:39424
    s_waitcnt lgkmcnt(10)
    v_mfma_f32_32x32x16_bf16 v[64:79], a[232:235], a[80:83], v[64:79]
    ds_read_b64_tr_b16 a[252:253], v243 offset:38912
    ds_read_b64_tr_b16 a[254:255], v243 offset:39424
    s_add_u32 m0, s70, 0x3800
    s_add_u32 s75, s8, 0xa800
    buffer_load_dwordx4 v225, s[28:31], s75 offen lds
    v_mfma_f32_32x32x16_bf16 v[80:95], a[232:235], a[84:87], v[80:95]
    s_waitcnt lgkmcnt(10)
    v_mfma_f32_32x32x16_bf16 v[96:111], a[236:239], a[80:83], v[96:111]
    s_add_u32 m0, s70, 0x3c00
    s_add_u32 s75, s8, 0xa800
    buffer_load_dwordx4 v226, s[28:31], s75 offen lds
    v_mfma_f32_32x32x16_bf16 v[112:127], a[236:239], a[84:87], v[112:127]
    s_waitcnt lgkmcnt(7)
    v_mfma_f32_32x32x16_bf16 v[0:15], a[240:243], a[88:91], v[0:15]
    s_waitcnt lgkmcnt(6)
    v_mfma_f32_32x32x16_bf16 v[16:31], a[240:243], a[92:95], v[16:31]
    s_waitcnt lgkmcnt(0)
    s_waitcnt vmcnt(12)
    s_barrier
    ds_read_b128 a[96:99], v232 offset:0
    ds_read_b64_tr_b16 a[224:225], v236 offset:0
    v_mfma_f32_32x32x16_bf16 v[32:47], a[244:247], a[88:91], v[32:47]
    ds_read_b64_tr_b16 a[226:227], v236 offset:512
    ds_read_b128 a[100:103], v232 offset:4096
    s_add_u32 m0, s71, 0x8000
    s_mul_i32 s75, s9, 0x700
    buffer_load_dwordx4 v227, s[36:39], s75 offen lds
    v_mfma_f32_32x32x16_bf16 v[48:63], a[244:247], a[92:95], v[48:63]
    ds_read_b64_tr_b16 a[228:229], v237 offset:0
    ds_read_b64_tr_b16 a[230:231], v237 offset:512
    v_mfma_f32_32x32x16_bf16 v[64:79], a[248:251], a[88:91], v[64:79]
    ds_read_b64_tr_b16 a[232:233], v238 offset:0
    ds_read_b64_tr_b16 a[234:235], v238 offset:512
    s_add_u32 m0, s70, 0x4000
    s_nop 0
    buffer_load_dwordx4 v225, s[28:31], s9 offen lds
    v_mfma_f32_32x32x16_bf16 v[80:95], a[248:251], a[92:95], v[80:95]
    ds_read_b64_tr_b16 a[236:237], v243 offset:0
    ds_read_b64_tr_b16 a[238:239], v243 offset:512
    v_mfma_f32_32x32x16_bf16 v[96:111], a[252:255], a[88:91], v[96:111]
    s_add_u32 m0, s70, 0x4400
    s_nop 0
    buffer_load_dwordx4 v226, s[28:31], s9 offen lds
    v_mfma_f32_32x32x16_bf16 v[112:127], a[252:255], a[92:95], v[112:127]
    s_waitcnt lgkmcnt(7)
    v_mfma_f32_32x32x16_bf16 v[0:15], a[224:227], a[96:99], v[0:15]
    ds_read_b128 a[104:107], v233 offset:0
    ds_read_b64_tr_b16 a[240:241], v236 offset:2048
    s_waitcnt lgkmcnt(8)
    v_mfma_f32_32x32x16_bf16 v[16:31], a[224:227], a[100:103], v[16:31]
    ds_read_b64_tr_b16 a[242:243], v236 offset:2560
    ds_read_b128 a[108:111], v233 offset:4096
    s_add_u32 m0, s71, 0x8400
    s_mul_i32 s75, s9, 0x700
    s_add_u32 s75, s75, 0x7000
    buffer_load_dwordx4 v227, s[36:39], s75 offen lds
    s_waitcnt lgkmcnt(8)
    v_mfma_f32_32x32x16_bf16 v[32:47], a[228:231], a[96:99], v[32:47]
    ds_read_b64_tr_b16 a[244:245], v237 offset:2048
    ds_read_b64_tr_b16 a[246:247], v237 offset:2560
    v_mfma_f32_32x32x16_bf16 v[48:63], a[228:231], a[100:103], v[48:63]
    ds_read_b64_tr_b16 a[248:249], v238 offset:2048
    ds_read_b64_tr_b16 a[250:251], v238 offset:2560
    s_waitcnt lgkmcnt(10)
    v_mfma_f32_32x32x16_bf16 v[64:79], a[232:235], a[96:99], v[64:79]
    ds_read_b64_tr_b16 a[252:253], v243 offset:2048
    ds_read_b64_tr_b16 a[254:255], v243 offset:2560
    s_add_u32 m0, s70, 0x4800
    s_add_u32 s75, s9, 0x3800
    buffer_load_dwordx4 v225, s[28:31], s75 offen lds
    v_mfma_f32_32x32x16_bf16 v[80:95], a[232:235], a[100:103], v[80:95]
    s_waitcnt lgkmcnt(10)
    v_mfma_f32_32x32x16_bf16 v[96:111], a[236:239], a[96:99], v[96:111]
    s_add_u32 m0, s70, 0x4c00
    s_add_u32 s75, s9, 0x3800
    buffer_load_dwordx4 v226, s[28:31], s75 offen lds
    v_mfma_f32_32x32x16_bf16 v[112:127], a[236:239], a[100:103], v[112:127]
    s_waitcnt lgkmcnt(7)
    v_mfma_f32_32x32x16_bf16 v[0:15], a[240:243], a[104:107], v[0:15]
    ds_read_b128 a[112:115], v234 offset:0
    ds_read_b64_tr_b16 a[224:225], v236 offset:4096
    s_waitcnt lgkmcnt(8)
    v_mfma_f32_32x32x16_bf16 v[16:31], a[240:243], a[108:111], v[16:31]
    ds_read_b64_tr_b16 a[226:227], v236 offset:4608
    ds_read_b128 a[116:119], v234 offset:4096
    s_add_u32 m0, s71, 0x8800
    s_mul_i32 s75, s9, 0x700
    s_add_u32 s75, s75, 0xe000
    buffer_load_dwordx4 v227, s[36:39], s75 offen lds
    s_waitcnt lgkmcnt(8)
    v_mfma_f32_32x32x16_bf16 v[32:47], a[244:247], a[104:107], v[32:47]
    ds_read_b64_tr_b16 a[228:229], v237 offset:4096
    ds_read_b64_tr_b16 a[230:231], v237 offset:4608
    v_mfma_f32_32x32x16_bf16 v[48:63], a[244:247], a[108:111], v[48:63]
    ds_read_b64_tr_b16 a[232:233], v238 offset:4096
    ds_read_b64_tr_b16 a[234:235], v238 offset:4608
    s_waitcnt lgkmcnt(10)
    v_mfma_f32_32x32x16_bf16 v[64:79], a[248:251], a[104:107], v[64:79]
    ds_read_b64_tr_b16 a[236:237], v243 offset:4096
    ds_read_b64_tr_b16 a[238:239], v243 offset:4608
    s_add_u32 m0, s70, 0x5000
    s_add_u32 s75, s9, 0x7000
    buffer_load_dwordx4 v225, s[28:31], s75 offen lds
    v_mfma_f32_32x32x16_bf16 v[80:95], a[248:251], a[108:111], v[80:95]
    s_waitcnt lgkmcnt(10)
    v_mfma_f32_32x32x16_bf16 v[96:111], a[252:255], a[104:107], v[96:111]
    s_add_u32 m0, s70, 0x5400
    s_add_u32 s75, s9, 0x7000
    buffer_load_dwordx4 v226, s[28:31], s75 offen lds
    v_mfma_f32_32x32x16_bf16 v[112:127], a[252:255], a[108:111], v[112:127]
    s_waitcnt lgkmcnt(7)
    v_mfma_f32_32x32x16_bf16 v[0:15], a[224:227], a[112:115], v[0:15]
    ds_read_b128 a[120:123], v235 offset:0
    ds_read_b64_tr_b16 a[240:241], v236 offset:6144
    s_waitcnt lgkmcnt(8)
    v_mfma_f32_32x32x16_bf16 v[16:31], a[224:227], a[116:119], v[16:31]
    ds_read_b64_tr_b16 a[242:243], v236 offset:6656
    ds_read_b128 a[124:127], v235 offset:4096
    s_add_u32 m0, s71, 0x8c00
    s_mul_i32 s75, s9, 0x700
    s_add_u32 s75, s75, 0x15000
    buffer_load_dwordx4 v227, s[36:39], s75 offen lds
    s_waitcnt lgkmcnt(8)
    v_mfma_f32_32x32x16_bf16 v[32:47], a[228:231], a[112:115], v[32:47]
    ds_read_b64_tr_b16 a[244:245], v237 offset:6144
    ds_read_b64_tr_b16 a[246:247], v237 offset:6656
    v_mfma_f32_32x32x16_bf16 v[48:63], a[228:231], a[116:119], v[48:63]
    ds_read_b64_tr_b16 a[248:249], v238 offset:6144
    ds_read_b64_tr_b16 a[250:251], v238 offset:6656
    s_waitcnt lgkmcnt(10)
    v_mfma_f32_32x32x16_bf16 v[64:79], a[232:235], a[112:115], v[64:79]
    ds_read_b64_tr_b16 a[252:253], v243 offset:6144
    ds_read_b64_tr_b16 a[254:255], v243 offset:6656
    s_add_u32 m0, s70, 0x5800
    s_add_u32 s75, s9, 0xa800
    buffer_load_dwordx4 v225, s[28:31], s75 offen lds
    v_mfma_f32_32x32x16_bf16 v[80:95], a[232:235], a[116:119], v[80:95]
    s_waitcnt lgkmcnt(10)
    v_mfma_f32_32x32x16_bf16 v[96:111], a[236:239], a[112:115], v[96:111]
    s_add_u32 m0, s70, 0x5c00
    s_add_u32 s75, s9, 0xa800
    buffer_load_dwordx4 v226, s[28:31], s75 offen lds
    v_mfma_f32_32x32x16_bf16 v[112:127], a[236:239], a[116:119], v[112:127]
    s_waitcnt lgkmcnt(7)
    v_mfma_f32_32x32x16_bf16 v[0:15], a[240:243], a[120:123], v[0:15]
    s_waitcnt lgkmcnt(6)
    v_mfma_f32_32x32x16_bf16 v[16:31], a[240:243], a[124:127], v[16:31]
    s_waitcnt lgkmcnt(0)
    s_waitcnt vmcnt(12)
    s_barrier
    ds_read_b128 a[128:131], v232 offset:8192
    ds_read_b64_tr_b16 a[224:225], v236 offset:16384
    v_mfma_f32_32x32x16_bf16 v[32:47], a[244:247], a[120:123], v[32:47]
    ds_read_b64_tr_b16 a[226:227], v236 offset:16896
    ds_read_b128 a[132:135], v232 offset:12288
    s_add_u32 m0, s71, 0
    s_mul_i32 s75, s10, 0x700
    buffer_load_dwordx4 v227, s[36:39], s75 offen lds
    v_mfma_f32_32x32x16_bf16 v[48:63], a[244:247], a[124:127], v[48:63]
    ds_read_b64_tr_b16 a[228:229], v237 offset:16384
    ds_read_b64_tr_b16 a[230:231], v237 offset:16896
    v_mfma_f32_32x32x16_bf16 v[64:79], a[248:251], a[120:123], v[64:79]
    ds_read_b64_tr_b16 a[232:233], v238 offset:16384
    ds_read_b64_tr_b16 a[234:235], v238 offset:16896
    s_add_u32 m0, s70, 0
    s_nop 0
    buffer_load_dwordx4 v225, s[28:31], s10 offen lds
    v_mfma_f32_32x32x16_bf16 v[80:95], a[248:251], a[124:127], v[80:95]
    ds_read_b64_tr_b16 a[236:237], v243 offset:16384
    ds_read_b64_tr_b16 a[238:239], v243 offset:16896
    v_mfma_f32_32x32x16_bf16 v[96:111], a[252:255], a[120:123], v[96:111]
    s_add_u32 m0, s70, 0x400
    s_nop 0
    buffer_load_dwordx4 v226, s[28:31], s10 offen lds
    v_mfma_f32_32x32x16_bf16 v[112:127], a[252:255], a[124:127], v[112:127]
    s_waitcnt lgkmcnt(7)
    v_mfma_f32_32x32x16_bf16 v[0:15], a[224:227], a[128:131], v[0:15]
    ds_read_b128 a[136:139], v233 offset:8192
    ds_read_b64_tr_b16 a[240:241], v236 offset:18432
    s_waitcnt lgkmcnt(8)
    v_mfma_f32_32x32x16_bf16 v[16:31], a[224:227], a[132:135], v[16:31]
    ds_read_b64_tr_b16 a[242:243], v236 offset:18944
    ds_read_b128 a[140:143], v233 offset:12288
    s_add_u32 m0, s71, 0x400
    s_mul_i32 s75, s10, 0x700
    s_add_u32 s75, s75, 0x7000
    buffer_load_dwordx4 v227, s[36:39], s75 offen lds
    s_waitcnt lgkmcnt(8)
    v_mfma_f32_32x32x16_bf16 v[32:47], a[228:231], a[128:131], v[32:47]
    ds_read_b64_tr_b16 a[244:245], v237 offset:18432
    ds_read_b64_tr_b16 a[246:247], v237 offset:18944
    v_mfma_f32_32x32x16_bf16 v[48:63], a[228:231], a[132:135], v[48:63]
    ds_read_b64_tr_b16 a[248:249], v238 offset:18432
    ds_read_b64_tr_b16 a[250:251], v238 offset:18944
    s_waitcnt lgkmcnt(10)
    v_mfma_f32_32x32x16_bf16 v[64:79], a[232:235], a[128:131], v[64:79]
    ds_read_b64_tr_b16 a[252:253], v243 offset:18432
    ds_read_b64_tr_b16 a[254:255], v243 offset:18944
    s_add_u32 m0, s70, 0x800
    s_add_u32 s75, s10, 0x3800
    buffer_load_dwordx4 v225, s[28:31], s75 offen lds
    v_mfma_f32_32x32x16_bf16 v[80:95], a[232:235], a[132:135], v[80:95]
    s_waitcnt lgkmcnt(10)
    v_mfma_f32_32x32x16_bf16 v[96:111], a[236:239], a[128:131], v[96:111]
    s_add_u32 m0, s70, 0xc00
    s_add_u32 s75, s10, 0x3800
    buffer_load_dwordx4 v226, s[28:31], s75 offen lds
    v_mfma_f32_32x32x16_bf16 v[112:127], a[236:239], a[132:135], v[112:127]
    s_waitcnt lgkmcnt(7)
    v_mfma_f32_32x32x16_bf16 v[0:15], a[240:243], a[136:139], v[0:15]
    ds_read_b128 a[144:147], v234 offset:8192
    ds_read_b64_tr_b16 a[224:225], v236 offset:20480
    s_waitcnt lgkmcnt(8)
    v_mfma_f32_32x32x16_bf16 v[16:31], a[240:243], a[140:143], v[16:31]
    ds_read_b64_tr_b16 a[226:227], v236 offset:20992
    ds_read_b128 a[148:151], v234 offset:12288
    s_add_u32 m0, s71, 0x800
    s_mul_i32 s75, s10, 0x700
    s_add_u32 s75, s75, 0xe000
    buffer_load_dwordx4 v227, s[36:39], s75 offen lds
    s_waitcnt lgkmcnt(8)
    v_mfma_f32_32x32x16_bf16 v[32:47], a[244:247], a[136:139], v[32:47]
    ds_read_b64_tr_b16 a[228:229], v237 offset:20480
    ds_read_b64_tr_b16 a[230:231], v237 offset:20992
    v_mfma_f32_32x32x16_bf16 v[48:63], a[244:247], a[140:143], v[48:63]
    ds_read_b64_tr_b16 a[232:233], v238 offset:20480
    ds_read_b64_tr_b16 a[234:235], v238 offset:20992
    s_waitcnt lgkmcnt(10)
    v_mfma_f32_32x32x16_bf16 v[64:79], a[248:251], a[136:139], v[64:79]
    ds_read_b64_tr_b16 a[236:237], v243 offset:20480
    ds_read_b64_tr_b16 a[238:239], v243 offset:20992
    s_add_u32 m0, s70, 0x1000
    s_add_u32 s75, s10, 0x7000
    buffer_load_dwordx4 v225, s[28:31], s75 offen lds
    v_mfma_f32_32x32x16_bf16 v[80:95], a[248:251], a[140:143], v[80:95]
    s_waitcnt lgkmcnt(10)
    v_mfma_f32_32x32x16_bf16 v[96:111], a[252:255], a[136:139], v[96:111]
    s_add_u32 m0, s70, 0x1400
    s_add_u32 s75, s10, 0x7000
    buffer_load_dwordx4 v226, s[28:31], s75 offen lds
    v_mfma_f32_32x32x16_bf16 v[112:127], a[252:255], a[140:143], v[112:127]
    s_waitcnt lgkmcnt(7)
    v_mfma_f32_32x32x16_bf16 v[0:15], a[224:227], a[144:147], v[0:15]
    ds_read_b128 a[152:155], v235 offset:8192
    ds_read_b64_tr_b16 a[240:241], v236 offset:22528
    s_waitcnt lgkmcnt(8)
    v_mfma_f32_32x32x16_bf16 v[16:31], a[224:227], a[148:151], v[16:31]
    ds_read_b64_tr_b16 a[242:243], v236 offset:23040
    ds_read_b128 a[156:159], v235 offset:12288
    s_add_u32 m0, s71, 0xc00
    s_mul_i32 s75, s10, 0x700
    s_add_u32 s75, s75, 0x15000
    buffer_load_dwordx4 v227, s[36:39], s75 offen lds
    s_waitcnt lgkmcnt(8)
    v_mfma_f32_32x32x16_bf16 v[32:47], a[228:231], a[144:147], v[32:47]
    ds_read_b64_tr_b16 a[244:245], v237 offset:22528
    ds_read_b64_tr_b16 a[246:247], v237 offset:23040
    v_mfma_f32_32x32x16_bf16 v[48:63], a[228:231], a[148:151], v[48:63]
    ds_read_b64_tr_b16 a[248:249], v238 offset:22528
    ds_read_b64_tr_b16 a[250:251], v238 offset:23040
    s_waitcnt lgkmcnt(10)
    v_mfma_f32_32x32x16_bf16 v[64:79], a[232:235], a[144:147], v[64:79]
    ds_read_b64_tr_b16 a[252:253], v243 offset:22528
    ds_read_b64_tr_b16 a[254:255], v243 offset:23040
    s_add_u32 m0, s70, 0x1800
    s_add_u32 s75, s10, 0xa800
    buffer_load_dwordx4 v225, s[28:31], s75 offen lds
    v_mfma_f32_32x32x16_bf16 v[80:95], a[232:235], a[148:151], v[80:95]
    s_waitcnt lgkmcnt(10)
    v_mfma_f32_32x32x16_bf16 v[96:111], a[236:239], a[144:147], v[96:111]
    s_add_u32 m0, s70, 0x1c00
    s_add_u32 s75, s10, 0xa800
    buffer_load_dwordx4 v226, s[28:31], s75 offen lds
    v_mfma_f32_32x32x16_bf16 v[112:127], a[236:239], a[148:151], v[112:127]
    s_waitcnt lgkmcnt(7)
    v_mfma_f32_32x32x16_bf16 v[0:15], a[240:243], a[152:155], v[0:15]
    s_waitcnt lgkmcnt(6)
    v_mfma_f32_32x32x16_bf16 v[16:31], a[240:243], a[156:159], v[16:31]
    s_waitcnt lgkmcnt(0)
    s_waitcnt vmcnt(12)
    s_barrier
    ds_read_b128 a[160:163], v232 offset:16384
    ds_read_b64_tr_b16 a[224:225], v236 offset:32768
    v_mfma_f32_32x32x16_bf16 v[32:47], a[244:247], a[152:155], v[32:47]
    ds_read_b64_tr_b16 a[226:227], v236 offset:33280
    ds_read_b128 a[164:167], v232 offset:20480
    s_add_u32 m0, s72, 0x2000
    s_mul_i32 s75, s4, 0x700
    buffer_load_dwordx4 v230, s[36:39], s75 offen lds
    v_mfma_f32_32x32x16_bf16 v[48:63], a[244:247], a[156:159], v[48:63]
    ds_read_b64_tr_b16 a[228:229], v237 offset:32768
    ds_read_b64_tr_b16 a[230:231], v237 offset:33280
    v_mfma_f32_32x32x16_bf16 v[64:79], a[248:251], a[152:155], v[64:79]
    ds_read_b64_tr_b16 a[232:233], v238 offset:32768
    ds_read_b64_tr_b16 a[234:235], v238 offset:33280
    v_mfma_f32_32x32x16_bf16 v[80:95], a[248:251], a[156:159], v[80:95]
    ds_read_b64_tr_b16 a[236:237], v243 offset:32768
    ds_read_b64_tr_b16 a[238:239], v243 offset:33280
    v_mfma_f32_32x32x16_bf16 v[96:111], a[252:255], a[152:155], v[96:111]
    s_add_u32 m0, s72, 0x2400
    s_mul_i32 s75, s4, 0x700
    s_add_u32 s75, s75, 0xe000
    buffer_load_dwordx4 v230, s[36:39], s75 offen lds
    v_mfma_f32_32x32x16_bf16 v[112:127], a[252:255], a[156:159], v[112:127]
    s_waitcnt lgkmcnt(7)
    v_mfma_f32_32x32x16_bf16 v[0:15], a[224:227], a[160:163], v[0:15]
    ds_read_b128 a[168:171], v233 offset:16384
    ds_read_b64_tr_b16 a[240:241], v236 offset:34816
    s_waitcnt lgkmcnt(8)
    v_mfma_f32_32x32x16_bf16 v[16:31], a[224:227], a[164:167], v[16:31]
    ds_read_b64_tr_b16 a[242:243], v236 offset:35328
    ds_read_b128 a[172:175], v233 offset:20480
    s_waitcnt lgkmcnt(8)
    v_mfma_f32_32x32x16_bf16 v[32:47], a[228:231], a[160:163], v[32:47]
    ds_read_b64_tr_b16 a[244:245], v237 offset:34816
    ds_read_b64_tr_b16 a[246:247], v237 offset:35328
    s_add_u32 m0, s72, 0x8000
    s_mul_i32 s75, s5, 0x700
    buffer_load_dwordx4 v230, s[36:39], s75 offen lds
    v_mfma_f32_32x32x16_bf16 v[48:63], a[228:231], a[164:167], v[48:63]
    ds_read_b64_tr_b16 a[248:249], v238 offset:34816
    ds_read_b64_tr_b16 a[250:251], v238 offset:35328
    s_waitcnt lgkmcnt(10)
    v_mfma_f32_32x32x16_bf16 v[64:79], a[232:235], a[160:163], v[64:79]
    ds_read_b64_tr_b16 a[252:253], v243 offset:34816
    ds_read_b64_tr_b16 a[254:255], v243 offset:35328
    v_mfma_f32_32x32x16_bf16 v[80:95], a[232:235], a[164:167], v[80:95]
    s_waitcnt lgkmcnt(10)
    v_mfma_f32_32x32x16_bf16 v[96:111], a[236:239], a[160:163], v[96:111]
    s_add_u32 m0, s72, 0x8400
    s_mul_i32 s75, s5, 0x700
    s_add_u32 s75, s75, 0xe000
    buffer_load_dwordx4 v230, s[36:39], s75 offen lds
    v_mfma_f32_32x32x16_bf16 v[112:127], a[236:239], a[164:167], v[112:127]
    s_waitcnt lgkmcnt(7)
    v_mfma_f32_32x32x16_bf16 v[0:15], a[240:243], a[168:171], v[0:15]
    ds_read_b128 a[176:179], v234 offset:16384
    ds_read_b64_tr_b16 a[224:225], v236 offset:36864
    s_waitcnt lgkmcnt(8)
    v_mfma_f32_32x32x16_bf16 v[16:31], a[240:243], a[172:175], v[16:31]
    ds_read_b64_tr_b16 a[226:227], v236 offset:37376
    ds_read_b128 a[180:183], v234 offset:20480
    s_waitcnt lgkmcnt(8)
    v_mfma_f32_32x32x16_bf16 v[32:47], a[244:247], a[168:171], v[32:47]
    ds_read_b64_tr_b16 a[228:229], v237 offset:36864
    ds_read_b64_tr_b16 a[230:231], v237 offset:37376
    s_add_u32 m0, s72, 0xe000
    s_mul_i32 s75, s6, 0x700
    buffer_load_dwordx4 v230, s[36:39], s75 offen lds
    v_mfma_f32_32x32x16_bf16 v[48:63], a[244:247], a[172:175], v[48:63]
    ds_read_b64_tr_b16 a[232:233], v238 offset:36864
    ds_read_b64_tr_b16 a[234:235], v238 offset:37376
    s_waitcnt lgkmcnt(10)
    v_mfma_f32_32x32x16_bf16 v[64:79], a[248:251], a[168:171], v[64:79]
    ds_read_b64_tr_b16 a[236:237], v243 offset:36864
    ds_read_b64_tr_b16 a[238:239], v243 offset:37376
    v_mfma_f32_32x32x16_bf16 v[80:95], a[248:251], a[172:175], v[80:95]
    s_waitcnt lgkmcnt(10)
    v_mfma_f32_32x32x16_bf16 v[96:111], a[252:255], a[168:171], v[96:111]
    s_add_u32 m0, s72, 0xe400
    s_mul_i32 s75, s6, 0x700
    s_add_u32 s75, s75, 0xe000
    buffer_load_dwordx4 v230, s[36:39], s75 offen lds
    v_mfma_f32_32x32x16_bf16 v[112:127], a[252:255], a[172:175], v[112:127]
    s_waitcnt lgkmcnt(7)
    v_mfma_f32_32x32x16_bf16 v[0:15], a[224:227], a[176:179], v[0:15]
    ds_read_b128 a[184:187], v235 offset:16384
    ds_read_b64_tr_b16 a[240:241], v236 offset:38912
    s_waitcnt lgkmcnt(8)
    v_mfma_f32_32x32x16_bf16 v[16:31], a[224:227], a[180:183], v[16:31]
    ds_read_b64_tr_b16 a[242:243], v236 offset:39424
    ds_read_b128 a[188:191], v235 offset:20480
    s_waitcnt lgkmcnt(8)
    v_mfma_f32_32x32x16_bf16 v[32:47], a[228:231], a[176:179], v[32:47]
    ds_read_b64_tr_b16 a[244:245], v237 offset:38912
    ds_read_b64_tr_b16 a[246:247], v237 offset:39424
    s_add_u32 m0, s72, 0x14000
    s_mul_i32 s75, s7, 0x700
    buffer_load_dwordx4 v230, s[36:39], s75 offen lds
    v_mfma_f32_32x32x16_bf16 v[48:63], a[228:231], a[180:183], v[48:63]
    ds_read_b64_tr_b16 a[248:249], v238 offset:38912
    ds_read_b64_tr_b16 a[250:251], v238 offset:39424
    s_waitcnt lgkmcnt(10)
    v_mfma_f32_32x32x16_bf16 v[64:79], a[232:235], a[176:179], v[64:79]
    ds_read_b64_tr_b16 a[252:253], v243 offset:38912
    ds_read_b64_tr_b16 a[254:255], v243 offset:39424
    v_mfma_f32_32x32x16_bf16 v[80:95], a[232:235], a[180:183], v[80:95]
    s_waitcnt lgkmcnt(10)
    v_mfma_f32_32x32x16_bf16 v[96:111], a[236:239], a[176:179], v[96:111]
    s_add_u32 m0, s72, 0x14400
    s_mul_i32 s75, s7, 0x700
    s_add_u32 s75, s75, 0xe000
    buffer_load_dwordx4 v230, s[36:39], s75 offen lds
    v_mfma_f32_32x32x16_bf16 v[112:127], a[236:239], a[180:183], v[112:127]
    s_waitcnt lgkmcnt(7)
    v_mfma_f32_32x32x16_bf16 v[0:15], a[240:243], a[184:187], v[0:15]
    s_waitcnt lgkmcnt(6)
    v_mfma_f32_32x32x16_bf16 v[16:31], a[240:243], a[188:191], v[16:31]
    s_waitcnt lgkmcnt(0)
    s_waitcnt vmcnt(8)
    s_barrier
    ds_read_b128 a[192:195], v232 offset:0
    ds_read_b64_tr_b16 a[224:225], v236 offset:0
    v_mfma_f32_32x32x16_bf16 v[32:47], a[244:247], a[184:187], v[32:47]
    ds_read_b64_tr_b16 a[226:227], v236 offset:512
    ds_read_b128 a[196:199], v232 offset:4096
    s_add_u32 m0, s72, 0x4000
    s_mul_i32 s75, s8, 0x700
    buffer_load_dwordx4 v230, s[36:39], s75 offen lds
    v_mfma_f32_32x32x16_bf16 v[48:63], a[244:247], a[188:191], v[48:63]
    ds_read_b64_tr_b16 a[228:229], v237 offset:0
    ds_read_b64_tr_b16 a[230:231], v237 offset:512
    v_mfma_f32_32x32x16_bf16 v[64:79], a[248:251], a[184:187], v[64:79]
    ds_read_b64_tr_b16 a[232:233], v238 offset:0
    ds_read_b64_tr_b16 a[234:235], v238 offset:512
    v_mfma_f32_32x32x16_bf16 v[80:95], a[248:251], a[188:191], v[80:95]
    ds_read_b64_tr_b16 a[236:237], v243 offset:0
    ds_read_b64_tr_b16 a[238:239], v243 offset:512
    v_mfma_f32_32x32x16_bf16 v[96:111], a[252:255], a[184:187], v[96:111]
    s_add_u32 m0, s72, 0x4400
    s_mul_i32 s75, s8, 0x700
    s_add_u32 s75, s75, 0xe000
    buffer_load_dwordx4 v230, s[36:39], s75 offen lds
    v_mfma_f32_32x32x16_bf16 v[112:127], a[252:255], a[188:191], v[112:127]
    s_waitcnt lgkmcnt(7)
    v_mfma_f32_32x32x16_bf16 v[0:15], a[224:227], a[192:195], v[0:15]
    ds_read_b128 a[200:203], v233 offset:0
    ds_read_b64_tr_b16 a[240:241], v236 offset:2048
    s_waitcnt lgkmcnt(8)
    v_mfma_f32_32x32x16_bf16 v[16:31], a[224:227], a[196:199], v[16:31]
    ds_read_b64_tr_b16 a[242:243], v236 offset:2560
    ds_read_b128 a[204:207], v233 offset:4096
    s_waitcnt lgkmcnt(8)
    v_mfma_f32_32x32x16_bf16 v[32:47], a[228:231], a[192:195], v[32:47]
    ds_read_b64_tr_b16 a[244:245], v237 offset:2048
    ds_read_b64_tr_b16 a[246:247], v237 offset:2560
    s_add_u32 m0, s72, 0xa000
    s_mul_i32 s75, s9, 0x700
    buffer_load_dwordx4 v230, s[36:39], s75 offen lds
    v_mfma_f32_32x32x16_bf16 v[48:63], a[228:231], a[196:199], v[48:63]
    ds_read_b64_tr_b16 a[248:249], v238 offset:2048
    ds_read_b64_tr_b16 a[250:251], v238 offset:2560
    s_waitcnt lgkmcnt(10)
    v_mfma_f32_32x32x16_bf16 v[64:79], a[232:235], a[192:195], v[64:79]
    ds_read_b64_tr_b16 a[252:253], v243 offset:2048
    ds_read_b64_tr_b16 a[254:255], v243 offset:2560
    v_mfma_f32_32x32x16_bf16 v[80:95], a[232:235], a[196:199], v[80:95]
    s_waitcnt lgkmcnt(10)
    v_mfma_f32_32x32x16_bf16 v[96:111], a[236:239], a[192:195], v[96:111]
    s_add_u32 m0, s72, 0xa400
    s_mul_i32 s75, s9, 0x700
    s_add_u32 s75, s75, 0xe000
    buffer_load_dwordx4 v230, s[36:39], s75 offen lds
    v_mfma_f32_32x32x16_bf16 v[112:127], a[236:239], a[196:199], v[112:127]
    s_waitcnt lgkmcnt(7)
    v_mfma_f32_32x32x16_bf16 v[0:15], a[240:243], a[200:203], v[0:15]
    ds_read_b128 a[208:211], v234 offset:0
    ds_read_b64_tr_b16 a[224:225], v236 offset:4096
    s_waitcnt lgkmcnt(8)
    v_mfma_f32_32x32x16_bf16 v[16:31], a[240:243], a[204:207], v[16:31]
    ds_read_b64_tr_b16 a[226:227], v236 offset:4608
    ds_read_b128 a[212:215], v234 offset:4096
    s_waitcnt lgkmcnt(8)
    v_mfma_f32_32x32x16_bf16 v[32:47], a[244:247], a[200:203], v[32:47]
    ds_read_b64_tr_b16 a[228:229], v237 offset:4096
    ds_read_b64_tr_b16 a[230:231], v237 offset:4608
    v_mfma_f32_32x32x16_bf16 v[48:63], a[244:247], a[204:207], v[48:63]
    ds_read_b64_tr_b16 a[232:233], v238 offset:4096
    ds_read_b64_tr_b16 a[234:235], v238 offset:4608
    s_waitcnt lgkmcnt(10)
    v_mfma_f32_32x32x16_bf16 v[64:79], a[248:251], a[200:203], v[64:79]
    ds_read_b64_tr_b16 a[236:237], v243 offset:4096
    ds_read_b64_tr_b16 a[238:239], v243 offset:4608
    s_add_u32 m0, s72, 0x10000
    s_mul_i32 s75, s10, 0x700
    buffer_load_dwordx4 v230, s[36:39], s75 offen lds
    v_mfma_f32_32x32x16_bf16 v[80:95], a[248:251], a[204:207], v[80:95]
    s_waitcnt lgkmcnt(10)
    v_mfma_f32_32x32x16_bf16 v[96:111], a[252:255], a[200:203], v[96:111]
    v_mfma_f32_32x32x16_bf16 v[112:127], a[252:255], a[204:207], v[112:127]
    s_waitcnt lgkmcnt(7)
    v_mfma_f32_32x32x16_bf16 v[0:15], a[224:227], a[208:211], v[0:15]
    ds_read_b128 a[216:219], v235 offset:0
    ds_read_b64_tr_b16 a[240:241], v236 offset:6144
    s_waitcnt lgkmcnt(8)
    v_mfma_f32_32x32x16_bf16 v[16:31], a[224:227], a[212:215], v[16:31]
    ds_read_b64_tr_b16 a[242:243], v236 offset:6656
    ds_read_b128 a[220:223], v235 offset:4096
    s_waitcnt lgkmcnt(8)
    v_mfma_f32_32x32x16_bf16 v[32:47], a[228:231], a[208:211], v[32:47]
    ds_read_b64_tr_b16 a[244:245], v237 offset:6144
    ds_read_b64_tr_b16 a[246:247], v237 offset:6656
    v_mfma_f32_32x32x16_bf16 v[48:63], a[228:231], a[212:215], v[48:63]
    ds_read_b64_tr_b16 a[248:249], v238 offset:6144
    ds_read_b64_tr_b16 a[250:251], v238 offset:6656
    s_waitcnt lgkmcnt(10)
    v_mfma_f32_32x32x16_bf16 v[64:79], a[232:235], a[208:211], v[64:79]
    ds_read_b64_tr_b16 a[252:253], v243 offset:6144
    ds_read_b64_tr_b16 a[254:255], v243 offset:6656
    s_add_u32 m0, s72, 0x10400
    s_mul_i32 s75, s10, 0x700
    s_add_u32 s75, s75, 0xe000
    buffer_load_dwordx4 v230, s[36:39], s75 offen lds
    v_mfma_f32_32x32x16_bf16 v[80:95], a[232:235], a[212:215], v[80:95]
    s_waitcnt lgkmcnt(10)
    v_mfma_f32_32x32x16_bf16 v[96:111], a[236:239], a[208:211], v[96:111]
    v_mfma_f32_32x32x16_bf16 v[112:127], a[236:239], a[212:215], v[112:127]
    s_waitcnt lgkmcnt(7)
    v_mfma_f32_32x32x16_bf16 v[0:15], a[240:243], a[216:219], v[0:15]
    s_waitcnt lgkmcnt(6)
    v_mfma_f32_32x32x16_bf16 v[16:31], a[240:243], a[220:223], v[16:31]
    s_waitcnt lgkmcnt(0)
    s_waitcnt vmcnt(6)
    s_barrier
    ds_read_b64_tr_b16 a[224:225], v239 offset:8192
    ds_read_b64_tr_b16 a[226:227], v239 offset:8448
    v_mfma_f32_32x32x16_bf16 v[32:47], a[244:247], a[216:219], v[32:47]
    v_mfma_f32_32x32x16_bf16 v[48:63], a[244:247], a[220:223], v[48:63]
    v_mfma_f32_32x32x16_bf16 v[64:79], a[248:251], a[216:219], v[64:79]
    v_mfma_f32_32x32x16_bf16 v[80:95], a[248:251], a[220:223], v[80:95]
    v_mfma_f32_32x32x16_bf16 v[96:111], a[252:255], a[216:219], v[96:111]
    v_mfma_f32_32x32x16_bf16 v[112:127], a[252:255], a[220:223], v[112:127]
    s_waitcnt lgkmcnt(0)
    v_mfma_f32_32x32x16_bf16 v[128:143], a[224:227], a[0:3], 0
    ds_read_b64_tr_b16 a[228:229], v239 offset:9216
    ds_read_b64_tr_b16 a[230:231], v239 offset:9472
    v_lshrrev_b32 v243, 5, v247
    v_bfe_u32 v213, v247, 2, 2
    v_bfe_u32 v214, v247, 4, 1
    v_and_b32 v255, 3, v247
    v_lshl_add_u32 v214, v214, 2, v255
    v_and_b32 v255, 1, v214
    v_lshrrev_b32 v215, 1, v214
    v_lshl_add_u32 v215, v255, 2, v215
    v_lshl_add_u32 v255, v243, 2, v213
    v_lshlrev_b32 v255, 7, v255
    v_lshl_add_u32 v255, v215, 3, v255
    v_lshrrev_b32 v212, 1, v213
    v_lshl_add_u32 v214, v212, 6, v255
    v_xor_b32 v212, 1, v212
    v_lshl_add_u32 v215, v212, 6, v255
    v_add_u32 v232, s70, v214
    v_mfma_f32_32x32x16_bf16 v[144:159], a[224:227], a[4:7], 0
    v_add_u32 v233, s70, v215
    v_add_u32 v234, s26, v214
    v_add_u32 v235, s26, v215
    v_add_u32 v236, s3, v214
    v_add_u32 v237, s3, v215
    s_lshl_b32 s82, s61, 2
    s_add_u32 s82, s82, s62
    s_mul_i32 s65, s82, 0x90
    s_mul_i32 s66, s60, 36
    s_add_u32 s65, s65, s66
    s_lshl_b32 s65, s65, 11
    v_add_u32 v225, s65, v224
    s_mov_b32 s68, s65
    v_min_u32 v255, 36, v247
    s_mul_i32 s66, s85, 37
    v_add_u32 v255, s66, v255
    v_min_u32 v255, 0xff, v255
    v_lshlrev_b32 v255, 7, v255
    s_waitcnt lgkmcnt(0)
    v_mfma_f32_32x32x16_bf16 v[128:143], a[228:231], a[8:11], v[128:143]
    ds_read_b64_tr_b16 a[224:225], v239 offset:10240
    ds_read_b64_tr_b16 a[226:227], v239 offset:10496
    s_add_u32 s66, s68, 0
    v_add_u32 v194, s66, v255
    v_min_u32 v255, 18, v247
    s_mul_i32 s66, s85, 19
    v_add_u32 v255, s66, v255
    v_min_u32 v255, 0x7f, v255
    v_lshlrev_b32 v255, 7, v255
    s_add_u32 s66, s68, 0x8000
    v_add_u32 v195, s66, v255
    v_min_u32 v255, 27, v247
    s_mul_i32 s66, s85, 28
    v_add_u32 v255, s66, v255
    v_min_u32 v255, 0xbf, v255
    v_lshlrev_b32 v255, 7, v255
    s_add_u32 s66, s68, 0xc000
    v_add_u32 v196, s66, v255
    v_mfma_f32_32x32x16_bf16 v[144:159], a[228:231], a[12:15], v[144:159]
    v_add_u32 v226, s3, v224
    v_add_u32 v227, 0x18000, v224
    v_and_b32 v255, 31, v247
    s_lshl_b32 s65, s82, 2
    s_add_u32 s65, s65, s60
    s_lshl_b32 s65, s65, 11
    s_add_u32 s65, s65, 0xc00080
    v_lshl_add_u32 v238, v255, 2, s65
    s_lshl_b32 s65, s82, 6
    s_lshr_b32 s66, s60, 1
    s_lshl_b32 s66, s66, 5
    s_add_u32 s65, s65, s66
    v_add_u32 v255, s65, v255
    v_mul_u32_u24 v255, 0x380, v255
    v_lshl_add_u32 v255, v243, 5, v255
    s_waitcnt lgkmcnt(0)
    v_mfma_f32_32x32x16_bf16 v[128:143], a[224:227], a[16:19], v[128:143]
    ds_read_b64_tr_b16 a[228:229], v239 offset:11264
    ds_read_b64_tr_b16 a[230:231], v239 offset:11520
    s_lshl_b32 s65, s85, 7
    s_and_b32 s66, s60, 1
    s_lshl_b32 s66, s66, 6
    s_add_u32 s65, s65, s66
    v_add_u32 v228, s65, v255
    s_mov_b32 s84, 0
    v_mul_f32 v64, 0xbfb8aa3b, v64
    v_mul_f32 v65, 0xbfb8aa3b, v65
    v_mul_f32 v66, 0xbfb8aa3b, v66
    v_mul_f32 v67, 0xbfb8aa3b, v67
    v_mul_f32 v68, 0xbfb8aa3b, v68
    v_mul_f32 v69, 0xbfb8aa3b, v69
    v_mul_f32 v70, 0xbfb8aa3b, v70
    v_mul_f32 v71, 0xbfb8aa3b, v71
    v_exp_f32 v64, v64
    v_mfma_f32_32x32x16_bf16 v[144:159], a[224:227], a[20:23], v[144:159]
    v_exp_f32 v65, v65
    v_exp_f32 v66, v66
    v_exp_f32 v67, v67
    v_exp_f32 v68, v68
    v_exp_f32 v69, v69
    v_exp_f32 v70, v70
    v_exp_f32 v71, v71
    v_add_f32 v64, 1.0, v64
    v_add_f32 v65, 1.0, v65
    v_add_f32 v66, 1.0, v66
    v_add_f32 v67, 1.0, v67
    s_waitcnt lgkmcnt(0)
    v_mfma_f32_32x32x16_bf16 v[128:143], a[228:231], a[24:27], v[128:143]
    ds_read_b64_tr_b16 a[224:225], v239 offset:32768
    ds_read_b64_tr_b16 a[226:227], v239 offset:33024
    v_add_f32 v68, 1.0, v68
    v_add_f32 v69, 1.0, v69
    v_add_f32 v70, 1.0, v70
    v_add_f32 v71, 1.0, v71
    v_rcp_f32 v64, v64
    v_rcp_f32 v65, v65
    v_rcp_f32 v66, v66
    v_rcp_f32 v67, v67
    v_rcp_f32 v68, v68
    v_rcp_f32 v69, v69
    v_mfma_f32_32x32x16_bf16 v[144:159], a[228:231], a[28:31], v[144:159]
    v_rcp_f32 v70, v70
    v_rcp_f32 v71, v71
    v_mul_f32 v64, v64, v72
    v_mul_f32 v65, v65, v73
    v_mul_f32 v66, v66, v74
    v_mul_f32 v67, v67, v75
    v_mul_f32 v68, v68, v76
    v_mul_f32 v69, v69, v77
    v_mul_f32 v70, v70, v78
    v_mul_f32 v71, v71, v79
    v_cvt_pk_bf16_f32 v72, v64, v65
    v_cvt_pk_bf16_f32 v73, v66, v67
    v_cvt_pk_bf16_f32 v74, v68, v69
    v_cvt_pk_bf16_f32 v75, v70, v71
    s_mov_b32 s76, 0x1000
    buffer_store_dwordx4 v[72:75], v246, s[52:55], s76 offen offset:0 sc1
    s_waitcnt lgkmcnt(0)
    v_mfma_f32_32x32x16_bf16 v[128:143], a[224:227], a[32:35], v[128:143]
    ds_read_b64_tr_b16 a[228:229], v239 offset:33792
    ds_read_b64_tr_b16 a[230:231], v239 offset:34048
    s_add_u32 m0, s26, 0
    s_nop 0
    buffer_load_dwordx4 v223, s[56:59], 0 offen lds
    v_mul_f32 v80, 0xbfb8aa3b, v80
    v_mul_f32 v81, 0xbfb8aa3b, v81
    v_mul_f32 v82, 0xbfb8aa3b, v82
    v_mul_f32 v83, 0xbfb8aa3b, v83
    v_mul_f32 v84, 0xbfb8aa3b, v84
    v_mul_f32 v85, 0xbfb8aa3b, v85
    v_mul_f32 v86, 0xbfb8aa3b, v86
    v_mul_f32 v87, 0xbfb8aa3b, v87
    v_exp_f32 v80, v80
    v_exp_f32 v81, v81
    v_exp_f32 v82, v82
    v_mfma_f32_32x32x16_bf16 v[144:159], a[224:227], a[36:39], v[144:159]
    s_add_u32 m0, s26, 0x400
    s_mov_b32 s75, 0x1c00
    buffer_load_dwordx4 v223, s[56:59], s75 offen lds
    v_exp_f32 v83, v83
    v_exp_f32 v84, v84
    v_exp_f32 v85, v85
    v_exp_f32 v86, v86
    v_exp_f32 v87, v87
    v_add_f32 v80, 1.0, v80
    v_add_f32 v81, 1.0, v81
    v_add_f32 v82, 1.0, v82
    v_add_f32 v83, 1.0, v83
    v_add_f32 v84, 1.0, v84
    s_waitcnt lgkmcnt(0)
    v_mfma_f32_32x32x16_bf16 v[128:143], a[228:231], a[40:43], v[128:143]
    ds_read_b64_tr_b16 a[224:225], v239 offset:34816
    ds_read_b64_tr_b16 a[226:227], v239 offset:35072
    s_add_u32 m0, s70, 0
    s_mov_b32 s75, 0x3800
    buffer_load_dwordx4 v223, s[56:59], s75 offen lds
    v_add_f32 v85, 1.0, v85
    v_add_f32 v86, 1.0, v86
    v_add_f32 v87, 1.0, v87
    v_rcp_f32 v80, v80
    v_rcp_f32 v81, v81
    v_rcp_f32 v82, v82
    v_rcp_f32 v83, v83
    v_rcp_f32 v84, v84
    v_mfma_f32_32x32x16_bf16 v[144:159], a[228:231], a[44:47], v[144:159]
    s_add_u32 m0, s70, 0x400
    s_mov_b32 s75, 0x5400
    buffer_load_dwordx4 v223, s[56:59], s75 offen lds
    v_rcp_f32 v85, v85
    v_rcp_f32 v86, v86
    v_rcp_f32 v87, v87
    v_mul_f32 v80, v80, v88
    v_mul_f32 v81, v81, v89
    v_mul_f32 v82, v82, v90
    v_mul_f32 v83, v83, v91
    v_mul_f32 v84, v84, v92
    v_mul_f32 v85, v85, v93
    v_mul_f32 v86, v86, v94
    v_mul_f32 v87, v87, v95
    v_cvt_pk_bf16_f32 v88, v80, v81
    s_waitcnt lgkmcnt(0)
    v_mfma_f32_32x32x16_bf16 v[128:143], a[224:227], a[48:51], v[128:143]
    ds_read_b64_tr_b16 a[228:229], v239 offset:35840
    ds_read_b64_tr_b16 a[230:231], v239 offset:36096
    s_add_u32 m0, s70, 0x800
    s_mov_b32 s75, 0x7000
    buffer_load_dwordx4 v223, s[56:59], s75 offen lds
    v_cvt_pk_bf16_f32 v89, v82, v83
    v_cvt_pk_bf16_f32 v90, v84, v85
    v_cvt_pk_bf16_f32 v91, v86, v87
    s_mov_b32 s76, 0x1000
    buffer_store_dwordx4 v[88:91], v246, s[52:55], s76 offen offset:1024 sc1
    v_mul_f32 v96, 0xbfb8aa3b, v96
    v_mul_f32 v97, 0xbfb8aa3b, v97
    v_mul_f32 v98, 0xbfb8aa3b, v98
    v_mul_f32 v99, 0xbfb8aa3b, v99
    v_mul_f32 v100, 0xbfb8aa3b, v100
    v_mul_f32 v101, 0xbfb8aa3b, v101
    v_mul_f32 v102, 0xbfb8aa3b, v102
    v_mul_f32 v103, 0xbfb8aa3b, v103
    v_mfma_f32_32x32x16_bf16 v[144:159], a[224:227], a[52:55], v[144:159]
    s_add_u32 m0, s70, 0xc00
    s_mov_b32 s75, 0x8c00
    buffer_load_dwordx4 v223, s[56:59], s75 offen lds
    v_exp_f32 v96, v96
    v_exp_f32 v97, v97
    v_exp_f32 v98, v98
    v_exp_f32 v99, v99
    v_exp_f32 v100, v100
    v_exp_f32 v101, v101
    v_exp_f32 v102, v102
    s_waitcnt lgkmcnt(0)
    v_mfma_f32_32x32x16_bf16 v[128:143], a[228:231], a[56:59], v[128:143]
    ds_read_b64_tr_b16 a[224:225], v240 offset:8192
    ds_read_b64_tr_b16 a[226:227], v240 offset:8448
    s_add_u32 m0, s70, 0x1000
    s_mov_b32 s75, 0xa800
    buffer_load_dwordx4 v223, s[56:59], s75 offen lds
    v_exp_f32 v103, v103
    v_add_f32 v96, 1.0, v96
    v_add_f32 v97, 1.0, v97
    v_add_f32 v98, 1.0, v98
    v_add_f32 v99, 1.0, v99
    v_add_f32 v100, 1.0, v100
    v_add_f32 v101, 1.0, v101
    v_add_f32 v102, 1.0, v102
    v_add_f32 v103, 1.0, v103
    v_rcp_f32 v96, v96
    v_mfma_f32_32x32x16_bf16 v[144:159], a[228:231], a[60:63], v[144:159]
    s_add_u32 m0, s70, 0x1400
    s_mov_b32 s75, 0xc400
    buffer_load_dwordx4 v223, s[56:59], s75 offen lds
    v_rcp_f32 v97, v97
    v_rcp_f32 v98, v98
    v_rcp_f32 v99, v99
    v_rcp_f32 v100, v100
    v_rcp_f32 v101, v101
    v_rcp_f32 v102, v102
    v_rcp_f32 v103, v103
    v_mul_f32 v96, v96, v104
    s_waitcnt lgkmcnt(0)
    v_mfma_f32_32x32x16_bf16 v[128:143], a[224:227], a[64:67], v[128:143]
    ds_read_b64_tr_b16 a[228:229], v240 offset:9216
    ds_read_b64_tr_b16 a[230:231], v240 offset:9472
    s_add_u32 m0, s70, 0x1800
    s_mov_b32 s75, 0xe000
    buffer_load_dwordx4 v223, s[56:59], s75 offen lds
    v_mul_f32 v97, v97, v105
    v_mul_f32 v98, v98, v106
    v_mul_f32 v99, v99, v107
    v_mul_f32 v100, v100, v108
    v_mul_f32 v101, v101, v109
    v_mul_f32 v102, v102, v110
    v_mul_f32 v103, v103, v111
    v_cvt_pk_bf16_f32 v104, v96, v97
    v_cvt_pk_bf16_f32 v105, v98, v99
    v_cvt_pk_bf16_f32 v106, v100, v101
    v_cvt_pk_bf16_f32 v107, v102, v103
    s_mov_b32 s76, 0x1000
    buffer_store_dwordx4 v[104:107], v246, s[52:55], s76 offen offset:2048 sc1
    v_mfma_f32_32x32x16_bf16 v[144:159], a[224:227], a[68:71], v[144:159]
    s_add_u32 m0, s70, 0x1c00
    s_mov_b32 s75, 0xfc00
    buffer_load_dwordx4 v223, s[56:59], s75 offen lds
    v_mul_f32 v112, 0xbfb8aa3b, v112
    v_mul_f32 v113, 0xbfb8aa3b, v113
    v_mul_f32 v114, 0xbfb8aa3b, v114
    v_mul_f32 v115, 0xbfb8aa3b, v115
    v_mul_f32 v116, 0xbfb8aa3b, v116
    v_mul_f32 v117, 0xbfb8aa3b, v117
    v_mul_f32 v118, 0xbfb8aa3b, v118
    v_mul_f32 v119, 0xbfb8aa3b, v119
    v_exp_f32 v112, v112
    v_exp_f32 v113, v113
    v_exp_f32 v114, v114
    s_waitcnt lgkmcnt(0)
    v_mfma_f32_32x32x16_bf16 v[128:143], a[228:231], a[72:75], v[128:143]
    ds_read_b64_tr_b16 a[224:225], v240 offset:10240
    ds_read_b64_tr_b16 a[226:227], v240 offset:10496
    s_add_u32 m0, s3, 0
    s_mov_b32 s75, 0x11800
    buffer_load_dwordx4 v223, s[56:59], s75 offen lds
    v_exp_f32 v115, v115
    v_exp_f32 v116, v116
    v_exp_f32 v117, v117
    v_exp_f32 v118, v118
    v_exp_f32 v119, v119
    v_add_f32 v112, 1.0, v112
    v_add_f32 v113, 1.0, v113
    v_add_f32 v114, 1.0, v114
    v_mfma_f32_32x32x16_bf16 v[144:159], a[228:231], a[76:79], v[144:159]
    s_add_u32 m0, s3, 0x400
    s_mov_b32 s75, 0x13400
    buffer_load_dwordx4 v223, s[56:59], s75 offen lds
    v_add_f32 v115, 1.0, v115
    v_add_f32 v116, 1.0, v116
    v_add_f32 v117, 1.0, v117
    v_add_f32 v118, 1.0, v118
    v_add_f32 v119, 1.0, v119
    v_rcp_f32 v112, v112
    v_rcp_f32 v113, v113
    v_rcp_f32 v114, v114
    v_rcp_f32 v115, v115
    v_rcp_f32 v116, v116
    s_waitcnt lgkmcnt(0)
    v_mfma_f32_32x32x16_bf16 v[128:143], a[224:227], a[80:83], v[128:143]
    ds_read_b64_tr_b16 a[228:229], v240 offset:11264
    ds_read_b64_tr_b16 a[230:231], v240 offset:11520
    s_add_u32 m0, s3, 0x800
    s_mov_b32 s75, 0x15000
    buffer_load_dwordx4 v223, s[56:59], s75 offen lds
    v_rcp_f32 v117, v117
    v_rcp_f32 v118, v118
    v_rcp_f32 v119, v119
    v_mul_f32 v112, v112, v120
    v_mul_f32 v113, v113, v121
    v_mul_f32 v114, v114, v122
    v_mul_f32 v115, v115, v123
    v_mul_f32 v116, v116, v124
    v_mul_f32 v117, v117, v125
    v_mul_f32 v118, v118, v126
    v_mfma_f32_32x32x16_bf16 v[144:159], a[224:227], a[84:87], v[144:159]
    s_add_u32 m0, s3, 0xc00
    s_mov_b32 s75, 0x16c00
    buffer_load_dwordx4 v223, s[56:59], s75 offen lds
    v_mul_f32 v119, v119, v127
    v_cvt_pk_bf16_f32 v120, v112, v113
    v_cvt_pk_bf16_f32 v121, v114, v115
    v_cvt_pk_bf16_f32 v122, v116, v117
    v_cvt_pk_bf16_f32 v123, v118, v119
    s_mov_b32 s76, 0x1000
    buffer_store_dwordx4 v[120:123], v246, s[52:55], s76 offen offset:3072 sc1
    v_mul_f32 v0, 0xbfb8aa3b, v0
    v_mul_f32 v1, 0xbfb8aa3b, v1
    v_mul_f32 v2, 0xbfb8aa3b, v2
    v_mul_f32 v3, 0xbfb8aa3b, v3
    v_mul_f32 v4, 0xbfb8aa3b, v4
    v_mul_f32 v5, 0xbfb8aa3b, v5
    v_mul_f32 v6, 0xbfb8aa3b, v6
    v_mul_f32 v7, 0xbfb8aa3b, v7
    s_waitcnt lgkmcnt(0)
    v_mfma_f32_32x32x16_bf16 v[128:143], a[228:231], a[88:91], v[128:143]
    ds_read_b64_tr_b16 a[224:225], v240 offset:32768
    ds_read_b64_tr_b16 a[226:227], v240 offset:33024
    s_add_u32 m0, s3, 0x1000
    s_mov_b32 s75, 0x18800
    buffer_load_dwordx4 v223, s[56:59], s75 offen lds
    v_exp_f32 v0, v0
    v_exp_f32 v1, v1
    v_exp_f32 v2, v2
    v_exp_f32 v3, v3
    v_exp_f32 v4, v4
    v_exp_f32 v5, v5
    v_mfma_f32_32x32x16_bf16 v[144:159], a[228:231], a[92:95], v[144:159]
    s_add_u32 m0, s3, 0x1400
    s_mov_b32 s75, 0x1a400
    buffer_load_dwordx4 v223, s[56:59], s75 offen lds
    v_exp_f32 v6, v6
    v_exp_f32 v7, v7
    v_add_f32 v0, 1.0, v0
    v_add_f32 v1, 1.0, v1
    v_add_f32 v2, 1.0, v2
    v_add_f32 v3, 1.0, v3
    v_add_f32 v4, 1.0, v4
    v_add_f32 v5, 1.0, v5
    v_add_f32 v6, 1.0, v6
    v_add_f32 v7, 1.0, v7
    v_rcp_f32 v0, v0
    s_waitcnt lgkmcnt(0)
    v_mfma_f32_32x32x16_bf16 v[128:143], a[224:227], a[96:99], v[128:143]
    ds_read_b64_tr_b16 a[228:229], v240 offset:33792
    ds_read_b64_tr_b16 a[230:231], v240 offset:34048
    s_add_u32 m0, s3, 0x1800
    s_mov_b32 s75, 0x1c000
    buffer_load_dwordx4 v223, s[56:59], s75 offen lds
    v_rcp_f32 v1, v1
    v_rcp_f32 v2, v2
    v_rcp_f32 v3, v3
    v_rcp_f32 v4, v4
    v_rcp_f32 v5, v5
    v_rcp_f32 v6, v6
    v_mfma_f32_32x32x16_bf16 v[144:159], a[224:227], a[100:103], v[144:159]
    s_add_u32 m0, s3, 0x1c00
    s_mov_b32 s75, 0x1dc00
    buffer_load_dwordx4 v223, s[56:59], s75 offen lds
    v_rcp_f32 v7, v7
    v_mul_f32 v0, v0, v8
    v_mul_f32 v1, v1, v9
    v_mul_f32 v2, v2, v10
    v_mul_f32 v3, v3, v11
    v_mul_f32 v4, v4, v12
    v_mul_f32 v5, v5, v13
    v_mul_f32 v6, v6, v14
    v_mul_f32 v7, v7, v15
    v_cvt_pk_bf16_f32 v8, v0, v1
    v_cvt_pk_bf16_f32 v9, v2, v3
    v_cvt_pk_bf16_f32 v10, v4, v5
    v_cvt_pk_bf16_f32 v11, v6, v7
    buffer_store_dwordx4 v[8:11], v246, s[52:55], 0 offen offset:0 sc1
    s_waitcnt lgkmcnt(0)
    v_mfma_f32_32x32x16_bf16 v[128:143], a[228:231], a[104:107], v[128:143]
    ds_read_b64_tr_b16 a[224:225], v240 offset:34816
    ds_read_b64_tr_b16 a[226:227], v240 offset:35072
    s_add_u32 m0, s3, 0x2000
    s_mov_b32 s75, 0x1f800
    buffer_load_dwordx4 v223, s[56:59], s75 offen lds
    v_mul_f32 v16, 0xbfb8aa3b, v16
    v_mul_f32 v17, 0xbfb8aa3b, v17
    v_mul_f32 v18, 0xbfb8aa3b, v18
    v_mul_f32 v19, 0xbfb8aa3b, v19
    v_mul_f32 v20, 0xbfb8aa3b, v20
    v_mul_f32 v21, 0xbfb8aa3b, v21
    v_mul_f32 v22, 0xbfb8aa3b, v22
    v_mul_f32 v23, 0xbfb8aa3b, v23
    v_exp_f32 v16, v16
    v_exp_f32 v17, v17
    v_mfma_f32_32x32x16_bf16 v[144:159], a[228:231], a[108:111], v[144:159]
    s_add_u32 m0, s3, 0x2400
    s_mov_b32 s75, 0x21400
    buffer_load_dwordx4 v223, s[56:59], s75 offen lds
    v_exp_f32 v18, v18
    v_exp_f32 v19, v19
    v_exp_f32 v20, v20
    v_exp_f32 v21, v21
    v_exp_f32 v22, v22
    v_exp_f32 v23, v23
    v_add_f32 v16, 1.0, v16
    v_add_f32 v17, 1.0, v17
    v_add_f32 v18, 1.0, v18
    s_waitcnt lgkmcnt(0)
    v_mfma_f32_32x32x16_bf16 v[128:143], a[224:227], a[112:115], v[128:143]
    ds_read_b64_tr_b16 a[228:229], v240 offset:35840
    ds_read_b64_tr_b16 a[230:231], v240 offset:36096
    s_waitcnt vmcnt(22)
    ds_read_b64_tr_b16 v[64:65], v234 offset:0
    ds_read_b64_tr_b16 v[66:67], v234 offset:1024
    ds_read_b64_tr_b16 v[68:69], v235 offset:0
    ds_read_b64_tr_b16 v[70:71], v235 offset:1024
    s_add_u32 m0, s3, 0x2800
    s_mov_b32 s75, 0x23000
    buffer_load_dwordx4 v223, s[56:59], s75 offen lds
    v_add_f32 v19, 1.0, v19
    v_add_f32 v20, 1.0, v20
    v_add_f32 v21, 1.0, v21
    v_add_f32 v22, 1.0, v22
    v_add_f32 v23, 1.0, v23
    v_rcp_f32 v16, v16
    v_rcp_f32 v17, v17
    v_mfma_f32_32x32x16_bf16 v[144:159], a[224:227], a[116:119], v[144:159]
    s_add_u32 m0, s3, 0x2c00
    s_mov_b32 s75, 0x24c00
    buffer_load_dwordx4 v223, s[56:59], s75 offen lds
    v_rcp_f32 v18, v18
    v_rcp_f32 v19, v19
    v_rcp_f32 v20, v20
    v_rcp_f32 v21, v21
    v_rcp_f32 v22, v22
    v_rcp_f32 v23, v23
    v_mul_f32 v16, v16, v24
    v_mul_f32 v17, v17, v25
    v_mul_f32 v18, v18, v26
    s_waitcnt lgkmcnt(4)
    v_mfma_f32_32x32x16_bf16 v[128:143], a[228:231], a[120:123], v[128:143]
    s_waitcnt lgkmcnt(0)
    s_barrier
    ds_read_b64_tr_b16 a[224:225], v239 offset:16384
    ds_read_b64_tr_b16 a[226:227], v239 offset:16640
    s_waitcnt vmcnt(22)
    ds_read_b64_tr_b16 v[72:73], v232 offset:0
    ds_read_b64_tr_b16 v[74:75], v232 offset:1024
    ds_read_b64_tr_b16 v[76:77], v233 offset:0
    ds_read_b64_tr_b16 v[78:79], v233 offset:1024
    s_add_u32 m0, s26, 0
    s_mov_b32 s75, 0x26800
    buffer_load_dwordx4 v223, s[56:59], s75 offen lds
    v_mul_f32 v19, v19, v27
    v_mul_f32 v20, v20, v28
    v_mul_f32 v21, v21, v29
    v_mul_f32 v22, v22, v30
    v_mul_f32 v23, v23, v31
    v_cvt_pk_bf16_f32 v24, v16, v17
    v_cvt_pk_bf16_f32 v25, v18, v19
    v_cvt_pk_bf16_f32 v26, v20, v21
    v_cvt_pk_bf16_f32 v27, v22, v23
    v_mfma_f32_32x32x16_bf16 v[144:159], a[228:231], a[124:127], v[144:159]
    s_add_u32 m0, s26, 0x400
    s_mov_b32 s75, 0x28400
    buffer_load_dwordx4 v223, s[56:59], s75 offen lds
    buffer_store_dwordx4 v[24:27], v246, s[52:55], 0 offen offset:1024 sc1
    v_mul_f32 v32, 0xbfb8aa3b, v32
    v_mul_f32 v33, 0xbfb8aa3b, v33
    v_mul_f32 v34, 0xbfb8aa3b, v34
    v_mul_f32 v35, 0xbfb8aa3b, v35
    v_mul_f32 v36, 0xbfb8aa3b, v36
    v_mul_f32 v37, 0xbfb8aa3b, v37
    v_mul_f32 v38, 0xbfb8aa3b, v38
    v_mul_f32 v39, 0xbfb8aa3b, v39
    v_exp_f32 v32, v32
    v_exp_f32 v33, v33
    v_exp_f32 v34, v34
    s_waitcnt lgkmcnt(4)
    v_mfma_f32_32x32x16_bf16 v[128:143], a[224:227], a[128:131], v[128:143]
    ds_read_b64_tr_b16 a[228:229], v239 offset:17408
    ds_read_b64_tr_b16 a[230:231], v239 offset:17664
    s_waitcnt vmcnt(22)
    ds_read_b64_tr_b16 v[80:81], v232 offset:2048
    ds_read_b64_tr_b16 v[82:83], v232 offset:3072
    ds_read_b64_tr_b16 v[84:85], v233 offset:2048
    ds_read_b64_tr_b16 v[86:87], v233 offset:3072
    s_waitcnt lgkmcnt(6)
    s_add_u32 m0, s70, 0
    s_mov_b32 s75, 0x2a000
    buffer_load_dwordx4 v223, s[56:59], s75 offen lds
    v_exp_f32 v35, v35
    v_exp_f32 v36, v36
    v_exp_f32 v37, v37
    v_exp_f32 v38, v38
    v_mfma_f32_32x32x16_bf16 v[144:159], a[224:227], a[132:135], v[144:159]
    s_add_u32 m0, s70, 0x400
    s_mov_b32 s75, 0x2bc00
    buffer_load_dwordx4 v223, s[56:59], s75 offen lds
    v_exp_f32 v39, v39
    v_add_f32 v32, 1.0, v32
    v_add_f32 v33, 1.0, v33
    v_add_f32 v34, 1.0, v34
    v_add_f32 v35, 1.0, v35
    v_add_f32 v36, 1.0, v36
    v_add_f32 v37, 1.0, v37
    v_add_f32 v38, 1.0, v38
    v_add_f32 v39, 1.0, v39
    v_rcp_f32 v32, v32
    v_rcp_f32 v33, v33
    s_waitcnt lgkmcnt(4)
    v_mfma_f32_32x32x16_bf16 v[128:143], a[228:231], a[136:139], v[128:143]
    ds_read_b64_tr_b16 a[224:225], v239 offset:18432
    ds_read_b64_tr_b16 a[226:227], v239 offset:18688
    s_waitcnt vmcnt(22)
    ds_read_b64_tr_b16 v[88:89], v232 offset:4096
    ds_read_b64_tr_b16 v[90:91], v232 offset:5120
    ds_read_b64_tr_b16 v[92:93], v233 offset:4096
    ds_read_b64_tr_b16 v[94:95], v233 offset:5120
    s_waitcnt lgkmcnt(6)
    s_add_u32 m0, s70, 0x800
    s_mov_b32 s75, 0x2d800
    buffer_load_dwordx4 v223, s[56:59], s75 offen lds
    v_rcp_f32 v34, v34
    v_rcp_f32 v35, v35
    v_rcp_f32 v36, v36
    v_rcp_f32 v37, v37
    v_mfma_f32_32x32x16_bf16 v[144:159], a[228:231], a[140:143], v[144:159]
    s_add_u32 m0, s70, 0xc00
    s_mov_b32 s75, 0x2f400
    buffer_load_dwordx4 v223, s[56:59], s75 offen lds
    v_rcp_f32 v38, v38
    v_rcp_f32 v39, v39
    v_mul_f32 v32, v32, v40
    v_mul_f32 v33, v33, v41
    v_mul_f32 v34, v34, v42
    v_mul_f32 v35, v35, v43
    v_mul_f32 v36, v36, v44
    v_mul_f32 v37, v37, v45
    v_mul_f32 v38, v38, v46
    v_mul_f32 v39, v39, v47
    v_cvt_pk_bf16_f32 v40, v32, v33
    v_cvt_pk_bf16_f32 v41, v34, v35
    v_cvt_pk_bf16_f32 v42, v36, v37
    s_waitcnt lgkmcnt(4)
    v_mfma_f32_32x32x16_bf16 v[128:143], a[224:227], a[144:147], v[128:143]
    ds_read_b64_tr_b16 a[228:229], v239 offset:19456
    ds_read_b64_tr_b16 a[230:231], v239 offset:19712
    s_waitcnt vmcnt(21)
    ds_read_b64_tr_b16 v[96:97], v232 offset:6144
    ds_read_b64_tr_b16 v[98:99], v232 offset:7168
    ds_read_b64_tr_b16 v[100:101], v233 offset:6144
    ds_read_b64_tr_b16 v[102:103], v233 offset:7168
    s_waitcnt lgkmcnt(6)
    s_add_u32 m0, s70, 0x1000
    s_mov_b32 s75, 0x31000
    buffer_load_dwordx4 v223, s[56:59], s75 offen lds
    v_cvt_pk_bf16_f32 v43, v38, v39
    buffer_store_dwordx4 v[40:43], v246, s[52:55], 0 offen offset:2048 sc1
    v_mul_f32 v48, 0xbfb8aa3b, v48
    v_mul_f32 v49, 0xbfb8aa3b, v49
    v_mul_f32 v50, 0xbfb8aa3b, v50
    v_mul_f32 v51, 0xbfb8aa3b, v51
    v_mul_f32 v52, 0xbfb8aa3b, v52
    v_mul_f32 v53, 0xbfb8aa3b, v53
    v_mul_f32 v54, 0xbfb8aa3b, v54
    v_mfma_f32_32x32x16_bf16 v[144:159], a[224:227], a[148:151], v[144:159]
    s_add_u32 m0, s70, 0x1400
    s_mov_b32 s75, 0x32c00
    buffer_load_dwordx4 v223, s[56:59], s75 offen lds
    v_mul_f32 v55, 0xbfb8aa3b, v55
    v_exp_f32 v48, v48
    v_exp_f32 v49, v49
    v_exp_f32 v50, v50
    v_exp_f32 v51, v51
    v_exp_f32 v52, v52
    v_exp_f32 v53, v53
    v_exp_f32 v54, v54
    s_waitcnt lgkmcnt(4)
    v_mfma_f32_32x32x16_bf16 v[128:143], a[228:231], a[152:155], v[128:143]
    ds_read_b64_tr_b16 a[224:225], v239 offset:40960
    ds_read_b64_tr_b16 a[226:227], v239 offset:41216
    s_waitcnt vmcnt(22)
    ds_read_b64_tr_b16 v[104:105], v236 offset:0
    ds_read_b64_tr_b16 v[106:107], v236 offset:1024
    ds_read_b64_tr_b16 v[108:109], v237 offset:0
    ds_read_b64_tr_b16 v[110:111], v237 offset:1024
    s_waitcnt lgkmcnt(6)
    s_add_u32 m0, s70, 0x1800
    s_mov_b32 s75, 0x34800
    buffer_load_dwordx4 v223, s[56:59], s75 offen lds
    v_exp_f32 v55, v55
    v_add_f32 v48, 1.0, v48
    v_add_f32 v49, 1.0, v49
    v_add_f32 v50, 1.0, v50
    v_add_f32 v51, 1.0, v51
    v_add_f32 v52, 1.0, v52
    v_add_f32 v53, 1.0, v53
    v_add_f32 v54, 1.0, v54
    v_mfma_f32_32x32x16_bf16 v[144:159], a[228:231], a[156:159], v[144:159]
    s_add_u32 m0, s70, 0x1c00
    s_mov_b32 s75, 0x36400
    buffer_load_dwordx4 v223, s[56:59], s75 offen lds
    v_add_f32 v55, 1.0, v55
    v_rcp_f32 v48, v48
    v_rcp_f32 v49, v49
    v_rcp_f32 v50, v50
    v_rcp_f32 v51, v51
    v_rcp_f32 v52, v52
    v_rcp_f32 v53, v53
    v_rcp_f32 v54, v54
    s_waitcnt lgkmcnt(4)
    v_mfma_f32_32x32x16_bf16 v[128:143], a[224:227], a[160:163], v[128:143]
    ds_read_b64_tr_b16 a[228:229], v239 offset:41984
    ds_read_b64_tr_b16 a[230:231], v239 offset:42240
    s_waitcnt vmcnt(22)
    ds_read_b64_tr_b16 v[112:113], v236 offset:2048
    ds_read_b64_tr_b16 v[114:115], v236 offset:3072
    ds_read_b64_tr_b16 v[116:117], v237 offset:2048
    ds_read_b64_tr_b16 v[118:119], v237 offset:3072
    s_waitcnt lgkmcnt(6)
    s_add_u32 m0, s3, 0
    s_nop 0
    buffer_load_dwordx4 v245, s[40:43], 0 offen lds
    v_rcp_f32 v55, v55
    v_mul_f32 v48, v48, v56
    v_mul_f32 v49, v49, v57
    v_mul_f32 v50, v50, v58
    v_mul_f32 v51, v51, v59
    v_mul_f32 v52, v52, v60
    v_mul_f32 v53, v53, v61
    v_mul_f32 v54, v54, v62
    v_mul_f32 v55, v55, v63
    v_mfma_f32_32x32x16_bf16 v[144:159], a[224:227], a[164:167], v[144:159]
    s_add_u32 m0, s3, 0x400
    s_mov_b32 s75, 0x1c00
    buffer_load_dwordx4 v245, s[40:43], s75 offen lds
    v_cvt_pk_bf16_f32 v56, v48, v49
    v_cvt_pk_bf16_f32 v57, v50, v51
    v_cvt_pk_bf16_f32 v58, v52, v53
    v_cvt_pk_bf16_f32 v59, v54, v55
    buffer_store_dwordx4 v[56:59], v246, s[52:55], 0 offen offset:3072 sc1
    s_waitcnt lgkmcnt(4)
    v_mfma_f32_32x32x16_bf16 v[128:143], a[228:231], a[168:171], v[128:143]
    ds_read_b64_tr_b16 a[224:225], v239 offset:43008
    ds_read_b64_tr_b16 a[226:227], v239 offset:43264
    s_waitcnt vmcnt(22)
    ds_read_b64_tr_b16 v[120:121], v236 offset:4096
    ds_read_b64_tr_b16 v[122:123], v236 offset:5120
    ds_read_b64_tr_b16 v[124:125], v237 offset:4096
    s_waitcnt lgkmcnt(5)
    s_add_u32 m0, s3, 0x800
    s_mov_b32 s75, 0x3800
    buffer_load_dwordx4 v245, s[40:43], s75 offen lds
    v_mfma_f32_32x32x16_bf16 v[144:159], a[228:231], a[172:175], v[144:159]
    ds_read_b64_tr_b16 v[126:127], v237 offset:5120
    s_add_u32 m0, s3, 0xc00
    s_mov_b32 s75, 0x5400
    buffer_load_dwordx4 v245, s[40:43], s75 offen lds
    s_waitcnt lgkmcnt(4)
    v_mfma_f32_32x32x16_bf16 v[128:143], a[224:227], a[176:179], v[128:143]
    ds_read_b64_tr_b16 a[228:229], v239 offset:44032
    ds_read_b64_tr_b16 a[230:231], v239 offset:44288
    s_waitcnt lgkmcnt(2)
    s_add_u32 m0, s3, 0x1000
    s_mov_b32 s75, 0x6200
    buffer_load_dwordx4 v245, s[40:43], s75 offen lds
    v_mfma_f32_32x32x16_bf16 v[144:159], a[224:227], a[180:183], v[144:159]
    s_add_u32 m0, s3, 0x1400
    s_mov_b32 s75, 0x7e00
    buffer_load_dwordx4 v245, s[40:43], s75 offen lds
    s_waitcnt lgkmcnt(0)
    v_mfma_f32_32x32x16_bf16 v[128:143], a[228:231], a[184:187], v[128:143]
    ds_read_b64_tr_b16 a[224:225], v240 offset:16384
    ds_read_b64_tr_b16 a[226:227], v240 offset:16640
    v_mfma_f32_32x32x16_bf16 v[144:159], a[228:231], a[188:191], v[144:159]
    s_waitcnt lgkmcnt(0)
    v_mfma_f32_32x32x16_bf16 v[128:143], a[224:227], a[192:195], v[128:143]
    ds_read_b64_tr_b16 a[228:229], v240 offset:17408
    ds_read_b64_tr_b16 a[230:231], v240 offset:17664
    v_mfma_f32_32x32x16_bf16 v[144:159], a[224:227], a[196:199], v[144:159]
    s_waitcnt lgkmcnt(0)
    v_mfma_f32_32x32x16_bf16 v[128:143], a[228:231], a[200:203], v[128:143]
    ds_read_b64_tr_b16 a[224:225], v240 offset:18432
    ds_read_b64_tr_b16 a[226:227], v240 offset:18688
    v_mfma_f32_32x32x16_bf16 v[144:159], a[228:231], a[204:207], v[144:159]
    s_waitcnt lgkmcnt(0)
    v_mfma_f32_32x32x16_bf16 v[128:143], a[224:227], a[208:211], v[128:143]
    ds_read_b64_tr_b16 a[228:229], v240 offset:19456
    ds_read_b64_tr_b16 a[230:231], v240 offset:19712
    v_mfma_f32_32x32x16_bf16 v[144:159], a[224:227], a[212:215], v[144:159]
    s_waitcnt lgkmcnt(0)
    v_mfma_f32_32x32x16_bf16 v[128:143], a[228:231], a[216:219], v[128:143]
    ds_read_b64_tr_b16 a[224:225], v241 offset:8192
    ds_read_b64_tr_b16 a[226:227], v241 offset:8448
    v_mfma_f32_32x32x16_bf16 v[144:159], a[228:231], a[220:223], v[144:159]
    s_waitcnt lgkmcnt(0)
    v_mfma_f32_32x32x16_bf16 v[160:175], a[224:227], a[0:3], 0
    ds_read_b64_tr_b16 a[228:229], v241 offset:9216
    ds_read_b64_tr_b16 a[230:231], v241 offset:9472
    s_nop 4
    v_mul_f32 v128, 0xbfb8aa3b, v128
    v_mul_f32 v129, 0xbfb8aa3b, v129
    v_mul_f32 v130, 0xbfb8aa3b, v130
    v_mfma_f32_32x32x16_bf16 v[176:191], a[224:227], a[4:7], 0
    v_mul_f32 v131, 0xbfb8aa3b, v131
    v_mul_f32 v132, 0xbfb8aa3b, v132
    v_mul_f32 v133, 0xbfb8aa3b, v133
    v_mul_f32 v134, 0xbfb8aa3b, v134
    v_mul_f32 v135, 0xbfb8aa3b, v135
    s_waitcnt lgkmcnt(0)
    v_mfma_f32_32x32x16_bf16 v[160:175], a[228:231], a[8:11], v[160:175]
    ds_read_b64_tr_b16 a[224:225], v241 offset:10240
    ds_read_b64_tr_b16 a[226:227], v241 offset:10496
    s_waitcnt vmcnt(24)
    ds_read_b64_tr_b16 a[0:1], v236 offset:6144
    ds_read_b64_tr_b16 a[2:3], v236 offset:7168
    ds_read_b64_tr_b16 a[4:5], v237 offset:6144
    v_mfma_f32_32x32x16_bf16 v[176:191], a[228:231], a[12:15], v[176:191]
    ds_read_b64_tr_b16 a[6:7], v237 offset:7168
    v_exp_f32 v128, v128
    v_exp_f32 v129, v129
    s_waitcnt lgkmcnt(4)
    v_mfma_f32_32x32x16_bf16 v[160:175], a[224:227], a[16:19], v[160:175]
    ds_read_b64_tr_b16 a[228:229], v241 offset:11264
    ds_read_b64_tr_b16 a[230:231], v241 offset:11520
    s_waitcnt vmcnt(21)
    ds_read_b64_tr_b16 a[8:9], v236 offset:8192
    ds_read_b64_tr_b16 a[10:11], v236 offset:9216
    ds_read_b64_tr_b16 a[12:13], v237 offset:8192
    s_waitcnt lgkmcnt(5)
    s_add_u32 m0, s3, 0x1800
    s_mov_b32 s75, 0x9a00
    buffer_load_dwordx4 v245, s[40:43], s75 offen lds
    v_mfma_f32_32x32x16_bf16 v[176:191], a[224:227], a[20:23], v[176:191]
    ds_read_b64_tr_b16 a[14:15], v237 offset:9216
    s_add_u32 m0, s3, 0x1c00
    s_mov_b32 s75, 0xb600
    buffer_load_dwordx4 v245, s[40:43], s75 offen lds
    s_waitcnt lgkmcnt(4)
    v_mfma_f32_32x32x16_bf16 v[160:175], a[228:231], a[24:27], v[160:175]
    ds_read_b64_tr_b16 a[224:225], v241 offset:32768
    ds_read_b64_tr_b16 a[226:227], v241 offset:33024
    s_waitcnt vmcnt(21)
    ds_read_b64_tr_b16 a[16:17], v236 offset:10240
    ds_read_b64_tr_b16 a[18:19], v236 offset:11264
    ds_read_b64_tr_b16 a[20:21], v237 offset:10240
    s_waitcnt lgkmcnt(5)
    s_add_u32 m0, s3, 0x2000
    s_mov_b32 s75, 0xc400
    buffer_load_dwordx4 v245, s[40:43], s75 offen lds
    v_mfma_f32_32x32x16_bf16 v[176:191], a[228:231], a[28:31], v[176:191]
    ds_read_b64_tr_b16 a[22:23], v237 offset:11264
    s_add_u32 m0, s3, 0x2400
    s_mov_b32 s75, 0xe000
    buffer_load_dwordx4 v245, s[40:43], s75 offen lds
    s_waitcnt lgkmcnt(4)
    v_mfma_f32_32x32x16_bf16 v[160:175], a[224:227], a[32:35], v[160:175]
    ds_read_b64_tr_b16 a[228:229], v241 offset:33792
    ds_read_b64_tr_b16 a[230:231], v241 offset:34048
    s_waitcnt vmcnt(21)
    ds_read_b64_tr_b16 a[24:25], v234 offset:0
    ds_read_b64_tr_b16 a[26:27], v234 offset:1024
    ds_read_b64_tr_b16 a[28:29], v235 offset:0
    s_waitcnt lgkmcnt(5)
    s_add_u32 m0, s3, 0x2800
    s_mov_b32 s75, 0xfc00
    buffer_load_dwordx4 v245, s[40:43], s75 offen lds
    v_mfma_f32_32x32x16_bf16 v[176:191], a[224:227], a[36:39], v[176:191]
    ds_read_b64_tr_b16 a[30:31], v235 offset:1024
    s_add_u32 m0, s3, 0x2c00
    s_mov_b32 s75, 0x11800
    buffer_load_dwordx4 v245, s[40:43], s75 offen lds
    s_waitcnt lgkmcnt(4)
    v_mfma_f32_32x32x16_bf16 v[160:175], a[228:231], a[40:43], v[160:175]
    ds_read_b64_tr_b16 a[224:225], v241 offset:34816
    ds_read_b64_tr_b16 a[226:227], v241 offset:35072
    s_waitcnt vmcnt(20)
    ds_read_b64_tr_b16 a[32:33], v232 offset:0
    ds_read_b64_tr_b16 a[34:35], v232 offset:1024
    ds_read_b64_tr_b16 a[36:37], v233 offset:0
    s_waitcnt lgkmcnt(5)
    s_add_u32 m0, s26, 0
    s_mov_b32 s75, 0x12600
    buffer_load_dwordx4 v245, s[40:43], s75 offen lds
    v_mfma_f32_32x32x16_bf16 v[176:191], a[228:231], a[44:47], v[176:191]
    ds_read_b64_tr_b16 a[38:39], v233 offset:1024
    s_add_u32 m0, s26, 0x400
    s_mov_b32 s75, 0x14200
    buffer_load_dwordx4 v245, s[40:43], s75 offen lds
    s_waitcnt lgkmcnt(4)
    v_mfma_f32_32x32x16_bf16 v[160:175], a[224:227], a[48:51], v[160:175]
    ds_read_b64_tr_b16 a[228:229], v241 offset:35840
    ds_read_b64_tr_b16 a[230:231], v241 offset:36096
    s_waitcnt vmcnt(20)
    ds_read_b64_tr_b16 a[40:41], v232 offset:2048
    ds_read_b64_tr_b16 a[42:43], v232 offset:3072
    ds_read_b64_tr_b16 a[44:45], v233 offset:2048
    s_waitcnt lgkmcnt(5)
    s_add_u32 m0, s70, 0
    s_mov_b32 s75, 0x15e00
    buffer_load_dwordx4 v245, s[40:43], s75 offen lds
    v_mfma_f32_32x32x16_bf16 v[176:191], a[224:227], a[52:55], v[176:191]
    ds_read_b64_tr_b16 a[46:47], v233 offset:3072
    s_add_u32 m0, s70, 0x400
    s_mov_b32 s75, 0x17a00
    buffer_load_dwordx4 v245, s[40:43], s75 offen lds
    s_waitcnt lgkmcnt(4)
    v_mfma_f32_32x32x16_bf16 v[160:175], a[228:231], a[56:59], v[160:175]
    ds_read_b64_tr_b16 a[224:225], v242 offset:8192
    ds_read_b64_tr_b16 a[226:227], v242 offset:8448
    s_waitcnt vmcnt(19)
    ds_read_b64_tr_b16 a[48:49], v232 offset:4096
    ds_read_b64_tr_b16 a[50:51], v232 offset:5120
    ds_read_b64_tr_b16 a[52:53], v233 offset:4096
    s_waitcnt lgkmcnt(5)
    s_add_u32 m0, s70, 0x800
    s_mov_b32 s75, 0x38000
    buffer_load_dwordx4 v223, s[56:59], s75 offen lds
    v_mfma_f32_32x32x16_bf16 v[176:191], a[228:231], a[60:63], v[176:191]
    ds_read_b64_tr_b16 a[54:55], v233 offset:5120
    s_add_u32 m0, s70, 0xc00
    s_mov_b32 s75, 0x39c00
    buffer_load_dwordx4 v223, s[56:59], s75 offen lds
    s_waitcnt lgkmcnt(4)
    v_mfma_f32_32x32x16_bf16 v[160:175], a[224:227], a[64:67], v[160:175]
    ds_read_b64_tr_b16 a[228:229], v242 offset:9216
    ds_read_b64_tr_b16 a[230:231], v242 offset:9472
    s_waitcnt vmcnt(19)
    ds_read_b64_tr_b16 a[56:57], v232 offset:6144
    ds_read_b64_tr_b16 a[58:59], v232 offset:7168
    ds_read_b64_tr_b16 a[60:61], v233 offset:6144
    s_waitcnt vmcnt(16)
    s_nop 0
    s_mov_b64 exec, 1
    buffer_store_dwordx2 v[220:221], v244, s[52:55], 0 offen offset:0 sc1
    s_mov_b64 exec, -1
    v_mfma_f32_32x32x16_bf16 v[176:191], a[224:227], a[68:71], v[176:191]
    ds_read_b64_tr_b16 a[62:63], v233 offset:7168
    s_waitcnt lgkmcnt(6)
    s_add_u32 m0, s70, 0x1000
    s_mov_b32 s75, 0x3b800
    buffer_load_dwordx4 v223, s[56:59], s75 offen lds
    s_add_u32 m0, s70, 0x1400
    s_mov_b32 s75, 0x3d400
    buffer_load_dwordx4 v223, s[56:59], s75 offen lds
    s_waitcnt lgkmcnt(4)
    v_mfma_f32_32x32x16_bf16 v[160:175], a[228:231], a[72:75], v[160:175]
    ds_read_b64_tr_b16 a[224:225], v242 offset:10240
    ds_read_b64_tr_b16 a[226:227], v242 offset:10496
    ds_read_b64_tr_b16 a[64:65], v236 offset:0
    ds_read_b64_tr_b16 a[66:67], v236 offset:1024
    ds_read_b64_tr_b16 a[68:69], v237 offset:0
    s_waitcnt lgkmcnt(5)
    s_add_u32 m0, s70, 0x1800
    s_mov_b32 s75, 0x3f000
    buffer_load_dwordx4 v223, s[56:59], s75 offen lds
    v_mfma_f32_32x32x16_bf16 v[176:191], a[228:231], a[76:79], v[176:191]
    ds_read_b64_tr_b16 a[70:71], v237 offset:1024
    s_add_u32 m0, s70, 0x1c00
    s_mov_b32 s75, 0x40c00
    buffer_load_dwordx4 v223, s[56:59], s75 offen lds
    s_waitcnt lgkmcnt(4)
    v_mfma_f32_32x32x16_bf16 v[160:175], a[224:227], a[80:83], v[160:175]
    ds_read_b64_tr_b16 a[228:229], v242 offset:11264
    ds_read_b64_tr_b16 a[230:231], v242 offset:11520
    s_waitcnt lgkmcnt(2)
    s_add_u32 m0, s3, 0
    s_mov_b32 s75, 0x42800
    buffer_load_dwordx4 v223, s[56:59], s75 offen lds
    v_mfma_f32_32x32x16_bf16 v[176:191], a[224:227], a[84:87], v[176:191]
    s_add_u32 m0, s3, 0x400
    s_mov_b32 s75, 0x44400
    buffer_load_dwordx4 v223, s[56:59], s75 offen lds
    v_exp_f32 v130, v130
    s_waitcnt lgkmcnt(0)
    v_mfma_f32_32x32x16_bf16 v[160:175], a[228:231], a[88:91], v[160:175]
    ds_read_b64_tr_b16 a[224:225], v242 offset:32768
    ds_read_b64_tr_b16 a[226:227], v242 offset:33024
    v_exp_f32 v131, v131
    v_mfma_f32_32x32x16_bf16 v[176:191], a[228:231], a[92:95], v[176:191]
    v_exp_f32 v132, v132
    v_exp_f32 v133, v133
    s_waitcnt lgkmcnt(0)
    v_mfma_f32_32x32x16_bf16 v[160:175], a[224:227], a[96:99], v[160:175]
    ds_read_b64_tr_b16 a[228:229], v242 offset:33792
    ds_read_b64_tr_b16 a[230:231], v242 offset:34048
    v_exp_f32 v134, v134
    v_mfma_f32_32x32x16_bf16 v[176:191], a[224:227], a[100:103], v[176:191]
    v_exp_f32 v135, v135
    v_add_f32 v128, 1.0, v128
    v_add_f32 v129, 1.0, v129
    v_add_f32 v130, 1.0, v130
    s_waitcnt lgkmcnt(0)
    v_mfma_f32_32x32x16_bf16 v[160:175], a[228:231], a[104:107], v[160:175]
    ds_read_b64_tr_b16 a[224:225], v242 offset:34816
    ds_read_b64_tr_b16 a[226:227], v242 offset:35072
    v_add_f32 v131, 1.0, v131
    v_add_f32 v132, 1.0, v132
    v_add_f32 v133, 1.0, v133
    v_mfma_f32_32x32x16_bf16 v[176:191], a[228:231], a[108:111], v[176:191]
    v_add_f32 v134, 1.0, v134
    v_add_f32 v135, 1.0, v135
    v_rcp_f32 v128, v128
    s_waitcnt lgkmcnt(0)
    v_mfma_f32_32x32x16_bf16 v[160:175], a[224:227], a[112:115], v[160:175]
    ds_read_b64_tr_b16 a[228:229], v242 offset:35840
    ds_read_b64_tr_b16 a[230:231], v242 offset:36096
    v_rcp_f32 v129, v129
    v_mfma_f32_32x32x16_bf16 v[176:191], a[224:227], a[116:119], v[176:191]
    v_rcp_f32 v130, v130
    v_rcp_f32 v131, v131
    s_waitcnt lgkmcnt(0)
    v_mfma_f32_32x32x16_bf16 v[160:175], a[228:231], a[120:123], v[160:175]
    s_waitcnt lgkmcnt(0)
    s_barrier
    ds_read_b64_tr_b16 a[224:225], v241 offset:16384
    ds_read_b64_tr_b16 a[226:227], v241 offset:16640
    v_rcp_f32 v132, v132
    v_mfma_f32_32x32x16_bf16 v[176:191], a[228:231], a[124:127], v[176:191]
    v_rcp_f32 v133, v133
    v_rcp_f32 v134, v134
    s_waitcnt lgkmcnt(0)
    v_mfma_f32_32x32x16_bf16 v[160:175], a[224:227], a[128:131], v[160:175]
    ds_read_b64_tr_b16 a[228:229], v241 offset:17408
    ds_read_b64_tr_b16 a[230:231], v241 offset:17664
    s_add_u32 m0, s70, 0x2000
    s_mov_b32 s75, 0x46000
    buffer_load_dwordx4 v223, s[56:59], s75 offen lds
    v_mfma_f32_32x32x16_bf16 v[176:191], a[224:227], a[132:135], v[176:191]
    s_add_u32 m0, s70, 0x2400
    s_mov_b32 s75, 0x47c00
    buffer_load_dwordx4 v223, s[56:59], s75 offen lds
    v_rcp_f32 v135, v135
    s_waitcnt lgkmcnt(0)
    v_mfma_f32_32x32x16_bf16 v[160:175], a[228:231], a[136:139], v[160:175]
    ds_read_b64_tr_b16 a[224:225], v241 offset:18432
    ds_read_b64_tr_b16 a[226:227], v241 offset:18688
    s_add_u32 m0, s70, 0x2800
    s_mov_b32 s75, 0x49800
    buffer_load_dwordx4 v223, s[56:59], s75 offen lds
    v_mfma_f32_32x32x16_bf16 v[176:191], a[228:231], a[140:143], v[176:191]
    s_add_u32 m0, s70, 0x2c00
    s_mov_b32 s75, 0x4b400
    buffer_load_dwordx4 v223, s[56:59], s75 offen lds
    v_mul_f32 v128, v128, v136
    v_mul_f32 v129, v129, v137
    s_waitcnt lgkmcnt(0)
    v_mfma_f32_32x32x16_bf16 v[160:175], a[224:227], a[144:147], v[160:175]
    ds_read_b64_tr_b16 a[228:229], v241 offset:19456
    ds_read_b64_tr_b16 a[230:231], v241 offset:19712
    s_add_u32 m0, s70, 0x3000
    s_mov_b32 s75, 0x4d000
    buffer_load_dwordx4 v223, s[56:59], s75 offen lds
    v_mfma_f32_32x32x16_bf16 v[176:191], a[224:227], a[148:151], v[176:191]
    s_add_u32 m0, s70, 0x3400
    s_mov_b32 s75, 0x4ec00
    buffer_load_dwordx4 v223, s[56:59], s75 offen lds
    v_mul_f32 v130, v130, v138
    v_mul_f32 v131, v131, v139
    s_waitcnt lgkmcnt(0)
    v_mfma_f32_32x32x16_bf16 v[160:175], a[228:231], a[152:155], v[160:175]
    ds_read_b64_tr_b16 a[224:225], v241 offset:40960
    ds_read_b64_tr_b16 a[226:227], v241 offset:41216
    s_add_u32 m0, s70, 0x3800
    s_mov_b32 s75, 0x50800
    buffer_load_dwordx4 v223, s[56:59], s75 offen lds
    v_mfma_f32_32x32x16_bf16 v[176:191], a[228:231], a[156:159], v[176:191]
    s_add_u32 m0, s70, 0x3c00
    s_mov_b32 s75, 0x52400
    buffer_load_dwordx4 v223, s[56:59], s75 offen lds
    v_mul_f32 v132, v132, v140
    v_mul_f32 v133, v133, v141
    s_waitcnt lgkmcnt(0)
    v_mfma_f32_32x32x16_bf16 v[160:175], a[224:227], a[160:163], v[160:175]
    ds_read_b64_tr_b16 a[228:229], v241 offset:41984
    ds_read_b64_tr_b16 a[230:231], v241 offset:42240
    v_mul_f32 v134, v134, v142
    v_mul_f32 v135, v135, v143
    v_cvt_pk_bf16_f32 v136, v128, v129
    v_mfma_f32_32x32x16_bf16 v[176:191], a[224:227], a[164:167], v[176:191]
    v_cvt_pk_bf16_f32 v137, v130, v131
    v_cvt_pk_bf16_f32 v138, v132, v133
    v_cvt_pk_bf16_f32 v139, v134, v135
    buffer_store_dwordx4 v[136:139], v246, s[52:55], s27 offen offset:0 sc1
    v_mul_f32 v144, 0xbfb8aa3b, v144
    s_waitcnt lgkmcnt(0)
    v_mfma_f32_32x32x16_bf16 v[160:175], a[228:231], a[168:171], v[160:175]
    ds_read_b64_tr_b16 a[224:225], v241 offset:43008
    ds_read_b64_tr_b16 a[226:227], v241 offset:43264
    v_mul_f32 v145, 0xbfb8aa3b, v145
    v_mul_f32 v146, 0xbfb8aa3b, v146
    v_mul_f32 v147, 0xbfb8aa3b, v147
    v_mfma_f32_32x32x16_bf16 v[176:191], a[228:231], a[172:175], v[176:191]
    v_mul_f32 v148, 0xbfb8aa3b, v148
    v_mul_f32 v149, 0xbfb8aa3b, v149
    v_mul_f32 v150, 0xbfb8aa3b, v150
    v_mul_f32 v151, 0xbfb8aa3b, v151
    s_waitcnt lgkmcnt(0)
    v_mfma_f32_32x32x16_bf16 v[160:175], a[224:227], a[176:179], v[160:175]
    ds_read_b64_tr_b16 a[228:229], v241 offset:44032
    ds_read_b64_tr_b16 a[230:231], v241 offset:44288
    v_exp_f32 v144, v144
    v_mfma_f32_32x32x16_bf16 v[176:191], a[224:227], a[180:183], v[176:191]
    v_exp_f32 v145, v145
    v_exp_f32 v146, v146
    s_waitcnt lgkmcnt(0)
    v_mfma_f32_32x32x16_bf16 v[160:175], a[228:231], a[184:187], v[160:175]
    ds_read_b64_tr_b16 a[224:225], v242 offset:16384
    ds_read_b64_tr_b16 a[226:227], v242 offset:16640
    v_exp_f32 v147, v147
    v_mfma_f32_32x32x16_bf16 v[176:191], a[228:231], a[188:191], v[176:191]
    v_exp_f32 v148, v148
    v_exp_f32 v149, v149
    s_waitcnt lgkmcnt(0)
    v_mfma_f32_32x32x16_bf16 v[160:175], a[224:227], a[192:195], v[160:175]
    ds_read_b64_tr_b16 a[228:229], v242 offset:17408
    ds_read_b64_tr_b16 a[230:231], v242 offset:17664
    v_exp_f32 v150, v150
    v_mfma_f32_32x32x16_bf16 v[176:191], a[224:227], a[196:199], v[176:191]
    v_exp_f32 v151, v151
    v_add_f32 v144, 1.0, v144
    v_add_f32 v145, 1.0, v145
    v_add_f32 v146, 1.0, v146
    s_waitcnt lgkmcnt(0)
    v_mfma_f32_32x32x16_bf16 v[160:175], a[228:231], a[200:203], v[160:175]
    ds_read_b64_tr_b16 a[224:225], v242 offset:18432
    ds_read_b64_tr_b16 a[226:227], v242 offset:18688
    v_add_f32 v147, 1.0, v147
    v_add_f32 v148, 1.0, v148
    v_add_f32 v149, 1.0, v149
    v_mfma_f32_32x32x16_bf16 v[176:191], a[228:231], a[204:207], v[176:191]
    v_add_f32 v150, 1.0, v150
    v_add_f32 v151, 1.0, v151
    v_rcp_f32 v144, v144
    s_waitcnt lgkmcnt(0)
    v_mfma_f32_32x32x16_bf16 v[160:175], a[224:227], a[208:211], v[160:175]
    ds_read_b64_tr_b16 a[228:229], v242 offset:19456
    ds_read_b64_tr_b16 a[230:231], v242 offset:19712
    v_rcp_f32 v145, v145
    v_mfma_f32_32x32x16_bf16 v[176:191], a[224:227], a[212:215], v[176:191]
    v_rcp_f32 v146, v146
    v_rcp_f32 v147, v147
    s_waitcnt lgkmcnt(0)
    v_mfma_f32_32x32x16_bf16 v[160:175], a[228:231], a[216:219], v[160:175]
    v_rcp_f32 v148, v148
    v_rcp_f32 v149, v149
    v_mfma_f32_32x32x16_bf16 v[176:191], a[228:231], a[220:223], v[176:191]
    v_rcp_f32 v150, v150
    v_rcp_f32 v151, v151
    v_mul_f32 v144, v144, v152
    v_mul_f32 v145, v145, v153
    v_mul_f32 v146, v146, v154
    v_mul_f32 v147, v147, v155
    v_mul_f32 v148, v148, v156
    v_mul_f32 v149, v149, v157
    v_mul_f32 v150, v150, v158
    v_mul_f32 v151, v151, v159
    v_cvt_pk_bf16_f32 v152, v144, v145
    v_cvt_pk_bf16_f32 v153, v146, v147
    v_cvt_pk_bf16_f32 v154, v148, v149
    v_cvt_pk_bf16_f32 v155, v150, v151
    buffer_store_dwordx4 v[152:155], v246, s[52:55], s27 offen offset:1024 sc1
    v_mul_f32 v160, 0xbfb8aa3b, v160
    v_mul_f32 v176, 0xbfb8aa3b, v176
    v_mul_f32 v161, 0xbfb8aa3b, v161
    v_mul_f32 v177, 0xbfb8aa3b, v177
    v_mul_f32 v162, 0xbfb8aa3b, v162
    v_mul_f32 v178, 0xbfb8aa3b, v178
    v_mul_f32 v163, 0xbfb8aa3b, v163
    v_mul_f32 v179, 0xbfb8aa3b, v179
    v_mul_f32 v164, 0xbfb8aa3b, v164
    v_mul_f32 v180, 0xbfb8aa3b, v180
    v_mul_f32 v165, 0xbfb8aa3b, v165
    v_mul_f32 v181, 0xbfb8aa3b, v181
    v_mul_f32 v166, 0xbfb8aa3b, v166
    v_mul_f32 v182, 0xbfb8aa3b, v182
    v_mul_f32 v167, 0xbfb8aa3b, v167
    v_mul_f32 v183, 0xbfb8aa3b, v183
    buffer_load_dwordx2 v[218:219], v216, s[52:55], 0 offen offset:0 sc1
    v_exp_f32 v160, v160
    v_exp_f32 v176, v176
    v_exp_f32 v161, v161
    v_exp_f32 v177, v177
    v_exp_f32 v162, v162
    v_exp_f32 v178, v178
    v_exp_f32 v163, v163
    v_exp_f32 v179, v179
    v_exp_f32 v164, v164
    v_exp_f32 v180, v180
    v_exp_f32 v165, v165
    v_exp_f32 v181, v181
    v_exp_f32 v166, v166
    v_exp_f32 v182, v182
    v_exp_f32 v167, v167
    v_exp_f32 v183, v183
    v_add_f32 v160, 1.0, v160
    v_add_f32 v176, 1.0, v176
    v_add_f32 v161, 1.0, v161
    v_add_f32 v177, 1.0, v177
    v_add_f32 v162, 1.0, v162
    v_add_f32 v178, 1.0, v178
    v_add_f32 v163, 1.0, v163
    v_add_f32 v179, 1.0, v179
    v_add_f32 v164, 1.0, v164
    v_add_f32 v180, 1.0, v180
    v_add_f32 v165, 1.0, v165
    v_add_f32 v181, 1.0, v181
    v_add_f32 v166, 1.0, v166
    v_add_f32 v182, 1.0, v182
    v_add_f32 v167, 1.0, v167
    v_add_f32 v183, 1.0, v183
    v_rcp_f32 v160, v160
    v_rcp_f32 v176, v176
    v_rcp_f32 v161, v161
    v_rcp_f32 v177, v177
    v_rcp_f32 v162, v162
    v_rcp_f32 v178, v178
    v_rcp_f32 v163, v163
    v_rcp_f32 v179, v179
    v_rcp_f32 v164, v164
    v_rcp_f32 v180, v180
    v_rcp_f32 v165, v165
    v_rcp_f32 v181, v181
    v_rcp_f32 v166, v166
    v_rcp_f32 v182, v182
    v_rcp_f32 v167, v167
    v_rcp_f32 v183, v183
    v_mul_f32 v160, v160, v168
    v_mul_f32 v176, v176, v184
    v_mul_f32 v161, v161, v169
    v_mul_f32 v177, v177, v185
    v_mul_f32 v162, v162, v170
    v_mul_f32 v178, v178, v186
    v_mul_f32 v163, v163, v171
    v_mul_f32 v179, v179, v187
    v_mul_f32 v164, v164, v172
    v_mul_f32 v180, v180, v188
    v_mul_f32 v165, v165, v173
    v_mul_f32 v181, v181, v189
    v_mul_f32 v166, v166, v174
    v_mul_f32 v182, v182, v190
    v_mul_f32 v167, v167, v175
    v_mul_f32 v183, v183, v191
    v_cvt_pk_bf16_f32 v168, v160, v161
    v_cvt_pk_bf16_f32 v184, v176, v177
    v_cvt_pk_bf16_f32 v169, v162, v163
    v_cvt_pk_bf16_f32 v185, v178, v179
    v_cvt_pk_bf16_f32 v170, v164, v165
    v_cvt_pk_bf16_f32 v186, v180, v181
    v_cvt_pk_bf16_f32 v171, v166, v167
    v_cvt_pk_bf16_f32 v187, v182, v183
    buffer_store_dwordx4 v[168:171], v246, s[52:55], s27 offen offset:2048 sc1
    buffer_store_dwordx4 v[184:187], v246, s[52:55], s27 offen offset:3072 sc1
    s_cmp_eq_u32 s63, 3
    s_cbranch_scc0 L_p2_go
    s_waitcnt vmcnt(0)
    s_nop 0
    s_mov_b64 exec, 2
    buffer_store_dwordx2 v[220:221], v244, s[52:55], 0 offen offset:0 sc1
    s_mov_b64 exec, -1
    s_endpgm
L_p2_go:
    s_waitcnt vmcnt(2)
    v_cmp_eq_u64 vcc, v[220:221], v[218:219]
    s_nop 0
    s_and_b32 s69, vcc_lo, 0xf
    s_cmp_eq_u32 s69, 15
    s_cbranch_scc1 L_fl_ok_glu_0
L_fl_loop_glu_0:
    s_sleep 2
    buffer_load_dwordx2 v[218:219], v216, s[52:55], 0 offen sc1
    s_waitcnt vmcnt(0)
    v_cmp_eq_u64 vcc, v[220:221], v[218:219]
    s_add_u32 s84, s84, 1
    s_cmp_gt_u32 s84, 20000
    s_cbranch_scc1 L_fl_ok_glu_0
    s_and_b32 s69, vcc_lo, 0xf
    s_cmp_eq_u32 s69, 0xf
    s_cbranch_scc0 L_fl_loop_glu_0
L_fl_ok_glu_0:
    buffer_load_dwordx4 a[72:75], v225, s[52:55], 0 offen offset:0 sc1
    buffer_load_dwordx4 a[76:79], v225, s[52:55], 0 offen offset:1024 sc1
    buffer_load_dwordx4 a[80:83], v225, s[52:55], 0 offen offset:2048 sc1
    buffer_load_dwordx4 a[84:87], v225, s[52:55], 0 offen offset:3072 sc1
    s_mov_b32 s76, 0x1000
    buffer_load_dwordx4 a[88:91], v225, s[52:55], s76 offen offset:0 sc1
    buffer_load_dwordx4 a[92:95], v225, s[52:55], s76 offen offset:1024 sc1
    s_mov_b32 s76, 0x1000
    buffer_load_dwordx4 a[96:99], v225, s[52:55], s76 offen offset:2048 sc1
    buffer_load_dwordx4 a[100:103], v225, s[52:55], s76 offen offset:3072 sc1
    s_barrier
    s_add_u32 m0, s70, 0x4000
    s_mov_b32 s75, 0x54000
    buffer_load_dwordx4 v223, s[56:59], s75 offen lds
    s_add_u32 m0, s70, 0x4400
    s_mov_b32 s75, 0x55c00
    buffer_load_dwordx4 v223, s[56:59], s75 offen lds
    s_add_u32 m0, s70, 0x4800
    s_mov_b32 s75, 0x57800
    buffer_load_dwordx4 v223, s[56:59], s75 offen lds
    s_add_u32 m0, s70, 0x4c00
    s_mov_b32 s75, 0x59400
    buffer_load_dwordx4 v223, s[56:59], s75 offen lds
    s_add_u32 m0, s70, 0x5000
    s_mov_b32 s75, 0x5b000
    buffer_load_dwordx4 v223, s[56:59], s75 offen lds
    s_add_u32 m0, s70, 0x5400
    s_mov_b32 s75, 0x5cc00
    buffer_load_dwordx4 v223, s[56:59], s75 offen lds
    s_add_u32 m0, s70, 0x5800
    s_mov_b32 s75, 0x5e800
    buffer_load_dwordx4 v223, s[56:59], s75 offen lds
    s_add_u32 m0, s70, 0x5c00
    s_mov_b32 s75, 0x60400
    buffer_load_dwordx4 v223, s[56:59], s75 offen lds
    s_mov_b32 s76, 0x2000
    buffer_load_dwordx4 a[104:107], v225, s[52:55], s76 offen offset:0 sc1
    buffer_load_dwordx4 a[108:111], v225, s[52:55], s76 offen offset:1024 sc1
    s_mov_b32 s76, 0x2000
    buffer_load_dwordx4 a[112:115], v225, s[52:55], s76 offen offset:2048 sc1
    buffer_load_dwordx4 a[116:119], v225, s[52:55], s76 offen offset:3072 sc1
    s_mov_b32 s76, 0x3000
    buffer_load_dwordx4 a[120:123], v225, s[52:55], s76 offen offset:0 sc1
    buffer_load_dwordx4 a[124:127], v225, s[52:55], s76 offen offset:1024 sc1
    s_waitcnt vmcnt(22)
    s_nop 0
    s_mov_b64 exec, 2
    buffer_store_dwordx2 v[220:221], v244, s[52:55], 0 offen offset:0 sc1
    s_mov_b64 exec, -1
    s_mov_b32 s76, 0x3000
    buffer_load_dwordx4 a[128:131], v225, s[52:55], s76 offen offset:2048 sc1
    buffer_load_dwordx4 a[132:135], v225, s[52:55], s76 offen offset:3072 sc1
    s_waitcnt vmcnt(24)
    v_mfma_f32_32x32x16_bf16 v[0:15], v[64:67], a[72:75], 0
    v_mfma_f32_32x32x16_bf16 v[16:31], v[68:71], a[72:75], 0
    s_mov_b32 s76, 0x4000
    buffer_load_dwordx4 a[136:139], v225, s[52:55], s76 offen offset:0 sc1
    buffer_load_dwordx4 a[140:143], v225, s[52:55], s76 offen offset:1024 sc1
    s_waitcnt vmcnt(25)
    v_mfma_f32_32x32x16_bf16 v[32:47], v[64:67], a[76:79], 0
    v_mfma_f32_32x32x16_bf16 v[48:63], v[68:71], a[76:79], 0
    s_waitcnt vmcnt(24)
    v_mfma_f32_32x32x16_bf16 v[0:15], v[72:75], a[80:83], v[0:15]
    v_mfma_f32_32x32x16_bf16 v[16:31], v[76:79], a[80:83], v[16:31]
    s_mov_b32 s76, 0x4000
    buffer_load_dwordx4 a[144:147], v225, s[52:55], s76 offen offset:2048 sc1
    buffer_load_dwordx4 a[148:151], v225, s[52:55], s76 offen offset:3072 sc1
    s_waitcnt vmcnt(25)
    v_mfma_f32_32x32x16_bf16 v[32:47], v[72:75], a[84:87], v[32:47]
    v_mfma_f32_32x32x16_bf16 v[48:63], v[76:79], a[84:87], v[48:63]
    s_waitcnt vmcnt(24)
    v_mfma_f32_32x32x16_bf16 v[0:15], v[80:83], a[88:91], v[0:15]
    v_mfma_f32_32x32x16_bf16 v[16:31], v[84:87], a[88:91], v[16:31]
    s_mov_b32 s76, 0x5000
    buffer_load_dwordx4 a[152:155], v225, s[52:55], s76 offen offset:0 sc1
    buffer_load_dwordx4 a[156:159], v225, s[52:55], s76 offen offset:1024 sc1
    s_waitcnt vmcnt(25)
    v_mfma_f32_32x32x16_bf16 v[32:47], v[80:83], a[92:95], v[32:47]
    v_mfma_f32_32x32x16_bf16 v[48:63], v[84:87], a[92:95], v[48:63]
    s_waitcnt vmcnt(24)
    v_mfma_f32_32x32x16_bf16 v[0:15], v[88:91], a[96:99], v[0:15]
    v_mfma_f32_32x32x16_bf16 v[16:31], v[92:95], a[96:99], v[16:31]
    s_mov_b32 s76, 0x5000
    buffer_load_dwordx4 a[160:163], v225, s[52:55], s76 offen offset:2048 sc1
    buffer_load_dwordx4 a[164:167], v225, s[52:55], s76 offen offset:3072 sc1
    s_waitcnt vmcnt(25)
    v_mfma_f32_32x32x16_bf16 v[32:47], v[88:91], a[100:103], v[32:47]
    v_mfma_f32_32x32x16_bf16 v[48:63], v[92:95], a[100:103], v[48:63]
    s_waitcnt vmcnt(16)
    v_mfma_f32_32x32x16_bf16 v[0:15], v[96:99], a[104:107], v[0:15]
    v_mfma_f32_32x32x16_bf16 v[16:31], v[100:103], a[104:107], v[16:31]
    s_mov_b32 s76, 0x6000
    buffer_load_dwordx4 a[168:171], v225, s[52:55], s76 offen offset:0 sc1
    buffer_load_dwordx4 a[172:175], v225, s[52:55], s76 offen offset:1024 sc1
    buffer_load_dwordx2 v[218:219], v216, s[52:55], 0 offen offset:0 sc1
    s_waitcnt vmcnt(18)
    v_mfma_f32_32x32x16_bf16 v[32:47], v[96:99], a[108:111], v[32:47]
    v_mfma_f32_32x32x16_bf16 v[48:63], v[100:103], a[108:111], v[48:63]
    s_waitcnt vmcnt(17)
    v_mfma_f32_32x32x16_bf16 v[0:15], v[104:107], a[112:115], v[0:15]
    v_mfma_f32_32x32x16_bf16 v[16:31], v[108:111], a[112:115], v[16:31]
    s_mov_b32 s76, 0x6000
    buffer_load_dwordx4 a[176:179], v225, s[52:55], s76 offen offset:2048 sc1
    buffer_load_dwordx4 a[180:183], v225, s[52:55], s76 offen offset:3072 sc1
    s_waitcnt vmcnt(18)
    v_mfma_f32_32x32x16_bf16 v[32:47], v[104:107], a[116:119], v[32:47]
    v_mfma_f32_32x32x16_bf16 v[48:63], v[108:111], a[116:119], v[48:63]
    s_waitcnt vmcnt(17)
    v_mfma_f32_32x32x16_bf16 v[0:15], v[112:115], a[120:123], v[0:15]
    v_mfma_f32_32x32x16_bf16 v[16:31], v[116:119], a[120:123], v[16:31]
    s_mov_b32 s76, 0x7000
    buffer_load_dwordx4 a[184:187], v225, s[52:55], s76 offen offset:0 sc1
    buffer_load_dwordx4 a[188:191], v225, s[52:55], s76 offen offset:1024 sc1
    s_waitcnt vmcnt(18)
    v_mfma_f32_32x32x16_bf16 v[32:47], v[112:115], a[124:127], v[32:47]
    v_mfma_f32_32x32x16_bf16 v[48:63], v[116:119], a[124:127], v[48:63]
    s_waitcnt vmcnt(16)
    v_mfma_f32_32x32x16_bf16 v[0:15], v[120:123], a[128:131], v[0:15]
    v_mfma_f32_32x32x16_bf16 v[16:31], v[124:127], a[128:131], v[16:31]
    s_mov_b32 s76, 0x7000
    buffer_load_dwordx4 a[192:195], v225, s[52:55], s76 offen offset:2048 sc1
    buffer_load_dwordx4 a[196:199], v225, s[52:55], s76 offen offset:3072 sc1
    s_waitcnt vmcnt(17)
    v_mfma_f32_32x32x16_bf16 v[32:47], v[120:123], a[132:135], v[32:47]
    v_mfma_f32_32x32x16_bf16 v[48:63], v[124:127], a[132:135], v[48:63]
    s_waitcnt vmcnt(16)
    v_mfma_f32_32x32x16_bf16 v[0:15], a[0:3], a[136:139], v[0:15]
    v_mfma_f32_32x32x16_bf16 v[16:31], a[4:7], a[136:139], v[16:31]
    s_waitcnt vmcnt(6)
    v_cmp_eq_u64 vcc, v[220:221], v[218:219]
    s_nop 0
    s_and_b32 s69, vcc_lo, 0xf0
    s_cmp_eq_u32 s69, 0xf0
    s_cbranch_scc1 L_fl_ok_glu_1
L_fl_loop_glu_1:
    s_sleep 2
    buffer_load_dwordx2 v[218:219], v216, s[52:55], 0 offen sc1
    s_waitcnt vmcnt(0)
    v_cmp_eq_u64 vcc, v[220:221], v[218:219]
    s_add_u32 s84, s84, 1
    s_cmp_gt_u32 s84, 20000
    s_cbranch_scc1 L_fl_ok_glu_1
    s_and_b32 s69, vcc_lo, 0xf0
    s_cmp_eq_u32 s69, 0xf0
    s_cbranch_scc0 L_fl_loop_glu_1
L_fl_ok_glu_1:
    buffer_load_dword v229, v238, s[52:55], 0 offen offset:0 sc1
    buffer_load_dword v231, v238, s[52:55], 0 offen offset:256 sc1
    s_mov_b32 s76, 0x8000
    buffer_load_dwordx4 a[200:203], v225, s[52:55], s76 offen offset:0 sc1
    buffer_load_dwordx4 a[204:207], v225, s[52:55], s76 offen offset:1024 sc1
    v_mfma_f32_32x32x16_bf16 v[32:47], a[0:3], a[140:143], v[32:47]
    v_mfma_f32_32x32x16_bf16 v[48:63], a[4:7], a[140:143], v[48:63]
    v_mfma_f32_32x32x16_bf16 v[0:15], a[8:11], a[144:147], v[0:15]
    v_mfma_f32_32x32x16_bf16 v[16:31], a[12:15], a[144:147], v[16:31]
    s_mov_b32 s76, 0x8000
    buffer_load_dwordx4 a[208:211], v225, s[52:55], s76 offen offset:2048 sc1
    buffer_load_dwordx4 a[212:215], v225, s[52:55], s76 offen offset:3072 sc1
    v_mfma_f32_32x32x16_bf16 v[32:47], a[8:11], a[148:151], v[32:47]
    v_mfma_f32_32x32x16_bf16 v[48:63], a[12:15], a[148:151], v[48:63]
    v_mfma_f32_32x32x16_bf16 v[0:15], a[16:19], a[152:155], v[0:15]
    v_mfma_f32_32x32x16_bf16 v[16:31], a[20:23], a[152:155], v[16:31]
    s_mov_b32 s76, 0x9000
    buffer_load_dwordx4 a[216:219], v225, s[52:55], s76 offen offset:0 sc1
    buffer_load_dwordx4 a[220:223], v225, s[52:55], s76 offen offset:1024 sc1
    v_mfma_f32_32x32x16_bf16 v[32:47], a[16:19], a[156:159], v[32:47]
    v_mfma_f32_32x32x16_bf16 v[48:63], a[20:23], a[156:159], v[48:63]
    v_mfma_f32_32x32x16_bf16 v[0:15], a[24:27], a[160:163], v[0:15]
    v_mfma_f32_32x32x16_bf16 v[16:31], a[28:31], a[160:163], v[16:31]
    s_mov_b32 s76, 0x9000
    buffer_load_dwordx4 a[224:227], v225, s[52:55], s76 offen offset:2048 sc1
    buffer_load_dwordx4 a[228:231], v225, s[52:55], s76 offen offset:3072 sc1
    v_mfma_f32_32x32x16_bf16 v[32:47], a[24:27], a[164:167], v[32:47]
    v_mfma_f32_32x32x16_bf16 v[48:63], a[28:31], a[164:167], v[48:63]
    v_mfma_f32_32x32x16_bf16 v[0:15], a[32:35], a[168:171], v[0:15]
    v_mfma_f32_32x32x16_bf16 v[16:31], a[36:39], a[168:171], v[16:31]
    s_mov_b32 s76, 0xa000
    buffer_load_dwordx4 a[232:235], v225, s[52:55], s76 offen offset:0 sc1
    buffer_load_dwordx4 a[236:239], v225, s[52:55], s76 offen offset:1024 sc1
    buffer_load_dwordx2 v[218:219], v216, s[52:55], 0 offen offset:0 sc1
    v_mfma_f32_32x32x16_bf16 v[32:47], a[32:35], a[172:175], v[32:47]
    v_mfma_f32_32x32x16_bf16 v[48:63], a[36:39], a[172:175], v[48:63]
    s_waitcnt vmcnt(18)
    v_mfma_f32_32x32x16_bf16 v[0:15], a[40:43], a[176:179], v[0:15]
    v_mfma_f32_32x32x16_bf16 v[16:31], a[44:47], a[176:179], v[16:31]
    s_mov_b32 s76, 0xa000
    buffer_load_dwordx4 a[240:243], v225, s[52:55], s76 offen offset:2048 sc1
    buffer_load_dwordx4 a[244:247], v225, s[52:55], s76 offen offset:3072 sc1
    s_waitcnt vmcnt(19)
    v_mfma_f32_32x32x16_bf16 v[32:47], a[40:43], a[180:183], v[32:47]
    v_mfma_f32_32x32x16_bf16 v[48:63], a[44:47], a[180:183], v[48:63]
    s_waitcnt vmcnt(18)
    v_mfma_f32_32x32x16_bf16 v[0:15], a[48:51], a[184:187], v[0:15]
    v_mfma_f32_32x32x16_bf16 v[16:31], a[52:55], a[184:187], v[16:31]
    s_mov_b32 s76, 0xb000
    buffer_load_dwordx4 a[248:251], v225, s[52:55], s76 offen offset:0 sc1
    buffer_load_dwordx4 a[252:255], v225, s[52:55], s76 offen offset:1024 sc1
    s_waitcnt vmcnt(19)
    v_mfma_f32_32x32x16_bf16 v[32:47], a[48:51], a[188:191], v[32:47]
    v_mfma_f32_32x32x16_bf16 v[48:63], a[52:55], a[188:191], v[48:63]
    s_waitcnt vmcnt(18)
    v_mfma_f32_32x32x16_bf16 v[0:15], a[56:59], a[192:195], v[0:15]
    v_mfma_f32_32x32x16_bf16 v[16:31], a[60:63], a[192:195], v[16:31]
    s_mov_b32 s76, 0xb000
    buffer_load_dwordx4 a[72:75], v225, s[52:55], s76 offen offset:2048 sc1
    buffer_load_dwordx4 a[76:79], v225, s[52:55], s76 offen offset:3072 sc1
    s_waitcnt vmcnt(19)
    v_mfma_f32_32x32x16_bf16 v[32:47], a[56:59], a[196:199], v[32:47]
    v_mfma_f32_32x32x16_bf16 v[48:63], a[60:63], a[196:199], v[48:63]
    s_waitcnt vmcnt(16)
    v_mfma_f32_32x32x16_bf16 v[64:79], a[64:67], a[200:203], 0
    ds_read_b64_tr_b16 v[144:145], v236 offset:2048
    ds_read_b64_tr_b16 v[146:147], v236 offset:3072
    ds_read_b64_tr_b16 v[148:149], v237 offset:2048
    ds_read_b64_tr_b16 v[150:151], v237 offset:3072
    v_mfma_f32_32x32x16_bf16 v[80:95], a[68:71], a[200:203], 0
    s_waitcnt vmcnt(6)
    v_cmp_eq_u64 vcc, v[220:221], v[218:219]
    s_nop 0
    s_and_b32 s69, vcc_lo, 0xff00
    s_cmp_eq_u32 s69, 0xff00
    s_cbranch_scc1 L_fl_ok_glu_2
L_fl_loop_glu_2:
    s_sleep 2
    buffer_load_dwordx2 v[218:219], v216, s[52:55], 0 offen sc1
    s_waitcnt vmcnt(0)
    v_cmp_eq_u64 vcc, v[220:221], v[218:219]
    s_add_u32 s84, s84, 1
    s_cmp_gt_u32 s84, 20000
    s_cbranch_scc1 L_fl_ok_glu_2
    s_and_b32 s69, vcc_lo, 0xff00
    s_cmp_eq_u32 s69, 0xff00
    s_cbranch_scc0 L_fl_loop_glu_2
L_fl_ok_glu_2:
    s_mov_b32 s76, 0xc000
    buffer_load_dwordx4 a[80:83], v225, s[52:55], s76 offen offset:0 sc1
    buffer_load_dwordx4 a[84:87], v225, s[52:55], s76 offen offset:1024 sc1
    v_mfma_f32_32x32x16_bf16 v[96:111], a[64:67], a[204:207], 0
    v_mfma_f32_32x32x16_bf16 v[112:127], a[68:71], a[204:207], 0
    s_waitcnt lgkmcnt(2)
    v_mfma_f32_32x32x16_bf16 v[64:79], v[144:147], a[208:211], v[64:79]
    ds_read_b64_tr_b16 v[136:137], v236 offset:4096
    ds_read_b64_tr_b16 v[138:139], v236 offset:5120
    ds_read_b64_tr_b16 v[140:141], v237 offset:4096
    ds_read_b64_tr_b16 v[142:143], v237 offset:5120
    s_waitcnt lgkmcnt(4)
    v_mfma_f32_32x32x16_bf16 v[80:95], v[148:151], a[208:211], v[80:95]
    s_mov_b32 s76, 0xc000
    buffer_load_dwordx4 a[88:91], v225, s[52:55], s76 offen offset:2048 sc1
    buffer_load_dwordx4 a[92:95], v225, s[52:55], s76 offen offset:3072 sc1
    v_mfma_f32_32x32x16_bf16 v[96:111], v[144:147], a[212:215], v[96:111]
    v_mfma_f32_32x32x16_bf16 v[112:127], v[148:151], a[212:215], v[112:127]
    s_waitcnt lgkmcnt(2)
    v_mfma_f32_32x32x16_bf16 v[64:79], v[136:139], a[216:219], v[64:79]
    ds_read_b64_tr_b16 v[144:145], v236 offset:6144
    ds_read_b64_tr_b16 v[146:147], v236 offset:7168
    ds_read_b64_tr_b16 v[148:149], v237 offset:6144
    ds_read_b64_tr_b16 v[150:151], v237 offset:7168
    s_waitcnt lgkmcnt(4)
    v_mfma_f32_32x32x16_bf16 v[80:95], v[140:143], a[216:219], v[80:95]
    s_mov_b32 s76, 0xd000
    buffer_load_dwordx4 a[96:99], v225, s[52:55], s76 offen offset:0 sc1
    buffer_load_dwordx4 a[100:103], v225, s[52:55], s76 offen offset:1024 sc1
    v_mfma_f32_32x32x16_bf16 v[96:111], v[136:139], a[220:223], v[96:111]
    v_mfma_f32_32x32x16_bf16 v[112:127], v[140:143], a[220:223], v[112:127]
    s_waitcnt lgkmcnt(2)
    v_mfma_f32_32x32x16_bf16 v[64:79], v[144:147], a[224:227], v[64:79]
    ds_read_b64_tr_b16 v[136:137], v236 offset:8192
    ds_read_b64_tr_b16 v[138:139], v236 offset:9216
    ds_read_b64_tr_b16 v[140:141], v237 offset:8192
    ds_read_b64_tr_b16 v[142:143], v237 offset:9216
    s_waitcnt lgkmcnt(4)
    v_mfma_f32_32x32x16_bf16 v[80:95], v[148:151], a[224:227], v[80:95]
    s_mov_b32 s76, 0xd000
    buffer_load_dwordx4 a[104:107], v225, s[52:55], s76 offen offset:2048 sc1
    buffer_load_dwordx4 a[108:111], v225, s[52:55], s76 offen offset:3072 sc1
    v_mfma_f32_32x32x16_bf16 v[96:111], v[144:147], a[228:231], v[96:111]
    v_mfma_f32_32x32x16_bf16 v[112:127], v[148:151], a[228:231], v[112:127]
    s_waitcnt lgkmcnt(2)
    v_mfma_f32_32x32x16_bf16 v[64:79], v[136:139], a[232:235], v[64:79]
    ds_read_b64_tr_b16 v[144:145], v236 offset:10240
    ds_read_b64_tr_b16 v[146:147], v236 offset:11264
    ds_read_b64_tr_b16 v[148:149], v237 offset:10240
    ds_read_b64_tr_b16 v[150:151], v237 offset:11264
    s_waitcnt lgkmcnt(4)
    v_mfma_f32_32x32x16_bf16 v[80:95], v[140:143], a[232:235], v[80:95]
    s_mov_b32 s76, 0xe000
    buffer_load_dwordx4 a[112:115], v225, s[52:55], s76 offen offset:0 sc1
    buffer_load_dwordx4 a[116:119], v225, s[52:55], s76 offen offset:1024 sc1
    v_mfma_f32_32x32x16_bf16 v[96:111], v[136:139], a[236:239], v[96:111]
    v_mfma_f32_32x32x16_bf16 v[112:127], v[140:143], a[236:239], v[112:127]
    s_waitcnt vmcnt(15) lgkmcnt(2)
    v_mfma_f32_32x32x16_bf16 v[64:79], v[144:147], a[240:243], v[64:79]
    ds_read_b64_tr_b16 v[136:137], v234 offset:0
    ds_read_b64_tr_b16 v[138:139], v234 offset:1024
    ds_read_b64_tr_b16 v[140:141], v235 offset:0
    ds_read_b64_tr_b16 v[142:143], v235 offset:1024
    s_waitcnt lgkmcnt(4)
    v_mfma_f32_32x32x16_bf16 v[80:95], v[148:151], a[240:243], v[80:95]
    s_mov_b32 s76, 0xe000
    buffer_load_dwordx4 a[120:123], v225, s[52:55], s76 offen offset:2048 sc1
    buffer_load_dwordx4 a[124:127], v225, s[52:55], s76 offen offset:3072 sc1
    s_waitcnt vmcnt(16)
    v_mfma_f32_32x32x16_bf16 v[96:111], v[144:147], a[244:247], v[96:111]
    v_mfma_f32_32x32x16_bf16 v[112:127], v[148:151], a[244:247], v[112:127]
    s_waitcnt vmcnt(15) lgkmcnt(2)
    v_mfma_f32_32x32x16_bf16 v[64:79], v[136:139], a[248:251], v[64:79]
    ds_read_b64_tr_b16 v[144:145], v232 offset:0
    ds_read_b64_tr_b16 v[146:147], v232 offset:1024
    ds_read_b64_tr_b16 v[148:149], v233 offset:0
    ds_read_b64_tr_b16 v[150:151], v233 offset:1024
    s_waitcnt lgkmcnt(4)
    v_mfma_f32_32x32x16_bf16 v[80:95], v[140:143], a[248:251], v[80:95]
    s_mov_b32 s76, 0xf000
    buffer_load_dwordx4 a[128:131], v225, s[52:55], s76 offen offset:0 sc1
    buffer_load_dwordx4 a[132:135], v225, s[52:55], s76 offen offset:1024 sc1
    s_waitcnt vmcnt(16)
    v_mfma_f32_32x32x16_bf16 v[96:111], v[136:139], a[252:255], v[96:111]
    v_mfma_f32_32x32x16_bf16 v[112:127], v[140:143], a[252:255], v[112:127]
    s_waitcnt vmcnt(15) lgkmcnt(2)
    v_mfma_f32_32x32x16_bf16 v[64:79], v[144:147], a[72:75], v[64:79]
    ds_read_b64_tr_b16 v[136:137], v232 offset:2048
    ds_read_b64_tr_b16 v[138:139], v232 offset:3072
    ds_read_b64_tr_b16 v[140:141], v233 offset:2048
    ds_read_b64_tr_b16 v[142:143], v233 offset:3072
    s_waitcnt lgkmcnt(4)
    v_mfma_f32_32x32x16_bf16 v[80:95], v[148:151], a[72:75], v[80:95]
    s_mov_b32 s76, 0xf000
    buffer_load_dwordx4 a[136:139], v225, s[52:55], s76 offen offset:2048 sc1
    buffer_load_dwordx4 a[140:143], v225, s[52:55], s76 offen offset:3072 sc1
    s_waitcnt vmcnt(16)
    v_mfma_f32_32x32x16_bf16 v[96:111], v[144:147], a[76:79], v[96:111]
    v_mfma_f32_32x32x16_bf16 v[112:127], v[148:151], a[76:79], v[112:127]
    s_waitcnt vmcnt(15) lgkmcnt(2)
    v_mfma_f32_32x32x16_bf16 v[0:15], v[136:139], a[80:83], v[0:15]
    ds_read_b64_tr_b16 v[144:145], v232 offset:4096
    ds_read_b64_tr_b16 v[146:147], v232 offset:5120
    ds_read_b64_tr_b16 v[148:149], v233 offset:4096
    ds_read_b64_tr_b16 v[150:151], v233 offset:5120
    s_waitcnt lgkmcnt(4)
    v_mfma_f32_32x32x16_bf16 v[16:31], v[140:143], a[80:83], v[16:31]
    s_mov_b32 s76, 0x10000
    buffer_load_dwordx4 a[144:147], v225, s[52:55], s76 offen offset:0 sc1
    buffer_load_dwordx4 a[148:151], v225, s[52:55], s76 offen offset:1024 sc1
    s_waitcnt vmcnt(16)
    v_mfma_f32_32x32x16_bf16 v[32:47], v[136:139], a[84:87], v[32:47]
    v_mfma_f32_32x32x16_bf16 v[48:63], v[140:143], a[84:87], v[48:63]
    s_waitcnt vmcnt(15) lgkmcnt(2)
    v_mfma_f32_32x32x16_bf16 v[0:15], v[144:147], a[88:91], v[0:15]
    ds_read_b64_tr_b16 v[136:137], v232 offset:6144
    ds_read_b64_tr_b16 v[138:139], v232 offset:7168
    ds_read_b64_tr_b16 v[140:141], v233 offset:6144
    ds_read_b64_tr_b16 v[142:143], v233 offset:7168
    s_waitcnt lgkmcnt(4)
    v_mfma_f32_32x32x16_bf16 v[16:31], v[148:151], a[88:91], v[16:31]
    s_mov_b32 s76, 0x10000
    buffer_load_dwordx4 a[152:155], v225, s[52:55], s76 offen offset:2048 sc1
    buffer_load_dwordx4 a[156:159], v225, s[52:55], s76 offen offset:3072 sc1
    s_waitcnt vmcnt(16)
    v_mfma_f32_32x32x16_bf16 v[32:47], v[144:147], a[92:95], v[32:47]
    v_sub_f32 v208, 1.0, v229
    v_sub_f32 v209, 1.0, v231
    v_mul_f32 v64, v64, v229
    v_mul_f32 v65, v65, v229
    v_mfma_f32_32x32x16_bf16 v[48:63], v[148:151], a[92:95], v[48:63]
    v_mul_f32 v66, v66, v229
    v_mul_f32 v67, v67, v229
    v_mul_f32 v68, v68, v229
    v_mul_f32 v69, v69, v229
    s_waitcnt vmcnt(15) lgkmcnt(2)
    v_mfma_f32_32x32x16_bf16 v[0:15], v[136:139], a[96:99], v[0:15]
    ds_read_b64_tr_b16 v[144:145], v236 offset:0
    ds_read_b64_tr_b16 v[146:147], v236 offset:1024
    ds_read_b64_tr_b16 v[148:149], v237 offset:0
    ds_read_b64_tr_b16 v[150:151], v237 offset:1024
    s_waitcnt lgkmcnt(4)
    v_mfma_f32_32x32x16_bf16 v[16:31], v[140:143], a[96:99], v[16:31]
    s_mov_b32 s76, 0x11000
    buffer_load_dwordx4 a[160:163], v225, s[52:55], s76 offen offset:0 sc1
    buffer_load_dwordx4 a[164:167], v225, s[52:55], s76 offen offset:1024 sc1
    s_waitcnt vmcnt(16)
    v_mfma_f32_32x32x16_bf16 v[32:47], v[136:139], a[100:103], v[32:47]
    v_mul_f32 v70, v70, v229
    v_mul_f32 v71, v71, v229
    v_mul_f32 v72, v72, v229
    v_mul_f32 v73, v73, v229
    v_mfma_f32_32x32x16_bf16 v[48:63], v[140:143], a[100:103], v[48:63]
    v_mul_f32 v74, v74, v229
    v_mul_f32 v75, v75, v229
    v_mul_f32 v76, v76, v229
    v_mul_f32 v77, v77, v229
    s_waitcnt vmcnt(15) lgkmcnt(2)
    v_mfma_f32_32x32x16_bf16 v[0:15], v[144:147], a[104:107], v[0:15]
    ds_read_b64_tr_b16 v[136:137], v232 offset:8192
    ds_read_b64_tr_b16 v[138:139], v232 offset:9216
    ds_read_b64_tr_b16 v[140:141], v233 offset:8192
    ds_read_b64_tr_b16 v[142:143], v233 offset:9216
    s_waitcnt lgkmcnt(4)
    v_mfma_f32_32x32x16_bf16 v[16:31], v[148:151], a[104:107], v[16:31]
    s_mov_b32 s76, 0x11000
    buffer_load_dwordx4 a[168:171], v225, s[52:55], s76 offen offset:2048 sc1
    buffer_load_dwordx4 a[172:175], v225, s[52:55], s76 offen offset:3072 sc1
    s_waitcnt vmcnt(16)
    v_mfma_f32_32x32x16_bf16 v[32:47], v[144:147], a[108:111], v[32:47]
    v_mul_f32 v78, v78, v229
    v_mul_f32 v79, v79, v229
    v_mul_f32 v80, v80, v229
    v_mul_f32 v81, v81, v229
    v_mfma_f32_32x32x16_bf16 v[48:63], v[148:151], a[108:111], v[48:63]
    v_mul_f32 v82, v82, v229
    v_mul_f32 v83, v83, v229
    v_mul_f32 v84, v84, v229
    v_mul_f32 v85, v85, v229
    s_waitcnt vmcnt(15) lgkmcnt(2)
    v_mfma_f32_32x32x16_bf16 v[0:15], v[136:139], a[112:115], v[0:15]
    ds_read_b64_tr_b16 v[144:145], v232 offset:10240
    ds_read_b64_tr_b16 v[146:147], v232 offset:11264
    ds_read_b64_tr_b16 v[148:149], v233 offset:10240
    ds_read_b64_tr_b16 v[150:151], v233 offset:11264
    s_waitcnt lgkmcnt(4)
    v_mfma_f32_32x32x16_bf16 v[16:31], v[140:143], a[112:115], v[16:31]
    s_waitcnt vmcnt(14)
    v_mfma_f32_32x32x16_bf16 v[32:47], v[136:139], a[116:119], v[32:47]
    v_mul_f32 v86, v86, v229
    v_mul_f32 v87, v87, v229
    v_mul_f32 v88, v88, v229
    v_mul_f32 v89, v89, v229
    v_mfma_f32_32x32x16_bf16 v[48:63], v[140:143], a[116:119], v[48:63]
    v_mul_f32 v90, v90, v229
    v_mul_f32 v91, v91, v229
    v_mul_f32 v92, v92, v229
    v_mul_f32 v93, v93, v229
    s_waitcnt vmcnt(13) lgkmcnt(2)
    v_mfma_f32_32x32x16_bf16 v[0:15], v[144:147], a[120:123], v[0:15]
    ds_read_b64_tr_b16 v[136:137], v232 offset:12288
    ds_read_b64_tr_b16 v[138:139], v232 offset:13312
    ds_read_b64_tr_b16 v[140:141], v233 offset:12288
    ds_read_b64_tr_b16 v[142:143], v233 offset:13312
    s_waitcnt lgkmcnt(4)
    v_mfma_f32_32x32x16_bf16 v[16:31], v[148:151], a[120:123], v[16:31]
    s_waitcnt vmcnt(12)
    v_mfma_f32_32x32x16_bf16 v[32:47], v[144:147], a[124:127], v[32:47]
    v_mul_f32 v94, v94, v229
    v_mul_f32 v95, v95, v229
    v_mul_f32 v96, v96, v231
    v_mul_f32 v97, v97, v231
    v_mfma_f32_32x32x16_bf16 v[48:63], v[148:151], a[124:127], v[48:63]
    v_mul_f32 v98, v98, v231
    v_mul_f32 v99, v99, v231
    v_mul_f32 v100, v100, v231
    v_mul_f32 v101, v101, v231
    s_waitcnt vmcnt(11) lgkmcnt(2)
    v_mfma_f32_32x32x16_bf16 v[0:15], v[136:139], a[128:131], v[0:15]
    ds_read_b64_tr_b16 v[144:145], v232 offset:14336
    ds_read_b64_tr_b16 v[146:147], v232 offset:15360
    ds_read_b64_tr_b16 v[148:149], v233 offset:14336
    ds_read_b64_tr_b16 v[150:151], v233 offset:15360
    s_waitcnt lgkmcnt(4)
    v_mfma_f32_32x32x16_bf16 v[16:31], v[140:143], a[128:131], v[16:31]
    s_waitcnt vmcnt(10)
    v_mfma_f32_32x32x16_bf16 v[32:47], v[136:139], a[132:135], v[32:47]
    v_mul_f32 v102, v102, v231
    v_mul_f32 v103, v103, v231
    v_mul_f32 v104, v104, v231
    v_mul_f32 v105, v105, v231
    v_mfma_f32_32x32x16_bf16 v[48:63], v[140:143], a[132:135], v[48:63]
    v_mul_f32 v106, v106, v231
    v_mul_f32 v107, v107, v231
    v_mul_f32 v108, v108, v231
    v_mul_f32 v109, v109, v231
    s_waitcnt vmcnt(9) lgkmcnt(2)
    v_mfma_f32_32x32x16_bf16 v[0:15], v[144:147], a[136:139], v[0:15]
    ds_read_b64_tr_b16 v[136:137], v232 offset:16384
    ds_read_b64_tr_b16 v[138:139], v232 offset:17408
    ds_read_b64_tr_b16 v[140:141], v233 offset:16384
    ds_read_b64_tr_b16 v[142:143], v233 offset:17408
    s_waitcnt lgkmcnt(4)
    v_mfma_f32_32x32x16_bf16 v[16:31], v[148:151], a[136:139], v[16:31]
    s_waitcnt vmcnt(8)
    v_mfma_f32_32x32x16_bf16 v[32:47], v[144:147], a[140:143], v[32:47]
    v_mul_f32 v110, v110, v231
    v_mul_f32 v111, v111, v231
    v_mul_f32 v112, v112, v231
    v_mul_f32 v113, v113, v231
    v_mfma_f32_32x32x16_bf16 v[48:63], v[148:151], a[140:143], v[48:63]
    v_mul_f32 v114, v114, v231
    v_mul_f32 v115, v115, v231
    v_mul_f32 v116, v116, v231
    v_mul_f32 v117, v117, v231
    s_waitcnt vmcnt(7) lgkmcnt(2)
    v_mfma_f32_32x32x16_bf16 v[0:15], v[136:139], a[144:147], v[0:15]
    ds_read_b64_tr_b16 v[144:145], v232 offset:18432
    ds_read_b64_tr_b16 v[146:147], v232 offset:19456
    ds_read_b64_tr_b16 v[148:149], v233 offset:18432
    ds_read_b64_tr_b16 v[150:151], v233 offset:19456
    s_waitcnt lgkmcnt(4)
    v_mfma_f32_32x32x16_bf16 v[16:31], v[140:143], a[144:147], v[16:31]
    s_waitcnt vmcnt(6)
    v_mfma_f32_32x32x16_bf16 v[32:47], v[136:139], a[148:151], v[32:47]
    v_mul_f32 v118, v118, v231
    v_mul_f32 v119, v119, v231
    v_mul_f32 v120, v120, v231
    v_mul_f32 v121, v121, v231
    v_mfma_f32_32x32x16_bf16 v[48:63], v[140:143], a[148:151], v[48:63]
    v_mul_f32 v122, v122, v231
    v_mul_f32 v123, v123, v231
    v_mul_f32 v124, v124, v231
    v_mul_f32 v125, v125, v231
    s_waitcnt vmcnt(5) lgkmcnt(2)
    v_mfma_f32_32x32x16_bf16 v[0:15], v[144:147], a[152:155], v[0:15]
    ds_read_b64_tr_b16 v[136:137], v232 offset:20480
    ds_read_b64_tr_b16 v[138:139], v232 offset:21504
    ds_read_b64_tr_b16 v[140:141], v233 offset:20480
    ds_read_b64_tr_b16 v[142:143], v233 offset:21504
    s_waitcnt lgkmcnt(4)
    v_mfma_f32_32x32x16_bf16 v[16:31], v[148:151], a[152:155], v[16:31]
    s_waitcnt vmcnt(4)
    v_mfma_f32_32x32x16_bf16 v[32:47], v[144:147], a[156:159], v[32:47]
    v_mul_f32 v126, v126, v231
    v_mul_f32 v127, v127, v231
    v_mfma_f32_32x32x16_bf16 v[48:63], v[148:151], a[156:159], v[48:63]
    s_waitcnt vmcnt(3) lgkmcnt(2)
    v_mfma_f32_32x32x16_bf16 v[0:15], v[136:139], a[160:163], v[0:15]
    ds_read_b64_tr_b16 v[144:145], v232 offset:22528
    ds_read_b64_tr_b16 v[146:147], v232 offset:23552
    ds_read_b64_tr_b16 v[148:149], v233 offset:22528
    ds_read_b64_tr_b16 v[150:151], v233 offset:23552
    s_waitcnt lgkmcnt(4)
    v_mfma_f32_32x32x16_bf16 v[16:31], v[140:143], a[160:163], v[16:31]
    s_waitcnt vmcnt(2)
    v_mfma_f32_32x32x16_bf16 v[32:47], v[136:139], a[164:167], v[32:47]
    v_mfma_f32_32x32x16_bf16 v[48:63], v[140:143], a[164:167], v[48:63]
    s_waitcnt vmcnt(1) lgkmcnt(2)
    v_mfma_f32_32x32x16_bf16 v[0:15], v[144:147], a[168:171], v[0:15]
    s_waitcnt lgkmcnt(0)
    v_mfma_f32_32x32x16_bf16 v[16:31], v[148:151], a[168:171], v[16:31]
    s_waitcnt vmcnt(0)
    v_mfma_f32_32x32x16_bf16 v[32:47], v[144:147], a[172:175], v[32:47]
    v_mfma_f32_32x32x16_bf16 v[48:63], v[148:151], a[172:175], v[48:63]
    s_cmp_eq_u32 s60, 0
    s_cbranch_scc0 L_red_glu_1
    s_nop 6
    v_fmac_f32 v80, v16, v208
    v_fmac_f32 v81, v17, v208
    v_fmac_f32 v82, v18, v208
    v_fmac_f32 v83, v19, v208
    v_fmac_f32 v84, v20, v208
    v_fmac_f32 v85, v21, v208
    v_fmac_f32 v86, v22, v208
    v_fmac_f32 v87, v23, v208
    v_fmac_f32 v88, v24, v208
    v_fmac_f32 v89, v25, v208
    v_fmac_f32 v90, v26, v208
    v_fmac_f32 v91, v27, v208
    v_fmac_f32 v92, v28, v208
    v_fmac_f32 v93, v29, v208
    v_fmac_f32 v94, v30, v208
    v_fmac_f32 v95, v31, v208
    ds_write_b128 v226, v[80:83] offset:0
    ds_write_b128 v226, v[84:87] offset:1024
    ds_write_b128 v226, v[88:91] offset:2048
    ds_write_b128 v226, v[92:95] offset:3072
    v_fmac_f32 v96, v32, v209
    v_fmac_f32 v97, v33, v209
    v_fmac_f32 v98, v34, v209
    v_fmac_f32 v99, v35, v209
    v_fmac_f32 v100, v36, v209
    v_fmac_f32 v101, v37, v209
    v_fmac_f32 v102, v38, v209
    v_fmac_f32 v103, v39, v209
    v_fmac_f32 v104, v40, v209
    v_fmac_f32 v105, v41, v209
    v_fmac_f32 v106, v42, v209
    v_fmac_f32 v107, v43, v209
    v_fmac_f32 v108, v44, v209
    v_fmac_f32 v109, v45, v209
    v_fmac_f32 v110, v46, v209
    v_fmac_f32 v111, v47, v209
    ds_write_b128 v226, v[96:99] offset:4096
    ds_write_b128 v226, v[100:103] offset:5120
    ds_write_b128 v226, v[104:107] offset:6144
    ds_write_b128 v226, v[108:111] offset:7168
    v_fmac_f32 v112, v48, v209
    v_fmac_f32 v113, v49, v209
    v_fmac_f32 v114, v50, v209
    v_fmac_f32 v115, v51, v209
    v_fmac_f32 v116, v52, v209
    v_fmac_f32 v117, v53, v209
    v_fmac_f32 v118, v54, v209
    v_fmac_f32 v119, v55, v209
    v_fmac_f32 v120, v56, v209
    v_fmac_f32 v121, v57, v209
    v_fmac_f32 v122, v58, v209
    v_fmac_f32 v123, v59, v209
    v_fmac_f32 v124, v60, v209
    v_fmac_f32 v125, v61, v209
    v_fmac_f32 v126, v62, v209
    v_fmac_f32 v127, v63, v209
    ds_write_b128 v226, v[112:115] offset:8192
    ds_write_b128 v226, v[116:119] offset:9216
    ds_write_b128 v226, v[120:123] offset:10240
    ds_write_b128 v226, v[124:127] offset:11264
    v_fmac_f32 v64, v0, v208
    v_fmac_f32 v65, v1, v208
    v_fmac_f32 v66, v2, v208
    v_fmac_f32 v67, v3, v208
    v_fmac_f32 v68, v4, v208
    v_fmac_f32 v69, v5, v208
    v_fmac_f32 v70, v6, v208
    v_fmac_f32 v71, v7, v208
    v_fmac_f32 v72, v8, v208
    v_fmac_f32 v73, v9, v208
    v_fmac_f32 v74, v10, v208
    v_fmac_f32 v75, v11, v208
    v_fmac_f32 v76, v12, v208
    v_fmac_f32 v77, v13, v208
    v_fmac_f32 v78, v14, v208
    v_fmac_f32 v79, v15, v208
    s_waitcnt lgkmcnt(0)
    s_barrier
    ds_read_b128 v[0:3], v227 offset:20480
    ds_read_b128 v[4:7], v227 offset:21504
    ds_read_b128 v[8:11], v227 offset:22528
    ds_read_b128 v[12:15], v227 offset:23552
    ds_read_b128 v[16:19], v227 offset:28672
    ds_read_b128 v[20:23], v227 offset:29696
    ds_read_b128 v[24:27], v227 offset:30720
    ds_read_b128 v[28:31], v227 offset:31744
    ds_read_b128 v[32:35], v227 offset:36864
    ds_read_b128 v[36:39], v227 offset:37888
    ds_read_b128 v[40:43], v227 offset:38912
    ds_read_b128 v[44:47], v227 offset:39936
    s_waitcnt lgkmcnt(11)
    v_add_f32 v64, v64, v0
    v_add_f32 v65, v65, v1
    v_add_f32 v66, v66, v2
    v_add_f32 v67, v67, v3
    s_waitcnt lgkmcnt(10)
    v_add_f32 v68, v68, v4
    v_add_f32 v69, v69, v5
    v_add_f32 v70, v70, v6
    v_add_f32 v71, v71, v7
    s_waitcnt lgkmcnt(9)
    v_add_f32 v72, v72, v8
    v_add_f32 v73, v73, v9
    v_add_f32 v74, v74, v10
    v_add_f32 v75, v75, v11
    s_waitcnt lgkmcnt(8)
    v_add_f32 v76, v76, v12
    v_add_f32 v77, v77, v13
    v_add_f32 v78, v78, v14
    v_add_f32 v79, v79, v15
    s_waitcnt lgkmcnt(7)
    v_add_f32 v64, v64, v16
    v_add_f32 v65, v65, v17
    v_add_f32 v66, v66, v18
    v_add_f32 v67, v67, v19
    s_waitcnt lgkmcnt(6)
    v_add_f32 v68, v68, v20
    v_add_f32 v69, v69, v21
    v_add_f32 v70, v70, v22
    v_add_f32 v71, v71, v23
    s_waitcnt lgkmcnt(5)
    v_add_f32 v72, v72, v24
    v_add_f32 v73, v73, v25
    v_add_f32 v74, v74, v26
    v_add_f32 v75, v75, v27
    s_waitcnt lgkmcnt(4)
    v_add_f32 v76, v76, v28
    v_add_f32 v77, v77, v29
    v_add_f32 v78, v78, v30
    v_add_f32 v79, v79, v31
    s_waitcnt lgkmcnt(3)
    v_add_f32 v64, v64, v32
    v_add_f32 v65, v65, v33
    v_add_f32 v66, v66, v34
    v_add_f32 v67, v67, v35
    s_waitcnt lgkmcnt(2)
    v_add_f32 v68, v68, v36
    v_add_f32 v69, v69, v37
    v_add_f32 v70, v70, v38
    v_add_f32 v71, v71, v39
    s_waitcnt lgkmcnt(1)
    v_add_f32 v72, v72, v40
    v_add_f32 v73, v73, v41
    v_add_f32 v74, v74, v42
    v_add_f32 v75, v75, v43
    s_waitcnt lgkmcnt(0)
    v_add_f32 v76, v76, v44
    v_add_f32 v77, v77, v45
    v_add_f32 v78, v78, v46
    v_add_f32 v79, v79, v47
    v_cvt_pk_bf16_f32 v64, v64, v65
    v_cvt_pk_bf16_f32 v65, v66, v67
    v_cvt_pk_bf16_f32 v66, v68, v69
    v_cvt_pk_bf16_f32 v67, v70, v71
    v_cvt_pk_bf16_f32 v68, v72, v73
    v_cvt_pk_bf16_f32 v69, v74, v75
    v_cvt_pk_bf16_f32 v70, v76, v77
    v_cvt_pk_bf16_f32 v71, v78, v79
    buffer_store_dwordx4 v[64:67], v228, s[48:51], 0 offen offset:0
    buffer_store_dwordx4 v[68:71], v228, s[48:51], 0 offen offset:16
    s_or_b32 s65, s62, s63
    s_cmp_eq_u32 s65, 0
    s_cbranch_scc0 L_fin_glu
    s_mov_b64 exec, 1
    buffer_store_dwordx2 v[220:221], v222, s[52:55], 0 offen offset:0 sc1
    s_mov_b64 exec, -1
    s_branch L_fin_glu
L_red_glu_1:
    s_cmp_eq_u32 s60, 1
    s_cbranch_scc0 L_red_glu_2
    s_nop 8
    v_fmac_f32 v96, v32, v209
    v_fmac_f32 v97, v33, v209
    v_fmac_f32 v98, v34, v209
    v_fmac_f32 v99, v35, v209
    v_fmac_f32 v100, v36, v209
    v_fmac_f32 v101, v37, v209
    v_fmac_f32 v102, v38, v209
    v_fmac_f32 v103, v39, v209
    v_fmac_f32 v104, v40, v209
    v_fmac_f32 v105, v41, v209
    v_fmac_f32 v106, v42, v209
    v_fmac_f32 v107, v43, v209
    v_fmac_f32 v108, v44, v209
    v_fmac_f32 v109, v45, v209
    v_fmac_f32 v110, v46, v209
    v_fmac_f32 v111, v47, v209
    ds_write_b128 v226, v[96:99] offset:0
    ds_write_b128 v226, v[100:103] offset:1024
    ds_write_b128 v226, v[104:107] offset:2048
    ds_write_b128 v226, v[108:111] offset:3072
    v_fmac_f32 v112, v48, v209
    v_fmac_f32 v113, v49, v209
    v_fmac_f32 v114, v50, v209
    v_fmac_f32 v115, v51, v209
    v_fmac_f32 v116, v52, v209
    v_fmac_f32 v117, v53, v209
    v_fmac_f32 v118, v54, v209
    v_fmac_f32 v119, v55, v209
    v_fmac_f32 v120, v56, v209
    v_fmac_f32 v121, v57, v209
    v_fmac_f32 v122, v58, v209
    v_fmac_f32 v123, v59, v209
    v_fmac_f32 v124, v60, v209
    v_fmac_f32 v125, v61, v209
    v_fmac_f32 v126, v62, v209
    v_fmac_f32 v127, v63, v209
    ds_write_b128 v226, v[112:115] offset:4096
    ds_write_b128 v226, v[116:119] offset:5120
    ds_write_b128 v226, v[120:123] offset:6144
    ds_write_b128 v226, v[124:127] offset:7168
    v_fmac_f32 v64, v0, v208
    v_fmac_f32 v65, v1, v208
    v_fmac_f32 v66, v2, v208
    v_fmac_f32 v67, v3, v208
    v_fmac_f32 v68, v4, v208
    v_fmac_f32 v69, v5, v208
    v_fmac_f32 v70, v6, v208
    v_fmac_f32 v71, v7, v208
    v_fmac_f32 v72, v8, v208
    v_fmac_f32 v73, v9, v208
    v_fmac_f32 v74, v10, v208
    v_fmac_f32 v75, v11, v208
    v_fmac_f32 v76, v12, v208
    v_fmac_f32 v77, v13, v208
    v_fmac_f32 v78, v14, v208
    v_fmac_f32 v79, v15, v208
    ds_write_b128 v226, v[64:67] offset:8192
    ds_write_b128 v226, v[68:71] offset:9216
    ds_write_b128 v226, v[72:75] offset:10240
    ds_write_b128 v226, v[76:79] offset:11264
    v_fmac_f32 v80, v16, v208
    v_fmac_f32 v81, v17, v208
    v_fmac_f32 v82, v18, v208
    v_fmac_f32 v83, v19, v208
    v_fmac_f32 v84, v20, v208
    v_fmac_f32 v85, v21, v208
    v_fmac_f32 v86, v22, v208
    v_fmac_f32 v87, v23, v208
    v_fmac_f32 v88, v24, v208
    v_fmac_f32 v89, v25, v208
    v_fmac_f32 v90, v26, v208
    v_fmac_f32 v91, v27, v208
    v_fmac_f32 v92, v28, v208
    v_fmac_f32 v93, v29, v208
    v_fmac_f32 v94, v30, v208
    v_fmac_f32 v95, v31, v208
    s_waitcnt lgkmcnt(0)
    s_barrier
    ds_read_b128 v[0:3], v227 offset:0
    ds_read_b128 v[4:7], v227 offset:1024
    ds_read_b128 v[8:11], v227 offset:2048
    ds_read_b128 v[12:15], v227 offset:3072
    ds_read_b128 v[16:19], v227 offset:32768
    ds_read_b128 v[20:23], v227 offset:33792
    ds_read_b128 v[24:27], v227 offset:34816
    ds_read_b128 v[28:31], v227 offset:35840
    ds_read_b128 v[32:35], v227 offset:40960
    ds_read_b128 v[36:39], v227 offset:41984
    ds_read_b128 v[40:43], v227 offset:43008
    ds_read_b128 v[44:47], v227 offset:44032
    s_waitcnt lgkmcnt(11)
    v_add_f32 v80, v80, v0
    v_add_f32 v81, v81, v1
    v_add_f32 v82, v82, v2
    v_add_f32 v83, v83, v3
    s_waitcnt lgkmcnt(10)
    v_add_f32 v84, v84, v4
    v_add_f32 v85, v85, v5
    v_add_f32 v86, v86, v6
    v_add_f32 v87, v87, v7
    s_waitcnt lgkmcnt(9)
    v_add_f32 v88, v88, v8
    v_add_f32 v89, v89, v9
    v_add_f32 v90, v90, v10
    v_add_f32 v91, v91, v11
    s_waitcnt lgkmcnt(8)
    v_add_f32 v92, v92, v12
    v_add_f32 v93, v93, v13
    v_add_f32 v94, v94, v14
    v_add_f32 v95, v95, v15
    s_waitcnt lgkmcnt(7)
    v_add_f32 v80, v80, v16
    v_add_f32 v81, v81, v17
    v_add_f32 v82, v82, v18
    v_add_f32 v83, v83, v19
    s_waitcnt lgkmcnt(6)
    v_add_f32 v84, v84, v20
    v_add_f32 v85, v85, v21
    v_add_f32 v86, v86, v22
    v_add_f32 v87, v87, v23
    s_waitcnt lgkmcnt(5)
    v_add_f32 v88, v88, v24
    v_add_f32 v89, v89, v25
    v_add_f32 v90, v90, v26
    v_add_f32 v91, v91, v27
    s_waitcnt lgkmcnt(4)
    v_add_f32 v92, v92, v28
    v_add_f32 v93, v93, v29
    v_add_f32 v94, v94, v30
    v_add_f32 v95, v95, v31
    s_waitcnt lgkmcnt(3)
    v_add_f32 v80, v80, v32
    v_add_f32 v81, v81, v33
    v_add_f32 v82, v82, v34
    v_add_f32 v83, v83, v35
    s_waitcnt lgkmcnt(2)
    v_add_f32 v84, v84, v36
    v_add_f32 v85, v85, v37
    v_add_f32 v86, v86, v38
    v_add_f32 v87, v87, v39
    s_waitcnt lgkmcnt(1)
    v_add_f32 v88, v88, v40
    v_add_f32 v89, v89, v41
    v_add_f32 v90, v90, v42
    v_add_f32 v91, v91, v43
    s_waitcnt lgkmcnt(0)
    v_add_f32 v92, v92, v44
    v_add_f32 v93, v93, v45
    v_add_f32 v94, v94, v46
    v_add_f32 v95, v95, v47
    v_cvt_pk_bf16_f32 v80, v80, v81
    v_cvt_pk_bf16_f32 v81, v82, v83
    v_cvt_pk_bf16_f32 v82, v84, v85
    v_cvt_pk_bf16_f32 v83, v86, v87
    v_cvt_pk_bf16_f32 v84, v88, v89
    v_cvt_pk_bf16_f32 v85, v90, v91
    v_cvt_pk_bf16_f32 v86, v92, v93
    v_cvt_pk_bf16_f32 v87, v94, v95
    buffer_store_dwordx4 v[80:83], v228, s[48:51], 0 offen offset:0
    buffer_store_dwordx4 v[84:87], v228, s[48:51], 0 offen offset:16
    s_branch L_fin_glu
L_red_glu_2:
    s_cmp_eq_u32 s60, 2
    s_cbranch_scc0 L_red_glu_3
    s_nop 9
    v_fmac_f32 v112, v48, v209
    v_fmac_f32 v113, v49, v209
    v_fmac_f32 v114, v50, v209
    v_fmac_f32 v115, v51, v209
    v_fmac_f32 v116, v52, v209
    v_fmac_f32 v117, v53, v209
    v_fmac_f32 v118, v54, v209
    v_fmac_f32 v119, v55, v209
    v_fmac_f32 v120, v56, v209
    v_fmac_f32 v121, v57, v209
    v_fmac_f32 v122, v58, v209
    v_fmac_f32 v123, v59, v209
    v_fmac_f32 v124, v60, v209
    v_fmac_f32 v125, v61, v209
    v_fmac_f32 v126, v62, v209
    v_fmac_f32 v127, v63, v209
    ds_write_b128 v226, v[112:115] offset:0
    ds_write_b128 v226, v[116:119] offset:1024
    ds_write_b128 v226, v[120:123] offset:2048
    ds_write_b128 v226, v[124:127] offset:3072
    v_fmac_f32 v64, v0, v208
    v_fmac_f32 v65, v1, v208
    v_fmac_f32 v66, v2, v208
    v_fmac_f32 v67, v3, v208
    v_fmac_f32 v68, v4, v208
    v_fmac_f32 v69, v5, v208
    v_fmac_f32 v70, v6, v208
    v_fmac_f32 v71, v7, v208
    v_fmac_f32 v72, v8, v208
    v_fmac_f32 v73, v9, v208
    v_fmac_f32 v74, v10, v208
    v_fmac_f32 v75, v11, v208
    v_fmac_f32 v76, v12, v208
    v_fmac_f32 v77, v13, v208
    v_fmac_f32 v78, v14, v208
    v_fmac_f32 v79, v15, v208
    ds_write_b128 v226, v[64:67] offset:4096
    ds_write_b128 v226, v[68:71] offset:5120
    ds_write_b128 v226, v[72:75] offset:6144
    ds_write_b128 v226, v[76:79] offset:7168
    v_fmac_f32 v80, v16, v208
    v_fmac_f32 v81, v17, v208
    v_fmac_f32 v82, v18, v208
    v_fmac_f32 v83, v19, v208
    v_fmac_f32 v84, v20, v208
    v_fmac_f32 v85, v21, v208
    v_fmac_f32 v86, v22, v208
    v_fmac_f32 v87, v23, v208
    v_fmac_f32 v88, v24, v208
    v_fmac_f32 v89, v25, v208
    v_fmac_f32 v90, v26, v208
    v_fmac_f32 v91, v27, v208
    v_fmac_f32 v92, v28, v208
    v_fmac_f32 v93, v29, v208
    v_fmac_f32 v94, v30, v208
    v_fmac_f32 v95, v31, v208
    ds_write_b128 v226, v[80:83] offset:8192
    ds_write_b128 v226, v[84:87] offset:9216
    ds_write_b128 v226, v[88:91] offset:10240
    ds_write_b128 v226, v[92:95] offset:11264
    v_fmac_f32 v96, v32, v209
    v_fmac_f32 v97, v33, v209
    v_fmac_f32 v98, v34, v209
    v_fmac_f32 v99, v35, v209
    v_fmac_f32 v100, v36, v209
    v_fmac_f32 v101, v37, v209
    v_fmac_f32 v102, v38, v209
    v_fmac_f32 v103, v39, v209
    v_fmac_f32 v104, v40, v209
    v_fmac_f32 v105, v41, v209
    v_fmac_f32 v106, v42, v209
    v_fmac_f32 v107, v43, v209
    v_fmac_f32 v108, v44, v209
    v_fmac_f32 v109, v45, v209
    v_fmac_f32 v110, v46, v209
    v_fmac_f32 v111, v47, v209
    s_waitcnt lgkmcnt(0)
    s_barrier
    ds_read_b128 v[0:3], v227 offset:4096
    ds_read_b128 v[4:7], v227 offset:5120
    ds_read_b128 v[8:11], v227 offset:6144
    ds_read_b128 v[12:15], v227 offset:7168
    ds_read_b128 v[16:19], v227 offset:12288
    ds_read_b128 v[20:23], v227 offset:13312
    ds_read_b128 v[24:27], v227 offset:14336
    ds_read_b128 v[28:31], v227 offset:15360
    ds_read_b128 v[32:35], v227 offset:45056
    ds_read_b128 v[36:39], v227 offset:46080
    ds_read_b128 v[40:43], v227 offset:47104
    ds_read_b128 v[44:47], v227 offset:48128
    s_waitcnt lgkmcnt(11)
    v_add_f32 v96, v96, v0
    v_add_f32 v97, v97, v1
    v_add_f32 v98, v98, v2
    v_add_f32 v99, v99, v3
    s_waitcnt lgkmcnt(10)
    v_add_f32 v100, v100, v4
    v_add_f32 v101, v101, v5
    v_add_f32 v102, v102, v6
    v_add_f32 v103, v103, v7
    s_waitcnt lgkmcnt(9)
    v_add_f32 v104, v104, v8
    v_add_f32 v105, v105, v9
    v_add_f32 v106, v106, v10
    v_add_f32 v107, v107, v11
    s_waitcnt lgkmcnt(8)
    v_add_f32 v108, v108, v12
    v_add_f32 v109, v109, v13
    v_add_f32 v110, v110, v14
    v_add_f32 v111, v111, v15
    s_waitcnt lgkmcnt(7)
    v_add_f32 v96, v96, v16
    v_add_f32 v97, v97, v17
    v_add_f32 v98, v98, v18
    v_add_f32 v99, v99, v19
    s_waitcnt lgkmcnt(6)
    v_add_f32 v100, v100, v20
    v_add_f32 v101, v101, v21
    v_add_f32 v102, v102, v22
    v_add_f32 v103, v103, v23
    s_waitcnt lgkmcnt(5)
    v_add_f32 v104, v104, v24
    v_add_f32 v105, v105, v25
    v_add_f32 v106, v106, v26
    v_add_f32 v107, v107, v27
    s_waitcnt lgkmcnt(4)
    v_add_f32 v108, v108, v28
    v_add_f32 v109, v109, v29
    v_add_f32 v110, v110, v30
    v_add_f32 v111, v111, v31
    s_waitcnt lgkmcnt(3)
    v_add_f32 v96, v96, v32
    v_add_f32 v97, v97, v33
    v_add_f32 v98, v98, v34
    v_add_f32 v99, v99, v35
    s_waitcnt lgkmcnt(2)
    v_add_f32 v100, v100, v36
    v_add_f32 v101, v101, v37
    v_add_f32 v102, v102, v38
    v_add_f32 v103, v103, v39
    s_waitcnt lgkmcnt(1)
    v_add_f32 v104, v104, v40
    v_add_f32 v105, v105, v41
    v_add_f32 v106, v106, v42
    v_add_f32 v107, v107, v43
    s_waitcnt lgkmcnt(0)
    v_add_f32 v108, v108, v44
    v_add_f32 v109, v109, v45
    v_add_f32 v110, v110, v46
    v_add_f32 v111, v111, v47
    v_cvt_pk_bf16_f32 v96, v96, v97
    v_cvt_pk_bf16_f32 v97, v98, v99
    v_cvt_pk_bf16_f32 v98, v100, v101
    v_cvt_pk_bf16_f32 v99, v102, v103
    v_cvt_pk_bf16_f32 v100, v104, v105
    v_cvt_pk_bf16_f32 v101, v106, v107
    v_cvt_pk_bf16_f32 v102, v108, v109
    v_cvt_pk_bf16_f32 v103, v110, v111
    buffer_store_dwordx4 v[96:99], v228, s[48:51], 0 offen offset:0
    buffer_store_dwordx4 v[100:103], v228, s[48:51], 0 offen offset:16
    s_branch L_fin_glu
L_red_glu_3:
    s_nop 6
    v_fmac_f32 v64, v0, v208
    v_fmac_f32 v65, v1, v208
    v_fmac_f32 v66, v2, v208
    v_fmac_f32 v67, v3, v208
    v_fmac_f32 v68, v4, v208
    v_fmac_f32 v69, v5, v208
    v_fmac_f32 v70, v6, v208
    v_fmac_f32 v71, v7, v208
    v_fmac_f32 v72, v8, v208
    v_fmac_f32 v73, v9, v208
    v_fmac_f32 v74, v10, v208
    v_fmac_f32 v75, v11, v208
    v_fmac_f32 v76, v12, v208
    v_fmac_f32 v77, v13, v208
    v_fmac_f32 v78, v14, v208
    v_fmac_f32 v79, v15, v208
    ds_write_b128 v226, v[64:67] offset:0
    ds_write_b128 v226, v[68:71] offset:1024
    ds_write_b128 v226, v[72:75] offset:2048
    ds_write_b128 v226, v[76:79] offset:3072
    v_fmac_f32 v80, v16, v208
    v_fmac_f32 v81, v17, v208
    v_fmac_f32 v82, v18, v208
    v_fmac_f32 v83, v19, v208
    v_fmac_f32 v84, v20, v208
    v_fmac_f32 v85, v21, v208
    v_fmac_f32 v86, v22, v208
    v_fmac_f32 v87, v23, v208
    v_fmac_f32 v88, v24, v208
    v_fmac_f32 v89, v25, v208
    v_fmac_f32 v90, v26, v208
    v_fmac_f32 v91, v27, v208
    v_fmac_f32 v92, v28, v208
    v_fmac_f32 v93, v29, v208
    v_fmac_f32 v94, v30, v208
    v_fmac_f32 v95, v31, v208
    ds_write_b128 v226, v[80:83] offset:4096
    ds_write_b128 v226, v[84:87] offset:5120
    ds_write_b128 v226, v[88:91] offset:6144
    ds_write_b128 v226, v[92:95] offset:7168
    v_fmac_f32 v96, v32, v209
    v_fmac_f32 v97, v33, v209
    v_fmac_f32 v98, v34, v209
    v_fmac_f32 v99, v35, v209
    v_fmac_f32 v100, v36, v209
    v_fmac_f32 v101, v37, v209
    v_fmac_f32 v102, v38, v209
    v_fmac_f32 v103, v39, v209
    v_fmac_f32 v104, v40, v209
    v_fmac_f32 v105, v41, v209
    v_fmac_f32 v106, v42, v209
    v_fmac_f32 v107, v43, v209
    v_fmac_f32 v108, v44, v209
    v_fmac_f32 v109, v45, v209
    v_fmac_f32 v110, v46, v209
    v_fmac_f32 v111, v47, v209
    ds_write_b128 v226, v[96:99] offset:8192
    ds_write_b128 v226, v[100:103] offset:9216
    ds_write_b128 v226, v[104:107] offset:10240
    ds_write_b128 v226, v[108:111] offset:11264
    v_fmac_f32 v112, v48, v209
    v_fmac_f32 v113, v49, v209
    v_fmac_f32 v114, v50, v209
    v_fmac_f32 v115, v51, v209
    v_fmac_f32 v116, v52, v209
    v_fmac_f32 v117, v53, v209
    v_fmac_f32 v118, v54, v209
    v_fmac_f32 v119, v55, v209
    v_fmac_f32 v120, v56, v209
    v_fmac_f32 v121, v57, v209
    v_fmac_f32 v122, v58, v209
    v_fmac_f32 v123, v59, v209
    v_fmac_f32 v124, v60, v209
    v_fmac_f32 v125, v61, v209
    v_fmac_f32 v126, v62, v209
    v_fmac_f32 v127, v63, v209
    s_waitcnt lgkmcnt(0)
    s_barrier
    ds_read_b128 v[0:3], v227 offset:8192
    ds_read_b128 v[4:7], v227 offset:9216
    ds_read_b128 v[8:11], v227 offset:10240
    ds_read_b128 v[12:15], v227 offset:11264
    ds_read_b128 v[16:19], v227 offset:16384
    ds_read_b128 v[20:23], v227 offset:17408
    ds_read_b128 v[24:27], v227 offset:18432
    ds_read_b128 v[28:31], v227 offset:19456
    ds_read_b128 v[32:35], v227 offset:24576
    ds_read_b128 v[36:39], v227 offset:25600
    ds_read_b128 v[40:43], v227 offset:26624
    ds_read_b128 v[44:47], v227 offset:27648
    s_waitcnt lgkmcnt(11)
    v_add_f32 v112, v112, v0
    v_add_f32 v113, v113, v1
    v_add_f32 v114, v114, v2
    v_add_f32 v115, v115, v3
    s_waitcnt lgkmcnt(10)
    v_add_f32 v116, v116, v4
    v_add_f32 v117, v117, v5
    v_add_f32 v118, v118, v6
    v_add_f32 v119, v119, v7
    s_waitcnt lgkmcnt(9)
    v_add_f32 v120, v120, v8
    v_add_f32 v121, v121, v9
    v_add_f32 v122, v122, v10
    v_add_f32 v123, v123, v11
    s_waitcnt lgkmcnt(8)
    v_add_f32 v124, v124, v12
    v_add_f32 v125, v125, v13
    v_add_f32 v126, v126, v14
    v_add_f32 v127, v127, v15
    s_waitcnt lgkmcnt(7)
    v_add_f32 v112, v112, v16
    v_add_f32 v113, v113, v17
    v_add_f32 v114, v114, v18
    v_add_f32 v115, v115, v19
    s_waitcnt lgkmcnt(6)
    v_add_f32 v116, v116, v20
    v_add_f32 v117, v117, v21
    v_add_f32 v118, v118, v22
    v_add_f32 v119, v119, v23
    s_waitcnt lgkmcnt(5)
    v_add_f32 v120, v120, v24
    v_add_f32 v121, v121, v25
    v_add_f32 v122, v122, v26
    v_add_f32 v123, v123, v27
    s_waitcnt lgkmcnt(4)
    v_add_f32 v124, v124, v28
    v_add_f32 v125, v125, v29
    v_add_f32 v126, v126, v30
    v_add_f32 v127, v127, v31
    s_waitcnt lgkmcnt(3)
    v_add_f32 v112, v112, v32
    v_add_f32 v113, v113, v33
    v_add_f32 v114, v114, v34
    v_add_f32 v115, v115, v35
    s_waitcnt lgkmcnt(2)
    v_add_f32 v116, v116, v36
    v_add_f32 v117, v117, v37
    v_add_f32 v118, v118, v38
    v_add_f32 v119, v119, v39
    s_waitcnt lgkmcnt(1)
    v_add_f32 v120, v120, v40
    v_add_f32 v121, v121, v41
    v_add_f32 v122, v122, v42
    v_add_f32 v123, v123, v43
    s_waitcnt lgkmcnt(0)
    v_add_f32 v124, v124, v44
    v_add_f32 v125, v125, v45
    v_add_f32 v126, v126, v46
    v_add_f32 v127, v127, v47
    v_cvt_pk_bf16_f32 v112, v112, v113
    v_cvt_pk_bf16_f32 v113, v114, v115
    v_cvt_pk_bf16_f32 v114, v116, v117
    v_cvt_pk_bf16_f32 v115, v118, v119
    v_cvt_pk_bf16_f32 v116, v120, v121
    v_cvt_pk_bf16_f32 v117, v122, v123
    v_cvt_pk_bf16_f32 v118, v124, v125
    v_cvt_pk_bf16_f32 v119, v126, v127
    buffer_store_dwordx4 v[112:115], v228, s[48:51], 0 offen offset:0
    buffer_store_dwordx4 v[116:119], v228, s[48:51], 0 offen offset:16
L_fin_glu:
    s_endpgm
L_h2:
    s_waitcnt lgkmcnt(5)
    v_mfma_f32_32x32x16_bf16 v[0:15], a[224:227], a[0:3], 0
    ds_read_b128 a[8:11], v233 offset:0
    ds_read_b64_tr_b16 a[236:237], v236 offset:3072
    ds_read_b64_tr_b16 a[238:239], v236 offset:3840
    s_add_u32 m0, s70, 0x3000
    s_add_u32 s75, s5, 0x7000
    buffer_load_dwordx4 v225, s[28:31], s75 offen lds
    s_waitcnt lgkmcnt(7)
    v_mfma_f32_32x32x16_bf16 v[16:31], a[224:227], a[4:7], 0
    s_mov_b64 exec, s[78:79]
    ds_read_b128 a[236:239], v255 offset:32
    s_mov_b64 exec, -1
    s_add_u32 m0, s70, 0x3400
    s_add_u32 s75, s5, 0x7000
    buffer_load_dwordx4 v226, s[28:31], s75 offen lds
    s_waitcnt lgkmcnt(6)
    v_mfma_f32_32x32x16_bf16 v[32:47], a[228:231], a[0:3], 0
    ds_read_b128 a[12:15], v233 offset:4096
    ds_read_b64_tr_b16 a[240:241], v236 offset:3136
    ds_read_b64_tr_b16 a[242:243], v236 offset:3904
    s_add_u32 m0, s73, 0x1000
    s_nop 0
    buffer_load_dwordx4 v231, s[28:31], s5 offen lds
    v_mfma_f32_32x32x16_bf16 v[48:63], a[228:231], a[4:7], 0
    ds_read_b64_tr_b16 a[244:245], v236 offset:3200
    ds_read_b64_tr_b16 a[246:247], v236 offset:3968
    ds_read_b128 a[248:251], v238 offset:0
    s_add_u32 m0, s70, 0x3800
    s_add_u32 s75, s5, 0xa800
    buffer_load_dwordx4 v225, s[28:31], s75 offen lds
    s_waitcnt lgkmcnt(10)
    v_mfma_f32_32x32x16_bf16 v[64:79], a[0:3], a[232:235], 0
    ds_read_b64_tr_b16 v[192:193], v237 offset:64
    ds_read_b64_tr_b16 v[194:195], v237 offset:832
    s_add_u32 m0, s70, 0x3c00
    s_add_u32 s75, s5, 0xa800
    buffer_load_dwordx4 v226, s[28:31], s75 offen lds
    v_mfma_f32_32x32x16_bf16 v[80:95], a[4:7], a[232:235], 0
    ds_read_b64_tr_b16 v[196:197], v237 offset:128
    ds_read_b64_tr_b16 v[198:199], v237 offset:896
    s_add_u32 m0, s71, 0x6200
    s_mul_i32 s75, s6, 0x540
    buffer_load_dwordx4 v227, s[32:35], s75 offen lds
    s_waitcnt lgkmcnt(10)
    v_mfma_f32_32x32x16_bf16 v[0:15], a[236:239], a[8:11], v[0:15]
    ds_read_b128 a[16:19], v234 offset:0
    ds_read_b64_tr_b16 a[224:225], v236 offset:6144
    s_add_u32 m0, s70, 0x4000
    s_nop 0
    buffer_load_dwordx4 v225, s[28:31], s6 offen lds
    s_mov_b32 s56, s16
    s_waitcnt lgkmcnt(11)
    v_mfma_f32_32x32x16_bf16 v[16:31], a[236:239], a[12:15], v[16:31]
    ds_read_b64_tr_b16 a[226:227], v236 offset:6912
    s_mov_b64 exec, s[78:79]
    ds_read_b128 a[224:227], v255 offset:64
    s_mov_b64 exec, -1
    s_add_u32 m0, s70, 0x4400
    s_nop 0
    buffer_load_dwordx4 v226, s[28:31], s6 offen lds
    s_waitcnt lgkmcnt(11)
    v_mfma_f32_32x32x16_bf16 v[32:47], a[240:243], a[8:11], v[32:47]
    ds_read_b128 a[20:23], v234 offset:4096
    ds_read_b64_tr_b16 a[228:229], v236 offset:6208
    s_add_u32 m0, s71, 0x6600
    s_mul_i32 s75, s6, 0x540
    buffer_load_dwordx4 v228, s[32:35], s75 offen lds
    v_mfma_f32_32x32x16_bf16 v[48:63], a[240:243], a[12:15], v[48:63]
    ds_read_b64_tr_b16 a[230:231], v236 offset:6976
    ds_read_b64_tr_b16 a[232:233], v236 offset:6272
    s_add_u32 m0, s70, 0x4800
    s_add_u32 s75, s6, 0x3800
    buffer_load_dwordx4 v225, s[28:31], s75 offen lds
    s_waitcnt lgkmcnt(13)
    v_mfma_f32_32x32x16_bf16 v[64:79], a[8:11], a[244:247], v[64:79]
    ds_read_b64_tr_b16 a[234:235], v236 offset:7040
    s_add_u32 m0, s70, 0x4c00
    s_add_u32 s75, s6, 0x3800
    buffer_load_dwordx4 v226, s[28:31], s75 offen lds
    s_mov_b32 s57, s17
    v_mfma_f32_32x32x16_bf16 v[80:95], a[12:15], a[244:247], v[80:95]
    s_add_u32 m0, s71, 0x6a00
    s_mul_i32 s75, s6, 0x540
    buffer_load_dwordx4 v229, s[32:35], s75 offen lds
    s_mov_b32 s58, 0x188000
    s_mov_b32 s59, 0x20000
    s_waitcnt lgkmcnt(5)
    v_mfma_f32_32x32x16_bf16 v[0:15], a[224:227], a[16:19], v[0:15]
    ds_read_b128 a[24:27], v235 offset:0
    ds_read_b64_tr_b16 a[236:237], v236 offset:9216
    ds_read_b64_tr_b16 a[238:239], v236 offset:9984
    s_add_u32 m0, s70, 0x5000
    s_add_u32 s75, s6, 0x7000
    buffer_load_dwordx4 v225, s[28:31], s75 offen lds
    s_waitcnt lgkmcnt(7)
    v_mfma_f32_32x32x16_bf16 v[16:31], a[224:227], a[20:23], v[16:31]
    s_mov_b64 exec, s[78:79]
    ds_read_b128 a[236:239], v255 offset:96
    s_mov_b64 exec, -1
    s_lshr_b32 s64, s2, 3
    s_and_b32 s65, s2, 7
    s_waitcnt lgkmcnt(6)
    v_mfma_f32_32x32x16_bf16 v[32:47], a[228:231], a[16:19], v[32:47]
    ds_read_b128 a[28:31], v235 offset:4096
    ds_read_b64_tr_b16 a[240:241], v236 offset:9280
    ds_read_b64_tr_b16 a[242:243], v236 offset:10048
    s_add_u32 m0, s70, 0x5400
    s_add_u32 s75, s6, 0x7000
    buffer_load_dwordx4 v226, s[28:31], s75 offen lds
    v_mfma_f32_32x32x16_bf16 v[48:63], a[228:231], a[20:23], v[48:63]
    ds_read_b64_tr_b16 a[244:245], v236 offset:9344
    ds_read_b64_tr_b16 a[246:247], v236 offset:10112
    s_lshl_b32 s76, s2, 2
    s_add_u32 s76, s76, s60
    s_mul_i32 s76, s76, 0x680
    v_min_u32 v217, 12, v247
    v_lshlrev_b32 v217, 7, v217
    buffer_load_dword v217, v217, s[56:59], s76 offen offset:0
    s_waitcnt lgkmcnt(9)
    v_mfma_f32_32x32x16_bf16 v[64:79], a[16:19], a[232:235], v[64:79]
    s_lshl_b32 s76, s2, 2
    s_add_u32 s76, s76, s60
    s_lshl_b32 s76, s76, 9
    v_min_u32 v215, 3, v247
    v_lshlrev_b32 v215, 7, v215
    buffer_load_dword v215, v215, s[40:43], s76 offen offset:0
    s_add_u32 m0, s73, 0x2000
    s_nop 0
    buffer_load_dwordx4 v231, s[28:31], s6 offen lds
    v_mfma_f32_32x32x16_bf16 v[80:95], a[20:23], a[232:235], v[80:95]
    s_add_u32 m0, s70, 0x5800
    s_add_u32 s75, s6, 0xa800
    buffer_load_dwordx4 v225, s[28:31], s75 offen lds
    s_lshl_b32 s65, s65, 2
    s_add_u32 s64, s64, s65
    v_mfma_f32_32x32x16_bf16 v[96:111], v[192:195], a[248:251], 0
    s_and_b32 s64, s64, 31
    s_lshl_b32 s64, s64, 2
    s_add_u32 s64, s64, s60
    v_min_u32 v206, 24, v247
    v_lshlrev_b32 v206, 7, v206
    v_mfma_f32_32x32x16_bf16 v[112:127], a[248:251], v[196:199], 0
    s_add_u32 m0, s70, 0x5c00
    s_add_u32 s75, s6, 0xa800
    buffer_load_dwordx4 v226, s[28:31], s75 offen lds
    s_mul_i32 s65, s64, 0x3100
    v_add_u32 v213, s65, v206
    s_waitcnt lgkmcnt(5)
    v_mfma_f32_32x32x16_bf16 v[0:15], a[236:239], a[24:27], v[0:15]
    s_mul_i32 s65, s64, 0xc80
    v_add_u32 v214, s65, v206
    s_and_b32 s64, s60, 1
    s_lshl_b32 s64, s64, 5
    s_and_b32 s65, s60, 2
    s_waitcnt lgkmcnt(4)
    v_mfma_f32_32x32x16_bf16 v[16:31], a[236:239], a[28:31], v[16:31]
    s_waitcnt lgkmcnt(0)
    s_waitcnt vmcnt(14)
    s_barrier
    v_add_u32 v255, s5, v243
    ds_read_b128 a[32:35], v232 offset:8192
    ds_read_b64_tr_b16 a[224:225], v236 offset:12544
    s_add_u32 m0, s71, 0
    s_mul_i32 s75, s7, 0x540
    buffer_load_dwordx4 v227, s[32:35], s75 offen lds
    v_mfma_f32_32x32x16_bf16 v[32:47], a[240:243], a[24:27], v[32:47]
    ds_read_b64_tr_b16 a[226:227], v236 offset:13312
    s_mov_b64 exec, s[78:79]
    ds_read_b128 a[224:227], v255 offset:0
    s_mov_b64 exec, -1
    v_lshrrev_b32 v205, 2, v247
    v_mfma_f32_32x32x16_bf16 v[48:63], a[240:243], a[28:31], v[48:63]
    ds_read_b128 a[36:39], v232 offset:12288
    ds_read_b64_tr_b16 a[228:229], v236 offset:12608
    s_add_u32 m0, s70, 0
    s_nop 0
    buffer_load_dwordx4 v225, s[28:31], s7 offen lds
    v_add_u32 v205, s64, v205
    v_mfma_f32_32x32x16_bf16 v[64:79], a[24:27], a[244:247], v[64:79]
    ds_read_b64_tr_b16 a[230:231], v236 offset:13376
    ds_read_b64_tr_b16 a[232:233], v236 offset:12672
    v_mul_u32_u24 v205, 0xe00, v205
    v_and_b32 v206, 3, v247
    v_xor_b32 v206, s65, v206
    v_mfma_f32_32x32x16_bf16 v[80:95], a[28:31], a[244:247], v[80:95]
    ds_read_b64_tr_b16 a[234:235], v236 offset:13440
    s_add_u32 m0, s70, 0x400
    s_nop 0
    buffer_load_dwordx4 v226, s[28:31], s7 offen lds
    v_lshl_add_u32 v205, v206, 4, v205
    v_add_u32 v230, s68, v205
    s_waitcnt lgkmcnt(5)
    v_mfma_f32_32x32x16_bf16 v[0:15], a[224:227], a[32:35], v[0:15]
    ds_read_b128 a[40:43], v233 offset:8192
    ds_read_b64_tr_b16 a[236:237], v236 offset:15616
    ds_read_b64_tr_b16 a[238:239], v236 offset:16384
    s_lshl_b32 s72, s60, 11
    s_sub_u32 s27, s77, s63
    s_waitcnt lgkmcnt(7)
    v_mfma_f32_32x32x16_bf16 v[16:31], a[224:227], a[36:39], v[16:31]
    s_mov_b64 exec, s[78:79]
    ds_read_b128 a[236:239], v255 offset:32
    s_mov_b64 exec, -1
    s_add_u32 m0, s71, 0x400
    s_mul_i32 s75, s7, 0x540
    buffer_load_dwordx4 v228, s[32:35], s75 offen lds
    s_waitcnt lgkmcnt(6)
    v_mfma_f32_32x32x16_bf16 v[32:47], a[228:231], a[32:35], v[32:47]
    ds_read_b128 a[44:47], v233 offset:12288
    ds_read_b64_tr_b16 a[240:241], v236 offset:15680
    ds_read_b64_tr_b16 a[242:243], v236 offset:16448
    s_lshl_b32 s27, s27, 12
    s_add_u32 s27, s27, 0xc000
    v_mfma_f32_32x32x16_bf16 v[48:63], a[228:231], a[36:39], v[48:63]
    ds_read_b64_tr_b16 a[244:245], v236 offset:15744
    ds_read_b64_tr_b16 a[246:247], v236 offset:16512
    ds_read_b128 a[248:251], v238 offset:4096
    s_add_u32 m0, s70, 0x800
    s_add_u32 s75, s7, 0x3800
    buffer_load_dwordx4 v225, s[28:31], s75 offen lds
    s_waitcnt lgkmcnt(10)
    v_mfma_f32_32x32x16_bf16 v[64:79], a[32:35], a[232:235], v[64:79]
    ds_read_b64_tr_b16 v[192:193], v237 offset:12608
    ds_read_b64_tr_b16 v[194:195], v237 offset:13376
    s_lshl_b32 s64, s61, 2
    s_add_u32 s64, s64, s60
    s_mul_i32 s64, s64, 0x90
    v_mfma_f32_32x32x16_bf16 v[80:95], a[36:39], a[232:235], v[80:95]
    ds_read_b64_tr_b16 v[196:197], v237 offset:12672
    ds_read_b64_tr_b16 v[198:199], v237 offset:13440
    s_add_u32 m0, s70, 0xc00
    s_add_u32 s75, s7, 0x3800
    buffer_load_dwordx4 v226, s[28:31], s75 offen lds
    s_waitcnt lgkmcnt(10)
    v_mfma_f32_32x32x16_bf16 v[0:15], a[236:239], a[40:43], v[0:15]
    ds_read_b128 a[48:51], v234 offset:8192
    ds_read_b64_tr_b16 a[224:225], v236 offset:18688
    s_mul_i32 s65, s62, 36
    s_add_u32 s64, s64, s65
    s_lshl_b32 s65, s63, 1
    s_waitcnt lgkmcnt(11)
    v_mfma_f32_32x32x16_bf16 v[16:31], a[236:239], a[44:47], v[16:31]
    ds_read_b64_tr_b16 a[226:227], v236 offset:19456
    s_mov_b64 exec, s[78:79]
    ds_read_b128 a[224:227], v255 offset:64
    s_mov_b64 exec, -1
    s_add_u32 m0, s71, 0x800
    s_mul_i32 s75, s7, 0x540
    buffer_load_dwordx4 v229, s[32:35], s75 offen lds
    s_waitcnt lgkmcnt(11)
    v_mfma_f32_32x32x16_bf16 v[32:47], a[240:243], a[40:43], v[32:47]
    ds_read_b128 a[52:55], v234 offset:12288
    ds_read_b64_tr_b16 a[228:229], v236 offset:18752
    s_add_u32 s64, s64, 8
    s_add_u32 s64, s64, s65
    s_lshl_b32 s64, s64, 11
    v_mfma_f32_32x32x16_bf16 v[48:63], a[240:243], a[44:47], v[48:63]
    ds_read_b64_tr_b16 a[230:231], v236 offset:19520
    ds_read_b64_tr_b16 a[232:233], v236 offset:18816
    s_add_u32 m0, s70, 0x1000
    s_add_u32 s75, s7, 0x7000
    buffer_load_dwordx4 v225, s[28:31], s75 offen lds
    s_waitcnt lgkmcnt(13)
    v_mfma_f32_32x32x16_bf16 v[64:79], a[40:43], a[244:247], v[64:79]
    ds_read_b64_tr_b16 a[234:235], v236 offset:19584
    v_add_u32 v246, s64, v224
    s_lshl_b32 s64, s61, 2
    s_add_u32 s64, s64, s60
    s_lshl_b32 s64, s64, 2
    v_mfma_f32_32x32x16_bf16 v[80:95], a[44:47], a[244:247], v[80:95]
    s_add_u32 m0, s70, 0x1400
    s_add_u32 s75, s7, 0x7000
    buffer_load_dwordx4 v226, s[28:31], s75 offen lds
    s_add_u32 s64, s64, s62
    s_lshl_b32 s64, s64, 4
    s_waitcnt lgkmcnt(5)
    v_mfma_f32_32x32x16_bf16 v[0:15], a[224:227], a[48:51], v[0:15]
    ds_read_b128 a[56:59], v235 offset:8192
    ds_read_b64_tr_b16 a[236:237], v236 offset:21760
    s_add_u32 s64, s64, s63
    s_lshl_b32 s64, s64, 3
    s_add_u32 s64, s64, 0xd00000
    s_waitcnt lgkmcnt(6)
    v_mfma_f32_32x32x16_bf16 v[16:31], a[224:227], a[52:55], v[16:31]
    ds_read_b64_tr_b16 a[238:239], v236 offset:22528
    s_mov_b64 exec, s[78:79]
    ds_read_b128 a[236:239], v255 offset:96
    s_mov_b64 exec, -1
    s_add_u32 m0, s73, 0
    s_nop 0
    buffer_load_dwordx4 v231, s[28:31], s7 offen lds
    s_waitcnt lgkmcnt(6)
    v_mfma_f32_32x32x16_bf16 v[32:47], a[228:231], a[48:51], v[32:47]
    ds_read_b128 a[60:63], v235 offset:12288
    ds_read_b64_tr_b16 a[240:241], v236 offset:21824
    v_and_b32 v205, 1, v247
    v_lshlrev_b32 v205, 6, v205
    v_add_u32 v244, s64, v205
    v_mfma_f32_32x32x16_bf16 v[48:63], a[228:231], a[52:55], v[48:63]
    ds_read_b64_tr_b16 a[242:243], v236 offset:22592
    ds_read_b64_tr_b16 a[244:245], v236 offset:21888
    s_mov_b32 s64, 0x19660d
    v_mul_lo_u32 v220, v220, s64
    v_add_u32 v220, 0x3c6ef35f, v220
    s_waitcnt lgkmcnt(8)
    v_mfma_f32_32x32x16_bf16 v[64:79], a[48:51], a[232:235], v[64:79]
    ds_read_b64_tr_b16 a[246:247], v236 offset:22656
    s_add_u32 m0, s70, 0x1800
    s_add_u32 s75, s7, 0xa800
    buffer_load_dwordx4 v225, s[28:31], s75 offen lds
    v_mfma_f32_32x32x16_bf16 v[80:95], a[52:55], a[232:235], v[80:95]
    s_mov_b32 s64, 0x15a4e35
    v_mul_lo_u32 v221, v221, s64
    v_add_u32 v221, 1, v221
    v_mfma_f32_32x32x16_bf16 v[96:111], v[192:195], a[248:251], v[96:111]
    s_add_u32 m0, s70, 0x1c00
    s_add_u32 s75, s7, 0xa800
    buffer_load_dwordx4 v226, s[28:31], s75 offen lds
    v_mfma_f32_32x32x16_bf16 v[112:127], a[248:251], v[196:199], v[112:127]
    s_cmp_gt_u32 s63, 3
    s_cselect_b32 s64, 1, 0
    s_sub_u32 s85, s63, s64
    v_bfe_u32 v205, v247, 4, 1
    v_lshlrev_b32 v205, 2, v205
    s_waitcnt lgkmcnt(5)
    v_mfma_f32_32x32x16_bf16 v[0:15], a[236:239], a[56:59], v[0:15]
    v_xor_b32 v205, v205, v201
    v_mul_u32_u24 v206, 0x380, v200
    v_lshl_add_u32 v206, v205, 4, v206
    s_lshl_b32 s64, s85, 7
    s_mul_i32 s65, s60, 0x18800
    s_waitcnt lgkmcnt(4)
    v_mfma_f32_32x32x16_bf16 v[16:31], a[236:239], a[60:63], v[16:31]
    s_waitcnt lgkmcnt(0)
    s_waitcnt vmcnt(12)
    s_barrier
    v_add_u32 v255, s6, v243
    ds_read_b128 a[64:67], v232 offset:16384
    ds_read_b64_tr_b16 a[224:225], v236 offset:25088
    s_add_u32 m0, s71, 0x3100
    s_mul_i32 s75, s8, 0x540
    buffer_load_dwordx4 v227, s[32:35], s75 offen lds
    v_mfma_f32_32x32x16_bf16 v[32:47], a[240:243], a[56:59], v[32:47]
    ds_read_b64_tr_b16 a[226:227], v236 offset:25856
    s_mov_b64 exec, s[78:79]
    ds_read_b128 a[224:227], v255 offset:0
    s_mov_b64 exec, -1
    s_add_u32 s65, s65, s64
    v_mfma_f32_32x32x16_bf16 v[48:63], a[240:243], a[60:63], v[48:63]
    ds_read_b128 a[68:71], v232 offset:20480
    ds_read_b64_tr_b16 a[228:229], v236 offset:25152
    s_add_u32 m0, s70, 0x2000
    s_nop 0
    buffer_load_dwordx4 v225, s[28:31], s8 offen lds
    v_add_u32 v245, s65, v206
    v_mfma_f32_32x32x16_bf16 v[64:79], a[56:59], a[244:247], v[64:79]
    ds_read_b64_tr_b16 a[230:231], v236 offset:25920
    ds_read_b64_tr_b16 a[232:233], v236 offset:25216
    s_mul_i32 s65, s60, 0x62000
    s_add_u32 s65, s65, s64
    v_add_u32 v223, s65, v206
    v_mfma_f32_32x32x16_bf16 v[80:95], a[60:63], a[244:247], v[80:95]
    ds_read_b64_tr_b16 a[234:235], v236 offset:25984
    s_add_u32 m0, s70, 0x2400
    s_nop 0
    buffer_load_dwordx4 v226, s[28:31], s8 offen lds
    s_lshl_b32 s64, s61, 2
    s_add_u32 s64, s64, s62
    s_waitcnt lgkmcnt(5)
    v_mfma_f32_32x32x16_bf16 v[0:15], a[224:227], a[64:67], v[0:15]
    ds_read_b128 a[72:75], v233 offset:16384
    ds_read_b64_tr_b16 a[236:237], v236 offset:28160
    ds_read_b64_tr_b16 a[238:239], v236 offset:28928
    s_lshl_b32 s64, s64, 2
    s_add_u32 s64, s64, s60
    s_waitcnt lgkmcnt(7)
    v_mfma_f32_32x32x16_bf16 v[16:31], a[224:227], a[68:71], v[16:31]
    s_mov_b64 exec, s[78:79]
    ds_read_b128 a[236:239], v255 offset:32
    s_mov_b64 exec, -1
    s_add_u32 m0, s71, 0x3500
    s_mul_i32 s75, s8, 0x540
    buffer_load_dwordx4 v228, s[32:35], s75 offen lds
    s_waitcnt lgkmcnt(6)
    v_mfma_f32_32x32x16_bf16 v[32:47], a[228:231], a[64:67], v[32:47]
    ds_read_b128 a[76:79], v233 offset:20480
    ds_read_b64_tr_b16 a[240:241], v236 offset:28224
    ds_read_b64_tr_b16 a[242:243], v236 offset:28992
    s_lshl_b32 s64, s64, 7
    s_add_u32 s64, s64, 0xd00000
    v_mfma_f32_32x32x16_bf16 v[48:63], a[228:231], a[68:71], v[48:63]
    ds_read_b64_tr_b16 a[244:245], v236 offset:28288
    ds_read_b64_tr_b16 a[246:247], v236 offset:29056
    ds_read_b128 a[248:251], v238 offset:8192
    s_add_u32 m0, s70, 0x2800
    s_add_u32 s75, s8, 0x3800
    buffer_load_dwordx4 v225, s[28:31], s75 offen lds
    s_waitcnt lgkmcnt(10)
    v_mfma_f32_32x32x16_bf16 v[64:79], a[64:67], a[232:235], v[64:79]
    ds_read_b64_tr_b16 v[192:193], v237 offset:25152
    ds_read_b64_tr_b16 v[194:195], v237 offset:25920
    v_and_b32 v205, 15, v247
    v_lshlrev_b32 v205, 3, v205
    v_add_u32 v216, s64, v205
    v_mfma_f32_32x32x16_bf16 v[80:95], a[68:71], a[232:235], v[80:95]
    ds_read_b64_tr_b16 v[196:197], v237 offset:25216
    ds_read_b64_tr_b16 v[198:199], v237 offset:25984
    s_add_u32 m0, s70, 0x2c00
    s_add_u32 s75, s8, 0x3800
    buffer_load_dwordx4 v226, s[28:31], s75 offen lds
    s_waitcnt lgkmcnt(10)
    v_mfma_f32_32x32x16_bf16 v[0:15], a[236:239], a[72:75], v[0:15]
    ds_read_b128 a[80:83], v234 offset:16384
    ds_read_b64_tr_b16 a[224:225], v236 offset:31232
    s_lshl_b32 s64, s61, 2
    s_add_u32 s64, s64, s62
    s_mul_i32 s64, s64, 0x90
    s_waitcnt lgkmcnt(11)
    v_mfma_f32_32x32x16_bf16 v[16:31], a[236:239], a[76:79], v[16:31]
    ds_read_b64_tr_b16 a[226:227], v236 offset:32000
    s_mov_b64 exec, s[78:79]
    ds_read_b128 a[224:227], v255 offset:64
    s_mov_b64 exec, -1
    s_add_u32 m0, s71, 0x3900
    s_mul_i32 s75, s8, 0x540
    buffer_load_dwordx4 v229, s[32:35], s75 offen lds
    s_waitcnt lgkmcnt(11)
    v_mfma_f32_32x32x16_bf16 v[32:47], a[240:243], a[72:75], v[32:47]
    ds_read_b128 a[84:87], v234 offset:20480
    ds_read_b64_tr_b16 a[228:229], v236 offset:31296
    s_mul_i32 s65, s60, 36
    s_add_u32 s64, s64, s65
    s_lshl_b32 s64, s64, 11
    v_mfma_f32_32x32x16_bf16 v[48:63], a[240:243], a[76:79], v[48:63]
    ds_read_b64_tr_b16 a[230:231], v236 offset:32064
    ds_read_b64_tr_b16 a[232:233], v236 offset:31360
    s_add_u32 m0, s70, 0x3000
    s_add_u32 s75, s8, 0x7000
    buffer_load_dwordx4 v225, s[28:31], s75 offen lds
    s_waitcnt lgkmcnt(13)
    v_mfma_f32_32x32x16_bf16 v[64:79], a[72:75], a[244:247], v[64:79]
    ds_read_b64_tr_b16 a[234:235], v236 offset:32128
    s_mul_i32 s65, s85, 37
    v_min_u32 v205, 36, v247
    v_add_u32 v205, s65, v205
    v_min_u32 v205, 0xff, v205
    v_mfma_f32_32x32x16_bf16 v[80:95], a[76:79], a[244:247], v[80:95]
    s_add_u32 m0, s70, 0x3400
    s_add_u32 s75, s8, 0x7000
    buffer_load_dwordx4 v226, s[28:31], s75 offen lds
    v_lshlrev_b32 v205, 7, v205
    v_add_u32 v215, s64, v205
    s_waitcnt lgkmcnt(5)
    v_mfma_f32_32x32x16_bf16 v[0:15], a[224:227], a[80:83], v[0:15]
    ds_read_b128 a[88:91], v235 offset:16384
    ds_read_b64_tr_b16 a[236:237], v236 offset:34304
    s_mul_i32 s26, s60, 0xe00
    s_add_u32 s26, s26, 0x24800
    s_mul_i32 s3, s60, 0x3000
    s_waitcnt lgkmcnt(6)
    v_mfma_f32_32x32x16_bf16 v[16:31], a[224:227], a[84:87], v[16:31]
    ds_read_b64_tr_b16 a[238:239], v236 offset:35072
    s_mov_b64 exec, s[78:79]
    ds_read_b128 a[236:239], v255 offset:96
    s_mov_b64 exec, -1
    s_add_u32 m0, s73, 0x1000
    s_nop 0
    buffer_load_dwordx4 v231, s[28:31], s8 offen lds
    s_waitcnt lgkmcnt(6)
    v_mfma_f32_32x32x16_bf16 v[32:47], a[228:231], a[80:83], v[32:47]
    ds_read_b128 a[92:95], v235 offset:20480
    ds_read_b64_tr_b16 a[240:241], v236 offset:34368
    s_add_u32 s3, s3, 0x18000
    s_mov_b32 s48, s20
    s_mov_b32 s49, s21
    v_mfma_f32_32x32x16_bf16 v[48:63], a[228:231], a[84:87], v[48:63]
    ds_read_b64_tr_b16 a[242:243], v236 offset:35136
    ds_read_b64_tr_b16 a[244:245], v236 offset:34432
    s_mov_b32 s50, 0x1c0000
    s_mov_b32 s51, 0x20000
    v_mov_b32 v248, 0xf149f2ca
    s_waitcnt lgkmcnt(8)
    v_mfma_f32_32x32x16_bf16 v[64:79], a[80:83], a[232:235], v[64:79]
    ds_read_b64_tr_b16 a[246:247], v236 offset:35200
    s_add_u32 m0, s70, 0x3800
    s_add_u32 s75, s8, 0xa800
    buffer_load_dwordx4 v225, s[28:31], s75 offen lds
    s_mov_b32 s83, 0x3e8b97f6
    v_mfma_f32_32x32x16_bf16 v[80:95], a[84:87], a[232:235], v[80:95]
    s_mov_b32 s80, -1
    s_mov_b32 s81, 0
    s_or_b32 s64, s61, s60
    v_mfma_f32_32x32x16_bf16 v[96:111], v[192:195], a[248:251], v[96:111]
    s_add_u32 m0, s70, 0x3c00
    s_add_u32 s75, s8, 0xa800
    buffer_load_dwordx4 v226, s[28:31], s75 offen lds
    v_mfma_f32_32x32x16_bf16 v[112:127], a[248:251], v[196:199], v[112:127]
    s_cmp_eq_u32 s64, 0
    s_cselect_b32 s0, 0, -1
    s_cselect_b32 s1, 0, -1
    s_mul_i32 s64, s60, 0x1800
    s_add_u32 s64, s64, 0x18000
    s_waitcnt lgkmcnt(5)
    v_mfma_f32_32x32x16_bf16 v[0:15], a[236:239], a[88:91], v[0:15]
    v_add_u32 v249, s64, v224
    s_lshl_b32 s64, s60, 10
    s_add_u32 s64, s64, 0x18000
    v_add_u32 v250, s64, v224
    s_lshr_b32 s64, s60, 1
    s_waitcnt lgkmcnt(4)
    v_mfma_f32_32x32x16_bf16 v[16:31], a[236:239], a[92:95], v[16:31]
    s_waitcnt lgkmcnt(0)
    s_waitcnt vmcnt(12)
    s_barrier
    v_add_u32 v255, s7, v243
    ds_read_b128 a[96:99], v232 offset:0
    ds_read_b64_tr_b16 a[224:225], v236 offset:0
    s_add_u32 m0, s71, 0x6200
    s_mul_i32 s75, s9, 0x540
    buffer_load_dwordx4 v227, s[32:35], s75 offen lds
    v_mfma_f32_32x32x16_bf16 v[32:47], a[240:243], a[88:91], v[32:47]
    ds_read_b64_tr_b16 a[226:227], v236 offset:768
    s_mov_b64 exec, s[78:79]
    ds_read_b128 a[224:227], v255 offset:0
    s_mov_b64 exec, -1
    s_lshl_b32 s64, s64, 10
    v_mfma_f32_32x32x16_bf16 v[48:63], a[240:243], a[92:95], v[48:63]
    ds_read_b128 a[100:103], v232 offset:4096
    ds_read_b64_tr_b16 a[228:229], v236 offset:64
    s_add_u32 m0, s70, 0x4000
    s_nop 0
    buffer_load_dwordx4 v225, s[28:31], s9 offen lds
    s_and_b32 s65, s60, 1
    v_mfma_f32_32x32x16_bf16 v[64:79], a[88:91], a[244:247], v[64:79]
    ds_read_b64_tr_b16 a[230:231], v236 offset:832
    ds_read_b64_tr_b16 a[232:233], v236 offset:128
    s_lshl_b32 s65, s65, 3
    s_add_u32 s64, s64, s65
    s_add_u32 s65, s64, 0x19000
    v_mfma_f32_32x32x16_bf16 v[80:95], a[92:95], a[244:247], v[80:95]
    ds_read_b64_tr_b16 a[234:235], v236 offset:896
    s_add_u32 m0, s70, 0x4400
    s_nop 0
    buffer_load_dwordx4 v226, s[28:31], s9 offen lds
    v_add_u32 v251, s65, v224
    s_add_u32 s65, s64, 0x1e000
    s_waitcnt lgkmcnt(5)
    v_mfma_f32_32x32x16_bf16 v[0:15], a[224:227], a[96:99], v[0:15]
    ds_read_b128 a[104:107], v233 offset:0
    ds_read_b64_tr_b16 a[236:237], v236 offset:3072
    ds_read_b64_tr_b16 a[238:239], v236 offset:3840
    v_add_u32 v252, s65, v224
    s_lshl_b32 s65, s60, 2
    s_waitcnt lgkmcnt(7)
    v_mfma_f32_32x32x16_bf16 v[16:31], a[224:227], a[100:103], v[16:31]
    s_mov_b64 exec, s[78:79]
    ds_read_b128 a[236:239], v255 offset:32
    s_mov_b64 exec, -1
    s_add_u32 m0, s71, 0x6600
    s_mul_i32 s75, s9, 0x540
    buffer_load_dwordx4 v228, s[32:35], s75 offen lds
    s_waitcnt lgkmcnt(6)
    v_mfma_f32_32x32x16_bf16 v[32:47], a[228:231], a[96:99], v[32:47]
    ds_read_b128 a[108:111], v233 offset:4096
    ds_read_b64_tr_b16 a[240:241], v236 offset:3136
    ds_read_b64_tr_b16 a[242:243], v236 offset:3904
    s_add_u32 s65, s65, 0x1e800
    v_add_u32 v253, s65, v224
    v_mfma_f32_32x32x16_bf16 v[48:63], a[228:231], a[100:103], v[48:63]
    ds_read_b64_tr_b16 a[244:245], v236 offset:3200
    ds_read_b64_tr_b16 a[246:247], v236 offset:3968
    ds_read_b128 a[248:251], v238 offset:0
    s_add_u32 m0, s70, 0x4800
    s_add_u32 s75, s9, 0x3800
    buffer_load_dwordx4 v225, s[28:31], s75 offen lds
    s_waitcnt lgkmcnt(10)
    v_mfma_f32_32x32x16_bf16 v[64:79], a[96:99], a[232:235], v[64:79]
    ds_read_b64_tr_b16 v[192:193], v237 offset:64
    ds_read_b64_tr_b16 v[194:195], v237 offset:832
    s_mul_i32 s65, s60, 0xc00
    s_add_u32 s65, s65, 0x1e000
    v_add_u32 v254, s65, v224
    v_mfma_f32_32x32x16_bf16 v[80:95], a[100:103], a[232:235], v[80:95]
    ds_read_b64_tr_b16 v[196:197], v237 offset:128
    ds_read_b64_tr_b16 v[198:199], v237 offset:896
    s_add_u32 m0, s70, 0x4c00
    s_add_u32 s75, s9, 0x3800
    buffer_load_dwordx4 v226, s[28:31], s75 offen lds
    s_waitcnt lgkmcnt(10)
    v_mfma_f32_32x32x16_bf16 v[0:15], a[236:239], a[104:107], v[0:15]
    ds_read_b128 a[112:115], v234 offset:0
    ds_read_b64_tr_b16 a[224:225], v236 offset:6144
    s_waitcnt lgkmcnt(11)
    v_mfma_f32_32x32x16_bf16 v[16:31], a[236:239], a[108:111], v[16:31]
    ds_read_b64_tr_b16 a[226:227], v236 offset:6912
    s_mov_b64 exec, s[78:79]
    ds_read_b128 a[224:227], v255 offset:64
    s_mov_b64 exec, -1
    s_add_u32 m0, s71, 0x6a00
    s_mul_i32 s75, s9, 0x540
    buffer_load_dwordx4 v229, s[32:35], s75 offen lds
    s_waitcnt lgkmcnt(11)
    v_mfma_f32_32x32x16_bf16 v[32:47], a[240:243], a[104:107], v[32:47]
    ds_read_b128 a[116:119], v234 offset:4096
    ds_read_b64_tr_b16 a[228:229], v236 offset:6208
    v_mfma_f32_32x32x16_bf16 v[48:63], a[240:243], a[108:111], v[48:63]
    ds_read_b64_tr_b16 a[230:231], v236 offset:6976
    ds_read_b64_tr_b16 a[232:233], v236 offset:6272
    s_add_u32 m0, s70, 0x5000
    s_add_u32 s75, s9, 0x7000
    buffer_load_dwordx4 v225, s[28:31], s75 offen lds
    s_waitcnt lgkmcnt(13)
    v_mfma_f32_32x32x16_bf16 v[64:79], a[104:107], a[244:247], v[64:79]
    ds_read_b64_tr_b16 a[234:235], v236 offset:7040
    v_mfma_f32_32x32x16_bf16 v[80:95], a[108:111], a[244:247], v[80:95]
    s_add_u32 m0, s70, 0x5400
    s_add_u32 s75, s9, 0x7000
    buffer_load_dwordx4 v226, s[28:31], s75 offen lds
    s_waitcnt lgkmcnt(5)
    v_mfma_f32_32x32x16_bf16 v[0:15], a[224:227], a[112:115], v[0:15]
    ds_read_b128 a[120:123], v235 offset:0
    ds_read_b64_tr_b16 a[236:237], v236 offset:9216
    s_waitcnt lgkmcnt(6)
    v_mfma_f32_32x32x16_bf16 v[16:31], a[224:227], a[116:119], v[16:31]
    ds_read_b64_tr_b16 a[238:239], v236 offset:9984
    s_mov_b64 exec, s[78:79]
    ds_read_b128 a[236:239], v255 offset:96
    s_mov_b64 exec, -1
    s_add_u32 m0, s73, 0x2000
    s_nop 0
    buffer_load_dwordx4 v231, s[28:31], s9 offen lds
    s_waitcnt lgkmcnt(6)
    v_mfma_f32_32x32x16_bf16 v[32:47], a[228:231], a[112:115], v[32:47]
    ds_read_b128 a[124:127], v235 offset:4096
    ds_read_b64_tr_b16 a[240:241], v236 offset:9280
    v_mfma_f32_32x32x16_bf16 v[48:63], a[228:231], a[116:119], v[48:63]
    ds_read_b64_tr_b16 a[242:243], v236 offset:10048
    ds_read_b64_tr_b16 a[244:245], v236 offset:9344
    s_waitcnt lgkmcnt(8)
    v_mfma_f32_32x32x16_bf16 v[64:79], a[112:115], a[232:235], v[64:79]
    ds_read_b64_tr_b16 a[246:247], v236 offset:10112
    s_add_u32 m0, s70, 0x5800
    s_add_u32 s75, s9, 0xa800
    buffer_load_dwordx4 v225, s[28:31], s75 offen lds
    v_mfma_f32_32x32x16_bf16 v[80:95], a[116:119], a[232:235], v[80:95]
    v_mfma_f32_32x32x16_bf16 v[96:111], v[192:195], a[248:251], v[96:111]
    s_add_u32 m0, s70, 0x5c00
    s_add_u32 s75, s9, 0xa800
    buffer_load_dwordx4 v226, s[28:31], s75 offen lds
    v_mfma_f32_32x32x16_bf16 v[112:127], a[248:251], v[196:199], v[112:127]
    s_waitcnt lgkmcnt(5)
    v_mfma_f32_32x32x16_bf16 v[0:15], a[236:239], a[120:123], v[0:15]
    s_waitcnt lgkmcnt(4)
    v_mfma_f32_32x32x16_bf16 v[16:31], a[236:239], a[124:127], v[16:31]
    s_waitcnt lgkmcnt(0)
    s_waitcnt vmcnt(12)
    s_barrier
    v_add_u32 v255, s8, v243
    ds_read_b128 a[128:131], v232 offset:8192
    ds_read_b64_tr_b16 a[224:225], v236 offset:12544
    s_add_u32 m0, s71, 0
    s_mul_i32 s75, s10, 0x540
    buffer_load_dwordx4 v227, s[32:35], s75 offen lds
    v_mfma_f32_32x32x16_bf16 v[32:47], a[240:243], a[120:123], v[32:47]
    ds_read_b64_tr_b16 a[226:227], v236 offset:13312
    s_mov_b64 exec, s[78:79]
    ds_read_b128 a[224:227], v255 offset:0
    s_mov_b64 exec, -1
    v_mfma_f32_32x32x16_bf16 v[48:63], a[240:243], a[124:127], v[48:63]
    ds_read_b128 a[132:135], v232 offset:12288
    ds_read_b64_tr_b16 a[228:229], v236 offset:12608
    s_add_u32 m0, s70, 0
    s_nop 0
    buffer_load_dwordx4 v225, s[28:31], s10 offen lds
    v_mfma_f32_32x32x16_bf16 v[64:79], a[120:123], a[244:247], v[64:79]
    ds_read_b64_tr_b16 a[230:231], v236 offset:13376
    ds_read_b64_tr_b16 a[232:233], v236 offset:12672
    v_mfma_f32_32x32x16_bf16 v[80:95], a[124:127], a[244:247], v[80:95]
    ds_read_b64_tr_b16 a[234:235], v236 offset:13440
    s_add_u32 m0, s70, 0x400
    s_nop 0
    buffer_load_dwordx4 v226, s[28:31], s10 offen lds
    s_waitcnt lgkmcnt(5)
    v_mfma_f32_32x32x16_bf16 v[0:15], a[224:227], a[128:131], v[0:15]
    ds_read_b128 a[136:139], v233 offset:8192
    ds_read_b64_tr_b16 a[236:237], v236 offset:15616
    ds_read_b64_tr_b16 a[238:239], v236 offset:16384
    s_waitcnt lgkmcnt(7)
    v_mfma_f32_32x32x16_bf16 v[16:31], a[224:227], a[132:135], v[16:31]
    s_mov_b64 exec, s[78:79]
    ds_read_b128 a[236:239], v255 offset:32
    s_mov_b64 exec, -1
    s_add_u32 m0, s71, 0x400
    s_mul_i32 s75, s10, 0x540
    buffer_load_dwordx4 v228, s[32:35], s75 offen lds
    s_waitcnt lgkmcnt(6)
    v_mfma_f32_32x32x16_bf16 v[32:47], a[228:231], a[128:131], v[32:47]
    ds_read_b128 a[140:143], v233 offset:12288
    ds_read_b64_tr_b16 a[240:241], v236 offset:15680
    ds_read_b64_tr_b16 a[242:243], v236 offset:16448
    v_mfma_f32_32x32x16_bf16 v[48:63], a[228:231], a[132:135], v[48:63]
    ds_read_b64_tr_b16 a[244:245], v236 offset:15744
    ds_read_b64_tr_b16 a[246:247], v236 offset:16512
    ds_read_b128 a[248:251], v238 offset:4096
    s_add_u32 m0, s70, 0x800
    s_add_u32 s75, s10, 0x3800
    buffer_load_dwordx4 v225, s[28:31], s75 offen lds
    s_waitcnt lgkmcnt(10)
    v_mfma_f32_32x32x16_bf16 v[64:79], a[128:131], a[232:235], v[64:79]
    ds_read_b64_tr_b16 v[192:193], v237 offset:12608
    ds_read_b64_tr_b16 v[194:195], v237 offset:13376
    v_mfma_f32_32x32x16_bf16 v[80:95], a[132:135], a[232:235], v[80:95]
    ds_read_b64_tr_b16 v[196:197], v237 offset:12672
    ds_read_b64_tr_b16 v[198:199], v237 offset:13440
    s_add_u32 m0, s70, 0xc00
    s_add_u32 s75, s10, 0x3800
    buffer_load_dwordx4 v226, s[28:31], s75 offen lds
    s_waitcnt lgkmcnt(10)
    v_mfma_f32_32x32x16_bf16 v[0:15], a[236:239], a[136:139], v[0:15]
    ds_read_b128 a[144:147], v234 offset:8192
    ds_read_b64_tr_b16 a[224:225], v236 offset:18688
    s_waitcnt lgkmcnt(11)
    v_mfma_f32_32x32x16_bf16 v[16:31], a[236:239], a[140:143], v[16:31]
    ds_read_b64_tr_b16 a[226:227], v236 offset:19456
    s_mov_b64 exec, s[78:79]
    ds_read_b128 a[224:227], v255 offset:64
    s_mov_b64 exec, -1
    s_add_u32 m0, s71, 0x800
    s_mul_i32 s75, s10, 0x540
    buffer_load_dwordx4 v229, s[32:35], s75 offen lds
    s_waitcnt lgkmcnt(11)
    v_mfma_f32_32x32x16_bf16 v[32:47], a[240:243], a[136:139], v[32:47]
    ds_read_b128 a[148:151], v234 offset:12288
    ds_read_b64_tr_b16 a[228:229], v236 offset:18752
    v_mfma_f32_32x32x16_bf16 v[48:63], a[240:243], a[140:143], v[48:63]
    ds_read_b64_tr_b16 a[230:231], v236 offset:19520
    ds_read_b64_tr_b16 a[232:233], v236 offset:18816
    s_add_u32 m0, s70, 0x1000
    s_add_u32 s75, s10, 0x7000
    buffer_load_dwordx4 v225, s[28:31], s75 offen lds
    s_waitcnt lgkmcnt(13)
    v_mfma_f32_32x32x16_bf16 v[64:79], a[136:139], a[244:247], v[64:79]
    ds_read_b64_tr_b16 a[234:235], v236 offset:19584
    v_mfma_f32_32x32x16_bf16 v[80:95], a[140:143], a[244:247], v[80:95]
    s_add_u32 m0, s70, 0x1400
    s_add_u32 s75, s10, 0x7000
    buffer_load_dwordx4 v226, s[28:31], s75 offen lds
    s_waitcnt lgkmcnt(5)
    v_mfma_f32_32x32x16_bf16 v[0:15], a[224:227], a[144:147], v[0:15]
    ds_read_b128 a[152:155], v235 offset:8192
    ds_read_b64_tr_b16 a[236:237], v236 offset:21760
    s_waitcnt lgkmcnt(6)
    v_mfma_f32_32x32x16_bf16 v[16:31], a[224:227], a[148:151], v[16:31]
    ds_read_b64_tr_b16 a[238:239], v236 offset:22528
    s_mov_b64 exec, s[78:79]
    ds_read_b128 a[236:239], v255 offset:96
    s_mov_b64 exec, -1
    s_add_u32 m0, s73, 0
    s_nop 0
    buffer_load_dwordx4 v231, s[28:31], s10 offen lds
    s_waitcnt lgkmcnt(6)
    v_mfma_f32_32x32x16_bf16 v[32:47], a[228:231], a[144:147], v[32:47]
    ds_read_b128 a[156:159], v235 offset:12288
    ds_read_b64_tr_b16 a[240:241], v236 offset:21824
    v_mfma_f32_32x32x16_bf16 v[48:63], a[228:231], a[148:151], v[48:63]
    ds_read_b64_tr_b16 a[242:243], v236 offset:22592
    ds_read_b64_tr_b16 a[244:245], v236 offset:21888
    s_waitcnt lgkmcnt(8)
    v_mfma_f32_32x32x16_bf16 v[64:79], a[144:147], a[232:235], v[64:79]
    ds_read_b64_tr_b16 a[246:247], v236 offset:22656
    s_add_u32 m0, s70, 0x1800
    s_add_u32 s75, s10, 0xa800
    buffer_load_dwordx4 v225, s[28:31], s75 offen lds
    v_mfma_f32_32x32x16_bf16 v[80:95], a[148:151], a[232:235], v[80:95]
    v_mfma_f32_32x32x16_bf16 v[96:111], v[192:195], a[248:251], v[96:111]
    s_add_u32 m0, s70, 0x1c00
    s_add_u32 s75, s10, 0xa800
    buffer_load_dwordx4 v226, s[28:31], s75 offen lds
    v_mfma_f32_32x32x16_bf16 v[112:127], a[248:251], v[196:199], v[112:127]
    s_waitcnt lgkmcnt(5)
    v_mfma_f32_32x32x16_bf16 v[0:15], a[236:239], a[152:155], v[0:15]
    s_waitcnt lgkmcnt(4)
    v_mfma_f32_32x32x16_bf16 v[16:31], a[236:239], a[156:159], v[16:31]
    s_waitcnt lgkmcnt(0)
    s_waitcnt vmcnt(12)
    s_barrier
    v_add_u32 v255, s9, v243
    ds_read_b128 a[160:163], v232 offset:16384
    ds_read_b64_tr_b16 a[224:225], v236 offset:25088
    v_mfma_f32_32x32x16_bf16 v[32:47], a[240:243], a[152:155], v[32:47]
    ds_read_b64_tr_b16 a[226:227], v236 offset:25856
    s_mov_b64 exec, s[78:79]
    ds_read_b128 a[224:227], v255 offset:0
    s_mov_b64 exec, -1
    s_add_u32 m0, s72, 0x2000
    s_mul_i32 s75, s4, 0x700
    buffer_load_dwordx4 v230, s[36:39], s75 offen lds
    v_mfma_f32_32x32x16_bf16 v[48:63], a[240:243], a[156:159], v[48:63]
    ds_read_b128 a[164:167], v232 offset:20480
    ds_read_b64_tr_b16 a[228:229], v236 offset:25152
    v_mfma_f32_32x32x16_bf16 v[64:79], a[152:155], a[244:247], v[64:79]
    ds_read_b64_tr_b16 a[230:231], v236 offset:25920
    ds_read_b64_tr_b16 a[232:233], v236 offset:25216
    s_add_u32 m0, s72, 0x2400
    s_mul_i32 s75, s4, 0x700
    s_add_u32 s75, s75, 0xe000
    buffer_load_dwordx4 v230, s[36:39], s75 offen lds
    v_mfma_f32_32x32x16_bf16 v[80:95], a[156:159], a[244:247], v[80:95]
    ds_read_b64_tr_b16 a[234:235], v236 offset:25984
    s_waitcnt lgkmcnt(5)
    v_mfma_f32_32x32x16_bf16 v[0:15], a[224:227], a[160:163], v[0:15]
    ds_read_b128 a[168:171], v233 offset:16384
    ds_read_b64_tr_b16 a[236:237], v236 offset:28160
    ds_read_b64_tr_b16 a[238:239], v236 offset:28928
    s_waitcnt lgkmcnt(7)
    v_mfma_f32_32x32x16_bf16 v[16:31], a[224:227], a[164:167], v[16:31]
    s_mov_b64 exec, s[78:79]
    ds_read_b128 a[236:239], v255 offset:32
    s_mov_b64 exec, -1
    s_add_u32 m0, s72, 0x8000
    s_mul_i32 s75, s5, 0x700
    buffer_load_dwordx4 v230, s[36:39], s75 offen lds
    s_waitcnt lgkmcnt(6)
    v_mfma_f32_32x32x16_bf16 v[32:47], a[228:231], a[160:163], v[32:47]
    ds_read_b128 a[172:175], v233 offset:20480
    ds_read_b64_tr_b16 a[240:241], v236 offset:28224
    ds_read_b64_tr_b16 a[242:243], v236 offset:28992
    v_mfma_f32_32x32x16_bf16 v[48:63], a[228:231], a[164:167], v[48:63]
    ds_read_b64_tr_b16 a[244:245], v236 offset:28288
    ds_read_b64_tr_b16 a[246:247], v236 offset:29056
    ds_read_b128 a[248:251], v238 offset:8192
    s_waitcnt lgkmcnt(10)
    v_mfma_f32_32x32x16_bf16 v[64:79], a[160:163], a[232:235], v[64:79]
    ds_read_b64_tr_b16 v[192:193], v237 offset:25152
    ds_read_b64_tr_b16 v[194:195], v237 offset:25920
    s_add_u32 m0, s72, 0x8400
    s_mul_i32 s75, s5, 0x700
    s_add_u32 s75, s75, 0xe000
    buffer_load_dwordx4 v230, s[36:39], s75 offen lds
    v_mfma_f32_32x32x16_bf16 v[80:95], a[164:167], a[232:235], v[80:95]
    ds_read_b64_tr_b16 v[196:197], v237 offset:25216
    ds_read_b64_tr_b16 v[198:199], v237 offset:25984
    s_waitcnt lgkmcnt(10)
    v_mfma_f32_32x32x16_bf16 v[0:15], a[236:239], a[168:171], v[0:15]
    ds_read_b128 a[176:179], v234 offset:16384
    ds_read_b64_tr_b16 a[224:225], v236 offset:31232
    s_waitcnt lgkmcnt(11)
    v_mfma_f32_32x32x16_bf16 v[16:31], a[236:239], a[172:175], v[16:31]
    ds_read_b64_tr_b16 a[226:227], v236 offset:32000
    s_mov_b64 exec, s[78:79]
    ds_read_b128 a[224:227], v255 offset:64
    s_mov_b64 exec, -1
    s_add_u32 m0, s72, 0xe000
    s_mul_i32 s75, s6, 0x700
    buffer_load_dwordx4 v230, s[36:39], s75 offen lds
    s_waitcnt lgkmcnt(11)
    v_mfma_f32_32x32x16_bf16 v[32:47], a[240:243], a[168:171], v[32:47]
    ds_read_b128 a[180:183], v234 offset:20480
    ds_read_b64_tr_b16 a[228:229], v236 offset:31296
    v_mfma_f32_32x32x16_bf16 v[48:63], a[240:243], a[172:175], v[48:63]
    ds_read_b64_tr_b16 a[230:231], v236 offset:32064
    ds_read_b64_tr_b16 a[232:233], v236 offset:31360
    s_waitcnt lgkmcnt(13)
    v_mfma_f32_32x32x16_bf16 v[64:79], a[168:171], a[244:247], v[64:79]
    ds_read_b64_tr_b16 a[234:235], v236 offset:32128
    s_add_u32 m0, s72, 0xe400
    s_mul_i32 s75, s6, 0x700
    s_add_u32 s75, s75, 0xe000
    buffer_load_dwordx4 v230, s[36:39], s75 offen lds
    v_mfma_f32_32x32x16_bf16 v[80:95], a[172:175], a[244:247], v[80:95]
    s_waitcnt lgkmcnt(5)
    v_mfma_f32_32x32x16_bf16 v[0:15], a[224:227], a[176:179], v[0:15]
    ds_read_b128 a[184:187], v235 offset:16384
    ds_read_b64_tr_b16 a[236:237], v236 offset:34304
    s_waitcnt lgkmcnt(6)
    v_mfma_f32_32x32x16_bf16 v[16:31], a[224:227], a[180:183], v[16:31]
    ds_read_b64_tr_b16 a[238:239], v236 offset:35072
    s_mov_b64 exec, s[78:79]
    ds_read_b128 a[236:239], v255 offset:96
    s_mov_b64 exec, -1
    s_waitcnt lgkmcnt(6)
    v_mfma_f32_32x32x16_bf16 v[32:47], a[228:231], a[176:179], v[32:47]
    ds_read_b128 a[188:191], v235 offset:20480
    ds_read_b64_tr_b16 a[240:241], v236 offset:34368
    s_add_u32 m0, s72, 0x14000
    s_mul_i32 s75, s7, 0x700
    buffer_load_dwordx4 v230, s[36:39], s75 offen lds
    v_mfma_f32_32x32x16_bf16 v[48:63], a[228:231], a[180:183], v[48:63]
    ds_read_b64_tr_b16 a[242:243], v236 offset:35136
    ds_read_b64_tr_b16 a[244:245], v236 offset:34432
    s_waitcnt lgkmcnt(8)
    v_mfma_f32_32x32x16_bf16 v[64:79], a[176:179], a[232:235], v[64:79]
    ds_read_b64_tr_b16 a[246:247], v236 offset:35200
    v_mfma_f32_32x32x16_bf16 v[80:95], a[180:183], a[232:235], v[80:95]
    v_mfma_f32_32x32x16_bf16 v[96:111], v[192:195], a[248:251], v[96:111]
    s_add_u32 m0, s72, 0x14400
    s_mul_i32 s75, s7, 0x700
    s_add_u32 s75, s75, 0xe000
    buffer_load_dwordx4 v230, s[36:39], s75 offen lds
    v_mfma_f32_32x32x16_bf16 v[112:127], a[248:251], v[196:199], v[112:127]
    s_waitcnt lgkmcnt(5)
    v_mfma_f32_32x32x16_bf16 v[0:15], a[236:239], a[184:187], v[0:15]
    s_waitcnt lgkmcnt(4)
    v_mfma_f32_32x32x16_bf16 v[16:31], a[236:239], a[188:191], v[16:31]
    s_waitcnt lgkmcnt(0)
    s_waitcnt vmcnt(8)
    s_barrier
    v_add_u32 v255, s10, v243
    ds_read_b128 a[192:195], v232 offset:0
    ds_read_b64_tr_b16 a[224:225], v236 offset:0
    v_mfma_f32_32x32x16_bf16 v[32:47], a[240:243], a[184:187], v[32:47]
    ds_read_b64_tr_b16 a[226:227], v236 offset:768
    s_mov_b64 exec, s[78:79]
    ds_read_b128 a[224:227], v255 offset:0
    s_mov_b64 exec, -1
    s_add_u32 m0, s72, 0x4000
    s_mul_i32 s75, s8, 0x700
    buffer_load_dwordx4 v230, s[36:39], s75 offen lds
    v_mfma_f32_32x32x16_bf16 v[48:63], a[240:243], a[188:191], v[48:63]
    ds_read_b128 a[196:199], v232 offset:4096
    ds_read_b64_tr_b16 a[228:229], v236 offset:64
    v_mfma_f32_32x32x16_bf16 v[64:79], a[184:187], a[244:247], v[64:79]
    ds_read_b64_tr_b16 a[230:231], v236 offset:832
    ds_read_b64_tr_b16 a[232:233], v236 offset:128
    s_add_u32 m0, s72, 0x4400
    s_mul_i32 s75, s8, 0x700
    s_add_u32 s75, s75, 0xe000
    buffer_load_dwordx4 v230, s[36:39], s75 offen lds
    v_mfma_f32_32x32x16_bf16 v[80:95], a[188:191], a[244:247], v[80:95]
    ds_read_b64_tr_b16 a[234:235], v236 offset:896
    s_waitcnt lgkmcnt(5)
    v_mfma_f32_32x32x16_bf16 v[0:15], a[224:227], a[192:195], v[0:15]
    ds_read_b128 a[200:203], v233 offset:0
    ds_read_b64_tr_b16 a[236:237], v236 offset:3072
    ds_read_b64_tr_b16 a[238:239], v236 offset:3840
    s_waitcnt lgkmcnt(7)
    v_mfma_f32_32x32x16_bf16 v[16:31], a[224:227], a[196:199], v[16:31]
    s_mov_b64 exec, s[78:79]
    ds_read_b128 a[236:239], v255 offset:32
    s_mov_b64 exec, -1
    s_add_u32 m0, s72, 0xa000
    s_mul_i32 s75, s9, 0x700
    buffer_load_dwordx4 v230, s[36:39], s75 offen lds
    s_waitcnt lgkmcnt(6)
    v_mfma_f32_32x32x16_bf16 v[32:47], a[228:231], a[192:195], v[32:47]
    ds_read_b128 a[204:207], v233 offset:4096
    ds_read_b64_tr_b16 a[240:241], v236 offset:3136
    ds_read_b64_tr_b16 a[242:243], v236 offset:3904
    v_mfma_f32_32x32x16_bf16 v[48:63], a[228:231], a[196:199], v[48:63]
    ds_read_b64_tr_b16 a[244:245], v236 offset:3200
    ds_read_b64_tr_b16 a[246:247], v236 offset:3968
    ds_read_b128 a[248:251], v238 offset:0
    s_waitcnt lgkmcnt(10)
    v_mfma_f32_32x32x16_bf16 v[64:79], a[192:195], a[232:235], v[64:79]
    ds_read_b64_tr_b16 v[192:193], v237 offset:64
    ds_read_b64_tr_b16 v[194:195], v237 offset:832
    s_add_u32 m0, s72, 0xa400
    s_mul_i32 s75, s9, 0x700
    s_add_u32 s75, s75, 0xe000
    buffer_load_dwordx4 v230, s[36:39], s75 offen lds
    v_mfma_f32_32x32x16_bf16 v[80:95], a[196:199], a[232:235], v[80:95]
    ds_read_b64_tr_b16 v[196:197], v237 offset:128
    ds_read_b64_tr_b16 v[198:199], v237 offset:896
    s_waitcnt lgkmcnt(10)
    v_mfma_f32_32x32x16_bf16 v[0:15], a[236:239], a[200:203], v[0:15]
    ds_read_b128 a[208:211], v234 offset:0
    ds_read_b64_tr_b16 a[224:225], v236 offset:6144
    s_waitcnt lgkmcnt(11)
    v_mfma_f32_32x32x16_bf16 v[16:31], a[236:239], a[204:207], v[16:31]
    ds_read_b64_tr_b16 a[226:227], v236 offset:6912
    s_mov_b64 exec, s[78:79]
    ds_read_b128 a[224:227], v255 offset:64
    s_mov_b64 exec, -1
    s_waitcnt lgkmcnt(11)
    v_mfma_f32_32x32x16_bf16 v[32:47], a[240:243], a[200:203], v[32:47]
    ds_read_b128 a[212:215], v234 offset:4096
    ds_read_b64_tr_b16 a[228:229], v236 offset:6208
    v_mfma_f32_32x32x16_bf16 v[48:63], a[240:243], a[204:207], v[48:63]
    ds_read_b64_tr_b16 a[230:231], v236 offset:6976
    ds_read_b64_tr_b16 a[232:233], v236 offset:6272
    s_add_u32 m0, s72, 0x10000
    s_mul_i32 s75, s10, 0x700
    buffer_load_dwordx4 v230, s[36:39], s75 offen lds
    s_waitcnt lgkmcnt(13)
    v_mfma_f32_32x32x16_bf16 v[64:79], a[200:203], a[244:247], v[64:79]
    ds_read_b64_tr_b16 a[234:235], v236 offset:7040
    v_mfma_f32_32x32x16_bf16 v[80:95], a[204:207], a[244:247], v[80:95]
    s_waitcnt lgkmcnt(5)
    v_mfma_f32_32x32x16_bf16 v[0:15], a[224:227], a[208:211], v[0:15]
    ds_read_b128 a[216:219], v235 offset:0
    ds_read_b64_tr_b16 a[236:237], v236 offset:9216
    s_waitcnt lgkmcnt(6)
    v_mfma_f32_32x32x16_bf16 v[16:31], a[224:227], a[212:215], v[16:31]
    ds_read_b64_tr_b16 a[238:239], v236 offset:9984
    s_mov_b64 exec, s[78:79]
    ds_read_b128 a[236:239], v255 offset:96
    s_mov_b64 exec, -1
    s_waitcnt lgkmcnt(6)
    v_mfma_f32_32x32x16_bf16 v[32:47], a[228:231], a[208:211], v[32:47]
    ds_read_b128 a[220:223], v235 offset:4096
    ds_read_b64_tr_b16 a[240:241], v236 offset:9280
    v_mfma_f32_32x32x16_bf16 v[48:63], a[228:231], a[212:215], v[48:63]
    ds_read_b64_tr_b16 a[242:243], v236 offset:10048
    ds_read_b64_tr_b16 a[244:245], v236 offset:9344
    s_waitcnt lgkmcnt(8)
    v_mfma_f32_32x32x16_bf16 v[64:79], a[208:211], a[232:235], v[64:79]
    ds_read_b64_tr_b16 a[246:247], v236 offset:10112
    s_add_u32 m0, s72, 0x10400
    s_mul_i32 s75, s10, 0x700
    s_add_u32 s75, s75, 0xe000
    buffer_load_dwordx4 v230, s[36:39], s75 offen lds
    v_mfma_f32_32x32x16_bf16 v[80:95], a[212:215], a[232:235], v[80:95]
    v_mfma_f32_32x32x16_bf16 v[96:111], v[192:195], a[248:251], v[96:111]
    v_mfma_f32_32x32x16_bf16 v[112:127], a[248:251], v[196:199], v[112:127]
    s_waitcnt lgkmcnt(5)
    v_mfma_f32_32x32x16_bf16 v[0:15], a[236:239], a[216:219], v[0:15]
    s_waitcnt lgkmcnt(4)
    v_mfma_f32_32x32x16_bf16 v[16:31], a[236:239], a[220:223], v[16:31]
    s_waitcnt lgkmcnt(0)
    s_waitcnt vmcnt(6)
    s_barrier
    ds_read_b64_tr_b16 a[224:225], v239 offset:8192
    ds_read_b64_tr_b16 a[226:227], v239 offset:8448
    v_mfma_f32_32x32x16_bf16 v[32:47], a[240:243], a[216:219], v[32:47]
    v_mfma_f32_32x32x16_bf16 v[48:63], a[240:243], a[220:223], v[48:63]
    v_mfma_f32_32x32x16_bf16 v[64:79], a[216:219], a[244:247], v[64:79]
    v_mfma_f32_32x32x16_bf16 v[80:95], a[220:223], a[244:247], v[80:95]
    s_waitcnt lgkmcnt(0)
    v_mfma_f32_32x32x16_bf16 v[128:143], a[224:227], a[0:3], 0
    ds_read_b64_tr_b16 a[228:229], v239 offset:9216
    ds_read_b64_tr_b16 a[230:231], v239 offset:9472
    v_mov_b32 v192, v12
    v_mov_b32 v193, v28
    s_nop 2
    v_cvt_pk_bf16_f32 v32, v32, v33
    v_cvt_pk_bf16_f32 v33, v34, v35
    v_cvt_pk_bf16_f32 v34, v36, v37
    v_cvt_pk_bf16_f32 v35, v38, v39
    v_cvt_pk_bf16_f32 v36, v40, v41
    ds_write_b128 v249, v[96:99] offset:0
    v_cvt_pk_bf16_f32 v37, v42, v43
    v_cvt_pk_bf16_f32 v38, v44, v45
    v_cvt_pk_bf16_f32 v39, v46, v47
    v_cvt_pk_bf16_f32 v40, v48, v49
    v_mfma_f32_32x32x16_bf16 v[144:159], a[224:227], a[4:7], 0
    v_cvt_pk_bf16_f32 v41, v50, v51
    ds_write_b128 v249, v[100:103] offset:1024
    v_cvt_pk_bf16_f32 v42, v52, v53
    v_cvt_pk_bf16_f32 v43, v54, v55
    v_cvt_pk_bf16_f32 v44, v56, v57
    v_cvt_pk_bf16_f32 v45, v58, v59
    v_cvt_pk_bf16_f32 v46, v60, v61
    ds_write_b128 v249, v[104:107] offset:2048
    v_cvt_pk_bf16_f32 v47, v62, v63
    v_cvt_pk_bf16_f32 v64, v64, v65
    v_cvt_pk_bf16_f32 v65, v66, v67
    v_cvt_pk_bf16_f32 v66, v68, v69
    s_waitcnt lgkmcnt(3)
    v_mfma_f32_32x32x16_bf16 v[128:143], a[228:231], a[8:11], v[128:143]
    ds_read_b64_tr_b16 a[224:225], v239 offset:10240
    ds_read_b64_tr_b16 a[226:227], v239 offset:10496
    v_cvt_pk_bf16_f32 v67, v70, v71
    ds_write_b128 v249, v[108:111] offset:3072
    v_cvt_pk_bf16_f32 v68, v72, v73
    v_cvt_pk_bf16_f32 v69, v74, v75
    v_cvt_pk_bf16_f32 v70, v76, v77
    v_cvt_pk_bf16_f32 v71, v78, v79
    v_cvt_pk_bf16_f32 v72, v80, v81
    ds_write_b128 v249, v[120:123] offset:4096
    v_cvt_pk_bf16_f32 v73, v82, v83
    v_cvt_pk_bf16_f32 v74, v84, v85
    v_mfma_f32_32x32x16_bf16 v[144:159], a[228:231], a[12:15], v[144:159]
    v_cvt_pk_bf16_f32 v75, v86, v87
    v_cvt_pk_bf16_f32 v76, v88, v89
    v_cvt_pk_bf16_f32 v77, v90, v91
    ds_write_b128 v249, v[124:127] offset:5120
    v_cvt_pk_bf16_f32 v78, v92, v93
    v_cvt_pk_bf16_f32 v79, v94, v95
    ds_write_b128 v254, v[40:43] offset:3072
    v_cvt_pk_bf16_f32 v0, v0, v1
    v_cvt_pk_bf16_f32 v1, v2, v3
    v_cvt_pk_bf16_f32 v2, v4, v5
    v_cvt_pk_bf16_f32 v3, v6, v7
    v_cvt_pk_bf16_f32 v4, v8, v9
    s_waitcnt lgkmcnt(4)
    v_mfma_f32_32x32x16_bf16 v[128:143], a[224:227], a[16:19], v[128:143]
    ds_read_b64_tr_b16 a[228:229], v239 offset:11264
    ds_read_b64_tr_b16 a[230:231], v239 offset:11520
    ds_write_b128 v254, v[44:47] offset:4096
    v_cvt_pk_bf16_f32 v5, v10, v11
    v_cvt_pk_bf16_f32 v6, v12, v13
    v_cvt_pk_bf16_f32 v7, v14, v15
    v_cvt_pk_bf16_f32 v8, v16, v17
    v_cvt_pk_bf16_f32 v9, v18, v19
    ds_write_b128 v254, v[76:79] offset:5120
    v_cvt_pk_bf16_f32 v10, v20, v21
    v_cvt_pk_bf16_f32 v11, v22, v23
    v_cvt_pk_bf16_f32 v12, v24, v25
    v_mfma_f32_32x32x16_bf16 v[144:159], a[224:227], a[20:23], v[144:159]
    v_cvt_pk_bf16_f32 v13, v26, v27
    v_cvt_pk_bf16_f32 v14, v28, v29
    v_cvt_pk_bf16_f32 v15, v30, v31
    v_cndmask_b32 v6, 0, v6, s[80:81]
    v_cndmask_b32 v7, 0, v7, s[80:81]
    v_cndmask_b32 v14, 0, v14, s[80:81]
    v_cndmask_b32 v15, 0, v15, s[80:81]
    s_waitcnt lgkmcnt(0)
    s_barrier
    ds_read_b128 v[48:51], v250 offset:0
    ds_read_b64 v[200:201], v251 offset:0
    ds_read_b128 v[52:55], v250 offset:6144
    ds_read_b64 v[202:203], v251 offset:6144
    ds_read_b128 v[56:59], v250 offset:12288
    ds_read_b64 v[204:205], v251 offset:12288
    ds_read_b128 v[60:63], v250 offset:18432
    ds_read_b64 v[206:207], v251 offset:18432
    v_mfma_f32_32x32x16_bf16 v[128:143], a[228:231], a[24:27], v[128:143]
    ds_read_b64_tr_b16 a[224:225], v239 offset:32768
    ds_read_b64_tr_b16 a[226:227], v239 offset:33024
    s_mov_b32 vcc_lo, 0xffffaaaa
    s_mov_b32 vcc_hi, 0xfffaaaaf
    v_cndmask_b32 v96, 0, v248, vcc
    s_mov_b32 vcc_lo, 0xffff5555
    s_mov_b32 vcc_hi, 0xfff5555f
    v_cndmask_b32 v97, 0, v248, vcc
    s_mov_b32 vcc_lo, 0xfffeaaab
    s_mov_b32 vcc_hi, 0xffeaaabf
    v_cndmask_b32 v98, 0, v248, vcc
    s_mov_b32 vcc_lo, 0xfffd5557
    s_mov_b32 vcc_hi, 0xffd5557f
    v_cndmask_b32 v99, 0, v248, vcc
    v_mfma_f32_32x32x16_bf16 v[144:159], a[228:231], a[28:31], v[144:159]
    s_mov_b32 vcc_lo, 0xffaaaaff
    s_mov_b32 vcc_hi, 0xfaaaafff
    v_cndmask_b32 v100, 0, v248, vcc
    s_mov_b32 vcc_lo, 0xff5555ff
    s_mov_b32 vcc_hi, 0xf5555fff
    v_cndmask_b32 v101, 0, v248, vcc
    s_mov_b32 vcc_lo, 0xfeaaabff
    s_mov_b32 vcc_hi, 0xeaaabfff
    v_cndmask_b32 v102, 0, v248, vcc
    s_mov_b32 vcc_lo, 0xfd5557ff
    s_mov_b32 vcc_hi, 0xd5557fff
    v_cndmask_b32 v103, 0, v248, vcc
    s_mov_b32 vcc_lo, 0xaaaaffff
    s_mov_b32 vcc_hi, 0xaaafffff
    v_cndmask_b32 v104, 0, v248, vcc
    s_waitcnt lgkmcnt(0)
    v_mfma_f32_32x32x16_bf16 v[128:143], a[224:227], a[32:35], v[128:143]
    ds_read_b64_tr_b16 a[228:229], v239 offset:33792
    ds_read_b64_tr_b16 a[230:231], v239 offset:34048
    s_add_u32 m0, s26, 0
    s_nop 0
    buffer_load_dwordx4 v223, s[56:59], 0 offen lds
    s_mov_b32 vcc_lo, 0x5555ffff
    s_mov_b32 vcc_hi, 0x555fffff
    v_cndmask_b32 v105, 0, v248, vcc
    s_mov_b32 vcc_lo, 0xaaabffff
    s_mov_b32 vcc_hi, 0xaabfffff
    v_cndmask_b32 v106, 0, v248, vcc
    s_mov_b32 vcc_lo, 0x5557ffff
    s_mov_b32 vcc_hi, 0x557fffff
    v_cndmask_b32 v107, 0, v248, vcc
    s_mov_b32 vcc_lo, 0xaaffffff
    s_mov_b32 vcc_hi, 0xafffffff
    v_cndmask_b32 v108, 0, v248, vcc
    v_mfma_f32_32x32x16_bf16 v[144:159], a[224:227], a[36:39], v[144:159]
    s_add_u32 m0, s26, 0x400
    s_mov_b32 s75, 0x1c00
    buffer_load_dwordx4 v223, s[56:59], s75 offen lds
    s_mov_b32 vcc_lo, 0x55ffffff
    s_mov_b32 vcc_hi, 0x5fffffff
    v_cndmask_b32 v109, 0, v248, vcc
    s_mov_b32 vcc_lo, 0xabffffff
    s_mov_b32 vcc_hi, 0xbfffffff
    v_cndmask_b32 v110, 0, v248, vcc
    s_mov_b32 vcc_lo, 0x57ffffff
    s_mov_b32 vcc_hi, 0x7fffffff
    v_cndmask_b32 v111, 0, v248, vcc
    s_mov_b32 vcc_lo, 0xffffffff
    s_mov_b32 vcc_hi, 0xfffffffa
    v_cndmask_b32 v112, 0, v248, vcc
    s_waitcnt lgkmcnt(0)
    v_mfma_f32_32x32x16_bf16 v[128:143], a[228:231], a[40:43], v[128:143]
    ds_read_b64_tr_b16 a[224:225], v239 offset:34816
    ds_read_b64_tr_b16 a[226:227], v239 offset:35072
    s_add_u32 m0, s70, 0
    s_mov_b32 s75, 0x3800
    buffer_load_dwordx4 v223, s[56:59], s75 offen lds
    s_mov_b32 vcc_lo, 0xffffffff
    s_mov_b32 vcc_hi, 0xfffffff5
    v_cndmask_b32 v113, 0, v248, vcc
    s_mov_b32 vcc_lo, 0xfffffffe
    s_mov_b32 vcc_hi, 0xffffffea
    v_cndmask_b32 v114, 0, v248, vcc
    s_mov_b32 vcc_lo, 0xfffffffd
    s_mov_b32 vcc_hi, 0xffffffd5
    v_cndmask_b32 v115, 0, v248, vcc
    v_mfma_f32_32x32x16_bf16 v[144:159], a[228:231], a[44:47], v[144:159]
    s_add_u32 m0, s70, 0x400
    s_mov_b32 s75, 0x5400
    buffer_load_dwordx4 v223, s[56:59], s75 offen lds
    s_mov_b32 vcc_lo, 0xffffffaa
    s_mov_b32 vcc_hi, 0xfffffaaa
    v_cndmask_b32 v116, 0, v248, vcc
    s_mov_b32 vcc_lo, 0xffffff55
    s_mov_b32 vcc_hi, 0xfffff555
    v_cndmask_b32 v117, 0, v248, vcc
    s_mov_b32 vcc_lo, 0xfffffeaa
    s_mov_b32 vcc_hi, 0xffffeaaa
    v_cndmask_b32 v118, 0, v248, vcc
    s_mov_b32 vcc_lo, 0xfffffd55
    s_mov_b32 vcc_hi, 0xffffd555
    v_cndmask_b32 v119, 0, v248, vcc
    v_mfma_f32_32x32x16_bf16 v[80:95], v[40:43], v[8:11], v[96:111]
    s_waitcnt lgkmcnt(0)
    v_mfma_f32_32x32x16_bf16 v[128:143], a[224:227], a[48:51], v[128:143]
    ds_read_b64_tr_b16 a[228:229], v239 offset:35840
    ds_read_b64_tr_b16 a[230:231], v239 offset:36096
    s_add_u32 m0, s70, 0x800
    s_mov_b32 s75, 0x7000
    buffer_load_dwordx4 v223, s[56:59], s75 offen lds
    v_mfma_f32_32x32x16_bf16 v[16:31], v[32:35], v[8:11], v[104:119]
    v_mfma_f32_32x32x16_bf16 v[80:95], v[44:47], v[12:15], v[80:95]
    v_mfma_f32_32x32x16_bf16 v[16:31], v[36:39], v[12:15], v[16:31]
    v_add_f32 v48, v48, v52
    v_add_f32 v56, v56, v60
    v_add_f32 v49, v49, v53
    v_add_f32 v57, v57, v61
    v_add_f32 v50, v50, v54
    v_add_f32 v58, v58, v62
    v_add_f32 v51, v51, v55
    v_add_f32 v59, v59, v63
    v_mfma_f32_32x32x16_bf16 v[144:159], a[224:227], a[52:55], v[144:159]
    s_add_u32 m0, s70, 0xc00
    s_mov_b32 s75, 0x8c00
    buffer_load_dwordx4 v223, s[56:59], s75 offen lds
    v_add_f32 v200, v200, v202
    v_add_f32 v204, v204, v206
    v_add_f32 v201, v201, v203
    v_add_f32 v205, v205, v207
    v_add_f32 v48, v48, v56
    v_add_f32 v49, v49, v57
    v_add_f32 v50, v50, v58
    v_add_f32 v51, v51, v59
    v_add_f32 v200, v200, v204
    v_add_f32 v201, v201, v205
    v_cvt_pk_bf16_f32 v48, v48, v49
    v_cvt_pk_bf16_f32 v49, v50, v51
    v_cvt_pk_bf16_f32 v200, v200, v201
    s_waitcnt lgkmcnt(0)
    v_mfma_f32_32x32x16_bf16 v[128:143], a[228:231], a[56:59], v[128:143]
    ds_read_b64_tr_b16 a[224:225], v240 offset:8192
    ds_read_b64_tr_b16 a[226:227], v240 offset:8448
    s_add_u32 m0, s70, 0x1000
    s_mov_b32 s75, 0xa800
    buffer_load_dwordx4 v223, s[56:59], s75 offen lds
    ds_write_b64 v252, v[48:49] offset:0
    ds_write_b32 v253, v200 offset:0
    s_lshl_b32 s64, s61, 2
    s_add_u32 s64, s64, s60
    s_lshl_b32 s64, s64, 2
    s_add_u32 s64, s64, s62
    s_lshl_b32 s64, s64, 2
    s_add_u32 s64, s64, s63
    s_lshl_b32 s64, s64, 9
    s_add_u32 s64, s64, 0xbff800
    v_mfma_f32_32x32x16_bf16 v[144:159], a[228:231], a[60:63], v[144:159]
    s_add_u32 m0, s70, 0x1400
    s_mov_b32 s75, 0xc400
    buffer_load_dwordx4 v223, s[56:59], s75 offen lds
    v_lshlrev_b32 v249, 2, v247
    v_add_u32 v249, s64, v249
    v_max3_f32 v120, v80, v81, v82
    v_max3_f32 v121, v83, v84, v85
    v_max3_f32 v120, v120, v86, v87
    v_max3_f32 v121, v121, v88, v89
    v_max3_f32 v120, v120, v90, v91
    v_max3_f32 v121, v121, v92, v93
    v_max3_f32 v120, v120, v94, v95
    v_max3_f32 v121, v121, v24, v25
    v_max3_f32 v120, v120, v26, v27
    v_max3_f32 v121, v121, v28, v29
    v_max3_f32 v120, v120, v30, v31
    s_waitcnt lgkmcnt(2)
    v_mfma_f32_32x32x16_bf16 v[128:143], a[224:227], a[64:67], v[128:143]
    ds_read_b64_tr_b16 a[228:229], v240 offset:9216
    ds_read_b64_tr_b16 a[230:231], v240 offset:9472
    s_add_u32 m0, s70, 0x1800
    s_mov_b32 s75, 0xe000
    buffer_load_dwordx4 v223, s[56:59], s75 offen lds
    v_max_f32 v120, v120, v121
    v_mov_b32 v121, v120
    v_mul_f32 v193, 0xbfb8aa3b, v193
    v_exp_f32 v193, v193
    v_permlane32_swap_b32 v120, v121
    v_max_f32 v120, v120, v121
    v_mul_f32 v124, 0xbe8b97f6, v120
    v_fma_f32 v80, v80, s83, v124
    v_fma_f32 v81, v81, s83, v124
    v_fma_f32 v82, v82, s83, v124
    v_mfma_f32_32x32x16_bf16 v[144:159], a[224:227], a[68:71], v[144:159]
    s_add_u32 m0, s70, 0x1c00
    s_mov_b32 s75, 0xfc00
    buffer_load_dwordx4 v223, s[56:59], s75 offen lds
    v_fma_f32 v83, v83, s83, v124
    v_fma_f32 v84, v84, s83, v124
    v_fma_f32 v85, v85, s83, v124
    v_fma_f32 v86, v86, s83, v124
    v_fma_f32 v87, v87, s83, v124
    v_fma_f32 v88, v88, s83, v124
    v_fma_f32 v89, v89, s83, v124
    v_fma_f32 v90, v90, s83, v124
    v_fma_f32 v91, v91, s83, v124
    v_fma_f32 v92, v92, s83, v124
    v_fma_f32 v93, v93, s83, v124
    v_fma_f32 v94, v94, s83, v124
    v_fma_f32 v95, v95, s83, v124
    s_waitcnt lgkmcnt(0)
    v_mfma_f32_32x32x16_bf16 v[128:143], a[228:231], a[72:75], v[128:143]
    ds_read_b64_tr_b16 a[224:225], v240 offset:10240
    ds_read_b64_tr_b16 a[226:227], v240 offset:10496
    v_fma_f32 v24, v24, s83, v124
    v_fma_f32 v25, v25, s83, v124
    v_fma_f32 v26, v26, s83, v124
    v_fma_f32 v27, v27, s83, v124
    v_fma_f32 v28, v28, s83, v124
    v_fma_f32 v29, v29, s83, v124
    v_fma_f32 v30, v30, s83, v124
    v_fma_f32 v31, v31, s83, v124
    v_exp_f32 v80, v80
    v_exp_f32 v81, v81
    v_exp_f32 v82, v82
    v_mfma_f32_32x32x16_bf16 v[144:159], a[228:231], a[76:79], v[144:159]
    v_exp_f32 v83, v83
    v_exp_f32 v84, v84
    v_exp_f32 v85, v85
    v_exp_f32 v86, v86
    v_exp_f32 v87, v87
    v_exp_f32 v88, v88
    v_exp_f32 v89, v89
    v_exp_f32 v90, v90
    s_waitcnt lgkmcnt(0)
    v_mfma_f32_32x32x16_bf16 v[128:143], a[224:227], a[80:83], v[128:143]
    ds_read_b64_tr_b16 a[228:229], v240 offset:11264
    ds_read_b64_tr_b16 a[230:231], v240 offset:11520
    v_exp_f32 v91, v91
    v_exp_f32 v92, v92
    v_exp_f32 v93, v93
    v_exp_f32 v94, v94
    v_exp_f32 v95, v95
    v_exp_f32 v24, v24
    v_exp_f32 v25, v25
    v_mfma_f32_32x32x16_bf16 v[144:159], a[224:227], a[84:87], v[144:159]
    v_exp_f32 v26, v26
    v_exp_f32 v27, v27
    v_exp_f32 v28, v28
    v_exp_f32 v29, v29
    v_exp_f32 v30, v30
    v_exp_f32 v31, v31
    v_add_f32 v193, 1.0, v193
    v_add_f32 v122, v80, v81
    v_add_f32 v123, v82, v83
    v_add_f32 v122, v122, v84
    s_waitcnt lgkmcnt(0)
    v_mfma_f32_32x32x16_bf16 v[128:143], a[228:231], a[88:91], v[128:143]
    ds_read_b64_tr_b16 a[224:225], v240 offset:32768
    ds_read_b64_tr_b16 a[226:227], v240 offset:33024
    v_add_f32 v123, v123, v85
    v_add_f32 v122, v122, v86
    v_add_f32 v123, v123, v87
    v_add_f32 v122, v122, v88
    v_add_f32 v123, v123, v89
    v_add_f32 v122, v122, v90
    v_add_f32 v123, v123, v91
    v_add_f32 v122, v122, v92
    v_add_f32 v123, v123, v93
    v_add_f32 v122, v122, v94
    v_add_f32 v123, v123, v95
    v_add_f32 v122, v122, v24
    v_add_f32 v123, v123, v25
    v_add_f32 v122, v122, v26
    v_mfma_f32_32x32x16_bf16 v[144:159], a[228:231], a[92:95], v[144:159]
    v_add_f32 v123, v123, v27
    v_add_f32 v122, v122, v28
    v_add_f32 v123, v123, v29
    v_add_f32 v122, v122, v30
    v_add_f32 v123, v123, v31
    v_cvt_pk_bf16_f32 v80, v80, v81
    v_cvt_pk_bf16_f32 v81, v82, v83
    v_cvt_pk_bf16_f32 v82, v84, v85
    v_cvt_pk_bf16_f32 v83, v86, v87
    v_cvt_pk_bf16_f32 v84, v88, v89
    v_cvt_pk_bf16_f32 v85, v90, v91
    v_cvt_pk_bf16_f32 v86, v92, v93
    v_cvt_pk_bf16_f32 v87, v94, v95
    v_cvt_pk_bf16_f32 v24, v24, v25
    v_cvt_pk_bf16_f32 v25, v26, v27
    v_cvt_pk_bf16_f32 v26, v28, v29
    s_waitcnt lgkmcnt(0)
    v_mfma_f32_32x32x16_bf16 v[128:143], a[224:227], a[96:99], v[128:143]
    ds_read_b64_tr_b16 a[228:229], v240 offset:33792
    ds_read_b64_tr_b16 a[230:231], v240 offset:34048
    v_cvt_pk_bf16_f32 v27, v30, v31
    v_add_f32 v122, v122, v123
    v_mov_b32 v123, v122
    v_mfma_f32_32x32x16_bf16 v[48:63], v[72:75], v[80:83], 0
    v_mfma_f32_32x32x16_bf16 v[48:63], v[76:79], v[84:87], v[48:63]
    v_mfma_f32_32x32x16_bf16 v[48:63], v[68:71], v[24:27], v[48:63]
    v_permlane32_swap_b32 v122, v123
    v_add_f32 v122, v122, v123
    v_rcp_f32 v125, v122
    v_rcp_f32 v193, v193
    v_cndmask_b32 v126, 0, v125, s[80:81]
    buffer_store_dword v193, v249, s[52:55], 0 offen offset:256 sc1
    v_mfma_f32_32x32x16_bf16 v[144:159], a[224:227], a[100:103], v[144:159]
    s_barrier
    ds_read_b128 a[240:243], v254 offset:0
    ds_read_b128 a[244:247], v254 offset:1024
    ds_read_b128 a[248:251], v254 offset:2048
    s_mov_b64 vcc, s[0:1]
    v_cndmask_b32 v112, v248, v112, vcc
    v_cndmask_b32 v113, v248, v113, vcc
    v_cndmask_b32 v114, v248, v114, vcc
    v_cndmask_b32 v115, v248, v115, vcc
    v_cndmask_b32 v116, v248, v116, vcc
    v_cndmask_b32 v117, v248, v117, vcc
    v_cndmask_b32 v118, v248, v118, vcc
    v_cndmask_b32 v119, v248, v119, vcc
    v_mfma_f32_32x32x16_bf16 v[80:95], v[32:35], v[0:3], v[96:111]
    s_waitcnt lgkmcnt(2)
    v_mfma_f32_32x32x16_bf16 v[16:31], a[240:243], v[0:3], v[104:119]
    v_mfma_f32_32x32x16_bf16 v[80:95], v[36:39], v[4:7], v[80:95]
    v_mfma_f32_32x32x16_bf16 v[128:143], a[228:231], a[104:107], v[128:143]
    ds_read_b64_tr_b16 a[224:225], v240 offset:34816
    ds_read_b64_tr_b16 a[226:227], v240 offset:35072
    s_waitcnt lgkmcnt(3)
    v_mfma_f32_32x32x16_bf16 v[16:31], a[244:247], v[4:7], v[16:31]
    s_waitcnt lgkmcnt(2)
    s_barrier
    v_mul_f32 v48, v48, v125
    v_mul_f32 v49, v49, v125
    v_mul_f32 v50, v50, v125
    v_mul_f32 v51, v51, v125
    v_mul_f32 v52, v52, v125
    v_mul_f32 v53, v53, v125
    v_mul_f32 v54, v54, v125
    v_mul_f32 v55, v55, v125
    v_mul_f32 v56, v56, v125
    v_mul_f32 v57, v57, v125
    v_mul_f32 v58, v58, v125
    v_mul_f32 v59, v59, v125
    v_mfma_f32_32x32x16_bf16 v[144:159], a[228:231], a[108:111], v[144:159]
    v_mul_f32 v60, v60, v126
    v_mul_f32 v61, v61, v126
    v_mul_f32 v62, v62, v126
    v_mul_f32 v63, v63, v126
    v_cvt_pk_bf16_f32 v48, v48, v49
    v_cvt_pk_bf16_f32 v49, v50, v51
    v_cvt_pk_bf16_f32 v50, v52, v53
    v_cvt_pk_bf16_f32 v51, v54, v55
    v_cvt_pk_bf16_f32 v52, v56, v57
    v_cvt_pk_bf16_f32 v53, v58, v59
    v_cvt_pk_bf16_f32 v54, v60, v61
    v_cvt_pk_bf16_f32 v55, v62, v63
    buffer_store_dwordx4 v[48:51], v246, s[52:55], 0 offen offset:1024 sc1
    buffer_store_dwordx4 v[52:55], v246, s[52:55], 0 offen offset:3072 sc1
    v_max3_f32 v120, v80, v81, v82
    v_max3_f32 v121, v83, v84, v85
    s_waitcnt lgkmcnt(0)
    v_mfma_f32_32x32x16_bf16 v[128:143], a[224:227], a[112:115], v[128:143]
    ds_read_b64_tr_b16 a[228:229], v240 offset:35840
    ds_read_b64_tr_b16 a[230:231], v240 offset:36096
    s_add_u32 m0, s3, 0
    s_mov_b32 s75, 0x11800
    buffer_load_dwordx4 v223, s[56:59], s75 offen lds
    v_max3_f32 v120, v120, v86, v87
    v_max3_f32 v121, v121, v88, v89
    v_max3_f32 v120, v120, v90, v91
    v_max3_f32 v121, v121, v92, v93
    v_max3_f32 v120, v120, v94, v95
    v_max3_f32 v121, v121, v24, v25
    v_max3_f32 v120, v120, v26, v27
    v_max3_f32 v121, v121, v28, v29
    v_max3_f32 v120, v120, v30, v31
    v_max_f32 v120, v120, v121
    v_mov_b32 v121, v120
    v_mfma_f32_32x32x16_bf16 v[144:159], a[224:227], a[116:119], v[144:159]
    s_add_u32 m0, s3, 0x400
    s_mov_b32 s75, 0x13400
    buffer_load_dwordx4 v223, s[56:59], s75 offen lds
    v_mul_f32 v192, 0xbfb8aa3b, v192
    v_exp_f32 v192, v192
    v_permlane32_swap_b32 v120, v121
    v_max_f32 v120, v120, v121
    v_mul_f32 v124, 0xbe8b97f6, v120
    v_fma_f32 v80, v80, s83, v124
    v_fma_f32 v81, v81, s83, v124
    v_fma_f32 v82, v82, s83, v124
    v_fma_f32 v83, v83, s83, v124
    v_fma_f32 v84, v84, s83, v124
    v_fma_f32 v85, v85, s83, v124
    v_fma_f32 v86, v86, s83, v124
    s_waitcnt lgkmcnt(0)
    v_mfma_f32_32x32x16_bf16 v[128:143], a[228:231], a[120:123], v[128:143]
    s_waitcnt lgkmcnt(0)
    s_waitcnt vmcnt(15)
    s_barrier
    ds_read_b64_tr_b16 a[224:225], v239 offset:16384
    ds_read_b64_tr_b16 a[226:227], v239 offset:16640
    s_add_u32 m0, s3, 0x800
    s_mov_b32 s75, 0x15000
    buffer_load_dwordx4 v223, s[56:59], s75 offen lds
    v_fma_f32 v87, v87, s83, v124
    v_fma_f32 v88, v88, s83, v124
    v_fma_f32 v89, v89, s83, v124
    v_fma_f32 v90, v90, s83, v124
    v_fma_f32 v91, v91, s83, v124
    v_fma_f32 v92, v92, s83, v124
    v_fma_f32 v93, v93, s83, v124
    v_fma_f32 v94, v94, s83, v124
    v_fma_f32 v95, v95, s83, v124
    v_fma_f32 v24, v24, s83, v124
    v_fma_f32 v25, v25, s83, v124
    v_mfma_f32_32x32x16_bf16 v[144:159], a[228:231], a[124:127], v[144:159]
    s_add_u32 m0, s3, 0xc00
    s_mov_b32 s75, 0x16c00
    buffer_load_dwordx4 v223, s[56:59], s75 offen lds
    v_fma_f32 v26, v26, s83, v124
    v_fma_f32 v27, v27, s83, v124
    v_fma_f32 v28, v28, s83, v124
    v_fma_f32 v29, v29, s83, v124
    v_fma_f32 v30, v30, s83, v124
    v_fma_f32 v31, v31, s83, v124
    v_exp_f32 v80, v80
    v_exp_f32 v81, v81
    v_exp_f32 v82, v82
    s_waitcnt lgkmcnt(0)
    v_mfma_f32_32x32x16_bf16 v[128:143], a[224:227], a[128:131], v[128:143]
    ds_read_b64_tr_b16 a[228:229], v239 offset:17408
    ds_read_b64_tr_b16 a[230:231], v239 offset:17664
    s_add_u32 m0, s3, 0x1000
    s_mov_b32 s75, 0x18800
    buffer_load_dwordx4 v223, s[56:59], s75 offen lds
    v_exp_f32 v83, v83
    v_exp_f32 v84, v84
    v_exp_f32 v85, v85
    v_exp_f32 v86, v86
    v_exp_f32 v87, v87
    v_mfma_f32_32x32x16_bf16 v[144:159], a[224:227], a[132:135], v[144:159]
    s_add_u32 m0, s3, 0x1400
    s_mov_b32 s75, 0x1a400
    buffer_load_dwordx4 v223, s[56:59], s75 offen lds
    v_exp_f32 v88, v88
    v_exp_f32 v89, v89
    v_exp_f32 v90, v90
    v_exp_f32 v91, v91
    v_exp_f32 v92, v92
    v_exp_f32 v93, v93
    s_waitcnt lgkmcnt(0)
    v_mfma_f32_32x32x16_bf16 v[128:143], a[228:231], a[136:139], v[128:143]
    ds_read_b64_tr_b16 a[224:225], v239 offset:18432
    ds_read_b64_tr_b16 a[226:227], v239 offset:18688
    s_add_u32 m0, s3, 0x1800
    s_mov_b32 s75, 0x1c000
    buffer_load_dwordx4 v223, s[56:59], s75 offen lds
    v_exp_f32 v94, v94
    v_exp_f32 v95, v95
    v_exp_f32 v24, v24
    v_exp_f32 v25, v25
    v_exp_f32 v26, v26
    v_mfma_f32_32x32x16_bf16 v[144:159], a[228:231], a[140:143], v[144:159]
    s_add_u32 m0, s3, 0x1c00
    s_mov_b32 s75, 0x1dc00
    buffer_load_dwordx4 v223, s[56:59], s75 offen lds
    v_exp_f32 v27, v27
    v_exp_f32 v28, v28
    v_exp_f32 v29, v29
    v_exp_f32 v30, v30
    v_exp_f32 v31, v31
    v_add_f32 v192, 1.0, v192
    v_add_f32 v122, v80, v81
    v_add_f32 v123, v82, v83
    s_waitcnt lgkmcnt(0)
    v_mfma_f32_32x32x16_bf16 v[128:143], a[224:227], a[144:147], v[128:143]
    ds_read_b64_tr_b16 a[228:229], v239 offset:19456
    ds_read_b64_tr_b16 a[230:231], v239 offset:19712
    s_add_u32 m0, s3, 0x2000
    s_mov_b32 s75, 0x1f800
    buffer_load_dwordx4 v223, s[56:59], s75 offen lds
    v_add_f32 v122, v122, v84
    v_add_f32 v123, v123, v85
    v_add_f32 v122, v122, v86
    v_add_f32 v123, v123, v87
    v_add_f32 v122, v122, v88
    v_add_f32 v123, v123, v89
    v_add_f32 v122, v122, v90
    v_add_f32 v123, v123, v91
    v_add_f32 v122, v122, v92
    v_add_f32 v123, v123, v93
    v_add_f32 v122, v122, v94
    v_mfma_f32_32x32x16_bf16 v[144:159], a[224:227], a[148:151], v[144:159]
    s_add_u32 m0, s3, 0x2400
    s_mov_b32 s75, 0x21400
    buffer_load_dwordx4 v223, s[56:59], s75 offen lds
    v_add_f32 v123, v123, v95
    v_add_f32 v122, v122, v24
    v_add_f32 v123, v123, v25
    v_add_f32 v122, v122, v26
    v_add_f32 v123, v123, v27
    v_add_f32 v122, v122, v28
    v_add_f32 v123, v123, v29
    v_add_f32 v122, v122, v30
    v_add_f32 v123, v123, v31
    v_cvt_pk_bf16_f32 v80, v80, v81
    v_cvt_pk_bf16_f32 v81, v82, v83
    v_cvt_pk_bf16_f32 v82, v84, v85
    v_cvt_pk_bf16_f32 v83, v86, v87
    s_waitcnt lgkmcnt(0)
    v_mfma_f32_32x32x16_bf16 v[128:143], a[228:231], a[152:155], v[128:143]
    ds_read_b64_tr_b16 a[224:225], v239 offset:40960
    ds_read_b64_tr_b16 a[226:227], v239 offset:41216
    s_add_u32 m0, s3, 0x2800
    s_mov_b32 s75, 0x23000
    buffer_load_dwordx4 v223, s[56:59], s75 offen lds
    v_cvt_pk_bf16_f32 v84, v88, v89
    v_cvt_pk_bf16_f32 v85, v90, v91
    v_cvt_pk_bf16_f32 v86, v92, v93
    v_cvt_pk_bf16_f32 v87, v94, v95
    v_cvt_pk_bf16_f32 v24, v24, v25
    v_cvt_pk_bf16_f32 v25, v26, v27
    v_cvt_pk_bf16_f32 v26, v28, v29
    v_cvt_pk_bf16_f32 v27, v30, v31
    v_add_f32 v122, v122, v123
    v_mov_b32 v123, v122
    v_mfma_f32_32x32x16_bf16 v[48:63], v[64:67], v[80:83], 0
    v_mfma_f32_32x32x16_bf16 v[144:159], a[228:231], a[156:159], v[144:159]
    s_add_u32 m0, s3, 0x2c00
    s_mov_b32 s75, 0x24c00
    buffer_load_dwordx4 v223, s[56:59], s75 offen lds
    v_mfma_f32_32x32x16_bf16 v[48:63], v[68:71], v[84:87], v[48:63]
    v_mfma_f32_32x32x16_bf16 v[48:63], a[248:251], v[24:27], v[48:63]
    v_permlane32_swap_b32 v122, v123
    v_add_f32 v122, v122, v123
    v_rcp_f32 v125, v122
    v_rcp_f32 v192, v192
    v_cndmask_b32 v126, 0, v125, s[80:81]
    buffer_store_dword v192, v249, s[52:55], 0 offen offset:0 sc1
    v_lshrrev_b32 v243, 5, v247
    v_bfe_u32 v213, v247, 2, 2
    v_bfe_u32 v214, v247, 4, 1
    s_waitcnt lgkmcnt(0)
    v_mfma_f32_32x32x16_bf16 v[128:143], a[224:227], a[160:163], v[128:143]
    ds_read_b64_tr_b16 a[228:229], v239 offset:41984
    ds_read_b64_tr_b16 a[230:231], v239 offset:42240
    v_and_b32 v255, 3, v247
    v_lshl_add_u32 v214, v214, 2, v255
    v_and_b32 v255, 1, v214
    v_lshrrev_b32 v215, 1, v214
    v_lshl_add_u32 v215, v255, 2, v215
    v_lshl_add_u32 v255, v243, 2, v213
    v_lshlrev_b32 v255, 7, v255
    v_lshl_add_u32 v255, v215, 3, v255
    v_lshrrev_b32 v212, 1, v213
    v_lshl_add_u32 v214, v212, 6, v255
    v_xor_b32 v212, 1, v212
    v_lshl_add_u32 v215, v212, 6, v255
    v_add_u32 v232, s70, v214
    v_add_u32 v233, s70, v215
    v_mfma_f32_32x32x16_bf16 v[144:159], a[224:227], a[164:167], v[144:159]
    v_add_u32 v234, s26, v214
    v_add_u32 v235, s26, v215
    v_add_u32 v236, s3, v214
    v_add_u32 v237, s3, v215
    s_lshl_b32 s82, s61, 2
    s_add_u32 s82, s82, s62
    s_mul_i32 s65, s82, 0x90
    s_mul_i32 s66, s60, 36
    s_add_u32 s65, s65, s66
    s_lshl_b32 s65, s65, 11
    v_add_u32 v225, s65, v224
    s_mov_b32 s68, s65
    v_min_u32 v255, 36, v247
    s_mul_i32 s66, s85, 37
    v_add_u32 v255, s66, v255
    v_min_u32 v255, 0xff, v255
    s_waitcnt lgkmcnt(0)
    v_mfma_f32_32x32x16_bf16 v[128:143], a[228:231], a[168:171], v[128:143]
    ds_read_b64_tr_b16 a[224:225], v239 offset:43008
    ds_read_b64_tr_b16 a[226:227], v239 offset:43264
    v_lshlrev_b32 v255, 7, v255
    s_add_u32 s66, s68, 0
    v_add_u32 v194, s66, v255
    v_min_u32 v255, 18, v247
    s_mul_i32 s66, s85, 19
    v_add_u32 v255, s66, v255
    v_min_u32 v255, 0x7f, v255
    v_lshlrev_b32 v255, 7, v255
    s_add_u32 s66, s68, 0x8000
    v_add_u32 v195, s66, v255
    v_min_u32 v255, 27, v247
    s_mul_i32 s66, s85, 28
    v_add_u32 v255, s66, v255
    v_min_u32 v255, 0xbf, v255
    v_mfma_f32_32x32x16_bf16 v[144:159], a[228:231], a[172:175], v[144:159]
    v_lshlrev_b32 v255, 7, v255
    s_add_u32 s66, s68, 0xc000
    v_add_u32 v196, s66, v255
    v_add_u32 v226, s3, v224
    v_add_u32 v227, 0x18000, v224
    v_and_b32 v255, 31, v247
    s_lshl_b32 s65, s82, 2
    s_add_u32 s65, s65, s60
    s_lshl_b32 s65, s65, 11
    s_add_u32 s65, s65, 0xc00080
    v_lshl_add_u32 v238, v255, 2, s65
    s_lshl_b32 s65, s82, 6
    s_lshr_b32 s66, s60, 1
    s_lshl_b32 s66, s66, 5
    s_add_u32 s65, s65, s66
    v_add_u32 v255, s65, v255
    s_waitcnt lgkmcnt(0)
    v_mfma_f32_32x32x16_bf16 v[128:143], a[224:227], a[176:179], v[128:143]
    ds_read_b64_tr_b16 a[228:229], v239 offset:44032
    ds_read_b64_tr_b16 a[230:231], v239 offset:44288
    v_mul_u32_u24 v255, 0x380, v255
    v_lshl_add_u32 v255, v243, 5, v255
    s_lshl_b32 s65, s85, 7
    s_and_b32 s66, s60, 1
    s_lshl_b32 s66, s66, 6
    s_add_u32 s65, s65, s66
    v_add_u32 v228, s65, v255
    s_mov_b32 s84, 0
    v_mul_f32 v48, v48, v125
    v_mul_f32 v49, v49, v125
    v_mul_f32 v50, v50, v125
    v_mul_f32 v51, v51, v125
    v_mul_f32 v52, v52, v125
    v_mul_f32 v53, v53, v125
    v_mfma_f32_32x32x16_bf16 v[144:159], a[224:227], a[180:183], v[144:159]
    v_mul_f32 v54, v54, v125
    v_mul_f32 v55, v55, v125
    v_mul_f32 v56, v56, v125
    v_mul_f32 v57, v57, v125
    v_mul_f32 v58, v58, v125
    v_mul_f32 v59, v59, v125
    v_mul_f32 v60, v60, v126
    v_mul_f32 v61, v61, v126
    v_mul_f32 v62, v62, v126
    v_mul_f32 v63, v63, v126
    v_cvt_pk_bf16_f32 v48, v48, v49
    v_cvt_pk_bf16_f32 v49, v50, v51
    v_cvt_pk_bf16_f32 v50, v52, v53
    v_cvt_pk_bf16_f32 v51, v54, v55
    v_cvt_pk_bf16_f32 v52, v56, v57
    v_cvt_pk_bf16_f32 v53, v58, v59
    s_waitcnt lgkmcnt(0)
    v_mfma_f32_32x32x16_bf16 v[128:143], a[228:231], a[184:187], v[128:143]
    ds_read_b64_tr_b16 a[224:225], v240 offset:16384
    ds_read_b64_tr_b16 a[226:227], v240 offset:16640
    v_cvt_pk_bf16_f32 v54, v60, v61
    v_cvt_pk_bf16_f32 v55, v62, v63
    buffer_store_dwordx4 v[48:51], v246, s[52:55], 0 offen offset:0 sc1
    buffer_store_dwordx4 v[52:55], v246, s[52:55], 0 offen offset:2048 sc1
    v_mfma_f32_32x32x16_bf16 v[144:159], a[228:231], a[188:191], v[144:159]
    s_waitcnt lgkmcnt(0)
    v_mfma_f32_32x32x16_bf16 v[128:143], a[224:227], a[192:195], v[128:143]
    ds_read_b64_tr_b16 a[228:229], v240 offset:17408
    ds_read_b64_tr_b16 a[230:231], v240 offset:17664
    s_waitcnt vmcnt(26)
    ds_read_b64_tr_b16 v[64:65], v234 offset:0
    ds_read_b64_tr_b16 v[66:67], v234 offset:1024
    ds_read_b64_tr_b16 v[68:69], v235 offset:0
    v_mfma_f32_32x32x16_bf16 v[144:159], a[224:227], a[196:199], v[144:159]
    ds_read_b64_tr_b16 v[70:71], v235 offset:1024
    s_waitcnt lgkmcnt(4)
    v_mfma_f32_32x32x16_bf16 v[128:143], a[228:231], a[200:203], v[128:143]
    ds_read_b64_tr_b16 a[224:225], v240 offset:18432
    ds_read_b64_tr_b16 a[226:227], v240 offset:18688
    s_waitcnt vmcnt(24)
    ds_read_b64_tr_b16 v[72:73], v232 offset:0
    ds_read_b64_tr_b16 v[74:75], v232 offset:1024
    ds_read_b64_tr_b16 v[76:77], v233 offset:0
    s_waitcnt lgkmcnt(5)
    s_add_u32 m0, s26, 0
    s_mov_b32 s75, 0x26800
    buffer_load_dwordx4 v223, s[56:59], s75 offen lds
    v_mfma_f32_32x32x16_bf16 v[144:159], a[228:231], a[204:207], v[144:159]
    ds_read_b64_tr_b16 v[78:79], v233 offset:1024
    s_add_u32 m0, s26, 0x400
    s_mov_b32 s75, 0x28400
    buffer_load_dwordx4 v223, s[56:59], s75 offen lds
    s_waitcnt lgkmcnt(4)
    v_mfma_f32_32x32x16_bf16 v[128:143], a[224:227], a[208:211], v[128:143]
    ds_read_b64_tr_b16 a[228:229], v240 offset:19456
    ds_read_b64_tr_b16 a[230:231], v240 offset:19712
    s_waitcnt vmcnt(24)
    ds_read_b64_tr_b16 v[80:81], v232 offset:2048
    ds_read_b64_tr_b16 v[82:83], v232 offset:3072
    ds_read_b64_tr_b16 v[84:85], v233 offset:2048
    s_waitcnt lgkmcnt(5)
    s_add_u32 m0, s70, 0
    s_mov_b32 s75, 0x2a000
    buffer_load_dwordx4 v223, s[56:59], s75 offen lds
    v_mfma_f32_32x32x16_bf16 v[144:159], a[224:227], a[212:215], v[144:159]
    ds_read_b64_tr_b16 v[86:87], v233 offset:3072
    s_add_u32 m0, s70, 0x400
    s_mov_b32 s75, 0x2bc00
    buffer_load_dwordx4 v223, s[56:59], s75 offen lds
    s_waitcnt lgkmcnt(4)
    v_mfma_f32_32x32x16_bf16 v[128:143], a[228:231], a[216:219], v[128:143]
    ds_read_b64_tr_b16 a[224:225], v241 offset:8192
    ds_read_b64_tr_b16 a[226:227], v241 offset:8448
    s_waitcnt vmcnt(24)
    ds_read_b64_tr_b16 v[88:89], v232 offset:4096
    ds_read_b64_tr_b16 v[90:91], v232 offset:5120
    ds_read_b64_tr_b16 v[92:93], v233 offset:4096
    s_waitcnt lgkmcnt(5)
    s_add_u32 m0, s70, 0x800
    s_mov_b32 s75, 0x2d800
    buffer_load_dwordx4 v223, s[56:59], s75 offen lds
    v_mfma_f32_32x32x16_bf16 v[144:159], a[228:231], a[220:223], v[144:159]
    ds_read_b64_tr_b16 v[94:95], v233 offset:5120
    s_add_u32 m0, s70, 0xc00
    s_mov_b32 s75, 0x2f400
    buffer_load_dwordx4 v223, s[56:59], s75 offen lds
    s_waitcnt lgkmcnt(4)
    v_mfma_f32_32x32x16_bf16 v[160:175], a[224:227], a[0:3], 0
    ds_read_b64_tr_b16 a[228:229], v241 offset:9216
    ds_read_b64_tr_b16 a[230:231], v241 offset:9472
    s_waitcnt vmcnt(24)
    ds_read_b64_tr_b16 v[96:97], v232 offset:6144
    ds_read_b64_tr_b16 v[98:99], v232 offset:7168
    ds_read_b64_tr_b16 v[100:101], v233 offset:6144
    s_waitcnt lgkmcnt(5)
    s_add_u32 m0, s70, 0x1000
    s_mov_b32 s75, 0x31000
    buffer_load_dwordx4 v223, s[56:59], s75 offen lds
    v_mfma_f32_32x32x16_bf16 v[176:191], a[224:227], a[4:7], 0
    ds_read_b64_tr_b16 v[102:103], v233 offset:7168
    s_add_u32 m0, s70, 0x1400
    s_mov_b32 s75, 0x32c00
    buffer_load_dwordx4 v223, s[56:59], s75 offen lds
    v_mul_f32 v128, 0xbfb8aa3b, v128
    s_waitcnt lgkmcnt(4)
    v_mfma_f32_32x32x16_bf16 v[160:175], a[228:231], a[8:11], v[160:175]
    ds_read_b64_tr_b16 a[224:225], v241 offset:10240
    ds_read_b64_tr_b16 a[226:227], v241 offset:10496
    s_waitcnt vmcnt(21)
    ds_read_b64_tr_b16 v[104:105], v236 offset:0
    ds_read_b64_tr_b16 v[106:107], v236 offset:1024
    ds_read_b64_tr_b16 v[108:109], v237 offset:0
    s_waitcnt lgkmcnt(5)
    s_add_u32 m0, s70, 0x1800
    s_mov_b32 s75, 0x34800
    buffer_load_dwordx4 v223, s[56:59], s75 offen lds
    v_mfma_f32_32x32x16_bf16 v[176:191], a[228:231], a[12:15], v[176:191]
    ds_read_b64_tr_b16 v[110:111], v237 offset:1024
    s_add_u32 m0, s70, 0x1c00
    s_mov_b32 s75, 0x36400
    buffer_load_dwordx4 v223, s[56:59], s75 offen lds
    v_mul_f32 v129, 0xbfb8aa3b, v129
    s_waitcnt lgkmcnt(4)
    v_mfma_f32_32x32x16_bf16 v[160:175], a[224:227], a[16:19], v[160:175]
    ds_read_b64_tr_b16 a[228:229], v241 offset:11264
    ds_read_b64_tr_b16 a[230:231], v241 offset:11520
    s_waitcnt vmcnt(21)
    ds_read_b64_tr_b16 v[112:113], v236 offset:2048
    ds_read_b64_tr_b16 v[114:115], v236 offset:3072
    ds_read_b64_tr_b16 v[116:117], v237 offset:2048
    s_waitcnt lgkmcnt(5)
    s_add_u32 m0, s3, 0
    s_nop 0
    buffer_load_dwordx4 v245, s[40:43], 0 offen lds
    v_mfma_f32_32x32x16_bf16 v[176:191], a[224:227], a[20:23], v[176:191]
    ds_read_b64_tr_b16 v[118:119], v237 offset:3072
    s_add_u32 m0, s3, 0x400
    s_mov_b32 s75, 0x1c00
    buffer_load_dwordx4 v245, s[40:43], s75 offen lds
    v_mul_f32 v130, 0xbfb8aa3b, v130
    s_waitcnt lgkmcnt(4)
    v_mfma_f32_32x32x16_bf16 v[160:175], a[228:231], a[24:27], v[160:175]
    ds_read_b64_tr_b16 a[224:225], v241 offset:32768
    ds_read_b64_tr_b16 a[226:227], v241 offset:33024
    s_waitcnt vmcnt(21)
    ds_read_b64_tr_b16 v[120:121], v236 offset:4096
    ds_read_b64_tr_b16 v[122:123], v236 offset:5120
    ds_read_b64_tr_b16 v[124:125], v237 offset:4096
    s_waitcnt lgkmcnt(5)
    s_add_u32 m0, s3, 0x800
    s_mov_b32 s75, 0x3800
    buffer_load_dwordx4 v245, s[40:43], s75 offen lds
    v_mfma_f32_32x32x16_bf16 v[176:191], a[228:231], a[28:31], v[176:191]
    ds_read_b64_tr_b16 v[126:127], v237 offset:5120
    s_add_u32 m0, s3, 0xc00
    s_mov_b32 s75, 0x5400
    buffer_load_dwordx4 v245, s[40:43], s75 offen lds
    v_mul_f32 v131, 0xbfb8aa3b, v131
    s_waitcnt lgkmcnt(4)
    v_mfma_f32_32x32x16_bf16 v[160:175], a[224:227], a[32:35], v[160:175]
    ds_read_b64_tr_b16 a[228:229], v241 offset:33792
    ds_read_b64_tr_b16 a[230:231], v241 offset:34048
    s_waitcnt vmcnt(21)
    ds_read_b64_tr_b16 a[0:1], v236 offset:6144
    ds_read_b64_tr_b16 a[2:3], v236 offset:7168
    ds_read_b64_tr_b16 a[4:5], v237 offset:6144
    s_waitcnt lgkmcnt(5)
    s_add_u32 m0, s3, 0x1000
    s_mov_b32 s75, 0x6200
    buffer_load_dwordx4 v245, s[40:43], s75 offen lds
    v_mfma_f32_32x32x16_bf16 v[176:191], a[224:227], a[36:39], v[176:191]
    ds_read_b64_tr_b16 a[6:7], v237 offset:7168
    s_add_u32 m0, s3, 0x1400
    s_mov_b32 s75, 0x7e00
    buffer_load_dwordx4 v245, s[40:43], s75 offen lds
    v_mul_f32 v132, 0xbfb8aa3b, v132
    s_waitcnt lgkmcnt(4)
    v_mfma_f32_32x32x16_bf16 v[160:175], a[228:231], a[40:43], v[160:175]
    ds_read_b64_tr_b16 a[224:225], v241 offset:34816
    ds_read_b64_tr_b16 a[226:227], v241 offset:35072
    s_waitcnt vmcnt(21)
    ds_read_b64_tr_b16 a[8:9], v236 offset:8192
    ds_read_b64_tr_b16 a[10:11], v236 offset:9216
    ds_read_b64_tr_b16 a[12:13], v237 offset:8192
    s_waitcnt lgkmcnt(5)
    s_add_u32 m0, s3, 0x1800
    s_mov_b32 s75, 0x9a00
    buffer_load_dwordx4 v245, s[40:43], s75 offen lds
    v_mfma_f32_32x32x16_bf16 v[176:191], a[228:231], a[44:47], v[176:191]
    ds_read_b64_tr_b16 a[14:15], v237 offset:9216
    s_add_u32 m0, s3, 0x1c00
    s_mov_b32 s75, 0xb600
    buffer_load_dwordx4 v245, s[40:43], s75 offen lds
    v_mul_f32 v133, 0xbfb8aa3b, v133
    s_waitcnt lgkmcnt(4)
    v_mfma_f32_32x32x16_bf16 v[160:175], a[224:227], a[48:51], v[160:175]
    ds_read_b64_tr_b16 a[228:229], v241 offset:35840
    ds_read_b64_tr_b16 a[230:231], v241 offset:36096
    s_waitcnt vmcnt(21)
    ds_read_b64_tr_b16 a[16:17], v236 offset:10240
    ds_read_b64_tr_b16 a[18:19], v236 offset:11264
    ds_read_b64_tr_b16 a[20:21], v237 offset:10240
    s_waitcnt lgkmcnt(5)
    s_add_u32 m0, s3, 0x2000
    s_mov_b32 s75, 0xc400
    buffer_load_dwordx4 v245, s[40:43], s75 offen lds
    v_mfma_f32_32x32x16_bf16 v[176:191], a[224:227], a[52:55], v[176:191]
    ds_read_b64_tr_b16 a[22:23], v237 offset:11264
    s_add_u32 m0, s3, 0x2400
    s_mov_b32 s75, 0xe000
    buffer_load_dwordx4 v245, s[40:43], s75 offen lds
    v_mul_f32 v134, 0xbfb8aa3b, v134
    s_waitcnt lgkmcnt(4)
    v_mfma_f32_32x32x16_bf16 v[160:175], a[228:231], a[56:59], v[160:175]
    ds_read_b64_tr_b16 a[224:225], v242 offset:8192
    ds_read_b64_tr_b16 a[226:227], v242 offset:8448
    s_waitcnt vmcnt(18)
    ds_read_b64_tr_b16 a[24:25], v234 offset:0
    ds_read_b64_tr_b16 a[26:27], v234 offset:1024
    ds_read_b64_tr_b16 a[28:29], v235 offset:0
    s_waitcnt lgkmcnt(5)
    s_add_u32 m0, s3, 0x2800
    s_mov_b32 s75, 0xfc00
    buffer_load_dwordx4 v245, s[40:43], s75 offen lds
    v_mfma_f32_32x32x16_bf16 v[176:191], a[228:231], a[60:63], v[176:191]
    ds_read_b64_tr_b16 a[30:31], v235 offset:1024
    s_add_u32 m0, s3, 0x2c00
    s_mov_b32 s75, 0x11800
    buffer_load_dwordx4 v245, s[40:43], s75 offen lds
    v_mul_f32 v135, 0xbfb8aa3b, v135
    s_waitcnt lgkmcnt(4)
    v_mfma_f32_32x32x16_bf16 v[160:175], a[224:227], a[64:67], v[160:175]
    ds_read_b64_tr_b16 a[228:229], v242 offset:9216
    ds_read_b64_tr_b16 a[230:231], v242 offset:9472
    s_waitcnt vmcnt(18)
    ds_read_b64_tr_b16 a[32:33], v232 offset:0
    ds_read_b64_tr_b16 a[34:35], v232 offset:1024
    ds_read_b64_tr_b16 a[36:37], v233 offset:0
    s_waitcnt lgkmcnt(5)
    s_add_u32 m0, s26, 0
    s_mov_b32 s75, 0x12600
    buffer_load_dwordx4 v245, s[40:43], s75 offen lds
    v_mfma_f32_32x32x16_bf16 v[176:191], a[224:227], a[68:71], v[176:191]
    ds_read_b64_tr_b16 a[38:39], v233 offset:1024
    s_add_u32 m0, s26, 0x400
    s_mov_b32 s75, 0x14200
    buffer_load_dwordx4 v245, s[40:43], s75 offen lds
    s_waitcnt lgkmcnt(4)
    v_mfma_f32_32x32x16_bf16 v[160:175], a[228:231], a[72:75], v[160:175]
    ds_read_b64_tr_b16 a[224:225], v242 offset:10240
    ds_read_b64_tr_b16 a[226:227], v242 offset:10496
    s_waitcnt vmcnt(18)
    ds_read_b64_tr_b16 a[40:41], v232 offset:2048
    ds_read_b64_tr_b16 a[42:43], v232 offset:3072
    ds_read_b64_tr_b16 a[44:45], v233 offset:2048
    s_waitcnt lgkmcnt(5)
    s_add_u32 m0, s70, 0
    s_mov_b32 s75, 0x15e00
    buffer_load_dwordx4 v245, s[40:43], s75 offen lds
    v_mfma_f32_32x32x16_bf16 v[176:191], a[228:231], a[76:79], v[176:191]
    ds_read_b64_tr_b16 a[46:47], v233 offset:3072
    s_add_u32 m0, s70, 0x400
    s_mov_b32 s75, 0x17a00
    buffer_load_dwordx4 v245, s[40:43], s75 offen lds
    s_waitcnt lgkmcnt(4)
    v_mfma_f32_32x32x16_bf16 v[160:175], a[224:227], a[80:83], v[160:175]
    ds_read_b64_tr_b16 a[228:229], v242 offset:11264
    ds_read_b64_tr_b16 a[230:231], v242 offset:11520
    s_waitcnt vmcnt(18)
    ds_read_b64_tr_b16 a[48:49], v232 offset:4096
    ds_read_b64_tr_b16 a[50:51], v232 offset:5120
    ds_read_b64_tr_b16 a[52:53], v233 offset:4096
    s_waitcnt lgkmcnt(5)
    s_add_u32 m0, s70, 0x800
    s_mov_b32 s75, 0x38000
    buffer_load_dwordx4 v223, s[56:59], s75 offen lds
    v_mfma_f32_32x32x16_bf16 v[176:191], a[224:227], a[84:87], v[176:191]
    ds_read_b64_tr_b16 a[54:55], v233 offset:5120
    s_add_u32 m0, s70, 0xc00
    s_mov_b32 s75, 0x39c00
    buffer_load_dwordx4 v223, s[56:59], s75 offen lds
    s_waitcnt lgkmcnt(4)
    v_mfma_f32_32x32x16_bf16 v[160:175], a[228:231], a[88:91], v[160:175]
    ds_read_b64_tr_b16 a[224:225], v242 offset:32768
    ds_read_b64_tr_b16 a[226:227], v242 offset:33024
    s_waitcnt vmcnt(18)
    ds_read_b64_tr_b16 a[56:57], v232 offset:6144
    ds_read_b64_tr_b16 a[58:59], v232 offset:7168
    ds_read_b64_tr_b16 a[60:61], v233 offset:6144
    s_nop 0
    s_mov_b64 exec, 1
    buffer_store_dwordx2 v[220:221], v244, s[52:55], 0 offen offset:0 sc1
    s_mov_b64 exec, -1
    v_mfma_f32_32x32x16_bf16 v[176:191], a[228:231], a[92:95], v[176:191]
    ds_read_b64_tr_b16 a[62:63], v233 offset:7168
    s_waitcnt lgkmcnt(6)
    s_add_u32 m0, s70, 0x1000
    s_mov_b32 s75, 0x3b800
    buffer_load_dwordx4 v223, s[56:59], s75 offen lds
    s_add_u32 m0, s70, 0x1400
    s_mov_b32 s75, 0x3d400
    buffer_load_dwordx4 v223, s[56:59], s75 offen lds
    s_waitcnt lgkmcnt(4)
    v_mfma_f32_32x32x16_bf16 v[160:175], a[224:227], a[96:99], v[160:175]
    ds_read_b64_tr_b16 a[228:229], v242 offset:33792
    ds_read_b64_tr_b16 a[230:231], v242 offset:34048
    s_waitcnt vmcnt(19)
    ds_read_b64_tr_b16 a[64:65], v236 offset:0
    ds_read_b64_tr_b16 a[66:67], v236 offset:1024
    ds_read_b64_tr_b16 a[68:69], v237 offset:0
    s_waitcnt lgkmcnt(5)
    s_add_u32 m0, s70, 0x1800
    s_mov_b32 s75, 0x3f000
    buffer_load_dwordx4 v223, s[56:59], s75 offen lds
    v_mfma_f32_32x32x16_bf16 v[176:191], a[224:227], a[100:103], v[176:191]
    ds_read_b64_tr_b16 a[70:71], v237 offset:1024
    s_add_u32 m0, s70, 0x1c00
    s_mov_b32 s75, 0x40c00
    buffer_load_dwordx4 v223, s[56:59], s75 offen lds
    s_waitcnt lgkmcnt(4)
    v_mfma_f32_32x32x16_bf16 v[160:175], a[228:231], a[104:107], v[160:175]
    ds_read_b64_tr_b16 a[224:225], v242 offset:34816
    ds_read_b64_tr_b16 a[226:227], v242 offset:35072
    s_waitcnt lgkmcnt(2)
    s_add_u32 m0, s3, 0
    s_mov_b32 s75, 0x42800
    buffer_load_dwordx4 v223, s[56:59], s75 offen lds
    v_mfma_f32_32x32x16_bf16 v[176:191], a[228:231], a[108:111], v[176:191]
    s_add_u32 m0, s3, 0x400
    s_mov_b32 s75, 0x44400
    buffer_load_dwordx4 v223, s[56:59], s75 offen lds
    v_exp_f32 v128, v128
    s_waitcnt lgkmcnt(0)
    v_mfma_f32_32x32x16_bf16 v[160:175], a[224:227], a[112:115], v[160:175]
    ds_read_b64_tr_b16 a[228:229], v242 offset:35840
    ds_read_b64_tr_b16 a[230:231], v242 offset:36096
    v_exp_f32 v129, v129
    v_mfma_f32_32x32x16_bf16 v[176:191], a[224:227], a[116:119], v[176:191]
    v_exp_f32 v130, v130
    v_exp_f32 v131, v131
    s_waitcnt lgkmcnt(0)
    v_mfma_f32_32x32x16_bf16 v[160:175], a[228:231], a[120:123], v[160:175]
    s_waitcnt lgkmcnt(0)
    s_barrier
    ds_read_b64_tr_b16 a[224:225], v241 offset:16384
    ds_read_b64_tr_b16 a[226:227], v241 offset:16640
    v_exp_f32 v132, v132
    v_mfma_f32_32x32x16_bf16 v[176:191], a[228:231], a[124:127], v[176:191]
    v_exp_f32 v133, v133
    v_exp_f32 v134, v134
    s_waitcnt lgkmcnt(0)
    v_mfma_f32_32x32x16_bf16 v[160:175], a[224:227], a[128:131], v[160:175]
    ds_read_b64_tr_b16 a[228:229], v241 offset:17408
    ds_read_b64_tr_b16 a[230:231], v241 offset:17664
    s_add_u32 m0, s70, 0x2000
    s_mov_b32 s75, 0x46000
    buffer_load_dwordx4 v223, s[56:59], s75 offen lds
    v_mfma_f32_32x32x16_bf16 v[176:191], a[224:227], a[132:135], v[176:191]
    s_add_u32 m0, s70, 0x2400
    s_mov_b32 s75, 0x47c00
    buffer_load_dwordx4 v223, s[56:59], s75 offen lds
    v_exp_f32 v135, v135
    s_waitcnt lgkmcnt(0)
    v_mfma_f32_32x32x16_bf16 v[160:175], a[228:231], a[136:139], v[160:175]
    ds_read_b64_tr_b16 a[224:225], v241 offset:18432
    ds_read_b64_tr_b16 a[226:227], v241 offset:18688
    s_add_u32 m0, s70, 0x2800
    s_mov_b32 s75, 0x49800
    buffer_load_dwordx4 v223, s[56:59], s75 offen lds
    v_mfma_f32_32x32x16_bf16 v[176:191], a[228:231], a[140:143], v[176:191]
    s_add_u32 m0, s70, 0x2c00
    s_mov_b32 s75, 0x4b400
    buffer_load_dwordx4 v223, s[56:59], s75 offen lds
    v_add_f32 v128, 1.0, v128
    v_add_f32 v129, 1.0, v129
    s_waitcnt lgkmcnt(0)
    v_mfma_f32_32x32x16_bf16 v[160:175], a[224:227], a[144:147], v[160:175]
    ds_read_b64_tr_b16 a[228:229], v241 offset:19456
    ds_read_b64_tr_b16 a[230:231], v241 offset:19712
    s_add_u32 m0, s70, 0x3000
    s_mov_b32 s75, 0x4d000
    buffer_load_dwordx4 v223, s[56:59], s75 offen lds
    v_mfma_f32_32x32x16_bf16 v[176:191], a[224:227], a[148:151], v[176:191]
    s_add_u32 m0, s70, 0x3400
    s_mov_b32 s75, 0x4ec00
    buffer_load_dwordx4 v223, s[56:59], s75 offen lds
    v_add_f32 v130, 1.0, v130
    v_add_f32 v131, 1.0, v131
    s_waitcnt lgkmcnt(0)
    v_mfma_f32_32x32x16_bf16 v[160:175], a[228:231], a[152:155], v[160:175]
    ds_read_b64_tr_b16 a[224:225], v241 offset:40960
    ds_read_b64_tr_b16 a[226:227], v241 offset:41216
    s_add_u32 m0, s70, 0x3800
    s_mov_b32 s75, 0x50800
    buffer_load_dwordx4 v223, s[56:59], s75 offen lds
    v_mfma_f32_32x32x16_bf16 v[176:191], a[228:231], a[156:159], v[176:191]
    s_add_u32 m0, s70, 0x3c00
    s_mov_b32 s75, 0x52400
    buffer_load_dwordx4 v223, s[56:59], s75 offen lds
    v_add_f32 v132, 1.0, v132
    v_add_f32 v133, 1.0, v133
    s_waitcnt lgkmcnt(0)
    v_mfma_f32_32x32x16_bf16 v[160:175], a[224:227], a[160:163], v[160:175]
    ds_read_b64_tr_b16 a[228:229], v241 offset:41984
    ds_read_b64_tr_b16 a[230:231], v241 offset:42240
    v_add_f32 v134, 1.0, v134
    v_add_f32 v135, 1.0, v135
    v_mfma_f32_32x32x16_bf16 v[176:191], a[224:227], a[164:167], v[176:191]
    v_rcp_f32 v128, v128
    v_rcp_f32 v129, v129
    s_waitcnt lgkmcnt(0)
    v_mfma_f32_32x32x16_bf16 v[160:175], a[228:231], a[168:171], v[160:175]
    ds_read_b64_tr_b16 a[224:225], v241 offset:43008
    ds_read_b64_tr_b16 a[226:227], v241 offset:43264
    v_rcp_f32 v130, v130
    v_mfma_f32_32x32x16_bf16 v[176:191], a[228:231], a[172:175], v[176:191]
    v_rcp_f32 v131, v131
    v_rcp_f32 v132, v132
    s_waitcnt lgkmcnt(0)
    v_mfma_f32_32x32x16_bf16 v[160:175], a[224:227], a[176:179], v[160:175]
    ds_read_b64_tr_b16 a[228:229], v241 offset:44032
    ds_read_b64_tr_b16 a[230:231], v241 offset:44288
    v_rcp_f32 v133, v133
    v_mfma_f32_32x32x16_bf16 v[176:191], a[224:227], a[180:183], v[176:191]
    v_rcp_f32 v134, v134
    v_rcp_f32 v135, v135
    v_mul_f32 v128, v128, v136
    s_waitcnt lgkmcnt(0)
    v_mfma_f32_32x32x16_bf16 v[160:175], a[228:231], a[184:187], v[160:175]
    ds_read_b64_tr_b16 a[224:225], v242 offset:16384
    ds_read_b64_tr_b16 a[226:227], v242 offset:16640
    v_mul_f32 v129, v129, v137
    v_mul_f32 v130, v130, v138
    v_mul_f32 v131, v131, v139
    v_mfma_f32_32x32x16_bf16 v[176:191], a[228:231], a[188:191], v[176:191]
    v_mul_f32 v132, v132, v140
    v_mul_f32 v133, v133, v141
    v_mul_f32 v134, v134, v142
    v_mul_f32 v135, v135, v143
    v_cvt_pk_bf16_f32 v136, v128, v129
    s_waitcnt lgkmcnt(0)
    v_mfma_f32_32x32x16_bf16 v[160:175], a[224:227], a[192:195], v[160:175]
    ds_read_b64_tr_b16 a[228:229], v242 offset:17408
    ds_read_b64_tr_b16 a[230:231], v242 offset:17664
    v_cvt_pk_bf16_f32 v137, v130, v131
    v_cvt_pk_bf16_f32 v138, v132, v133
    v_cvt_pk_bf16_f32 v139, v134, v135
    v_mfma_f32_32x32x16_bf16 v[176:191], a[224:227], a[196:199], v[176:191]
    buffer_store_dwordx4 v[136:139], v246, s[52:55], s27 offen offset:0 sc1
    v_mul_f32 v144, 0xbfb8aa3b, v144
    v_mul_f32 v145, 0xbfb8aa3b, v145
    v_mul_f32 v146, 0xbfb8aa3b, v146
    v_mul_f32 v147, 0xbfb8aa3b, v147
    s_waitcnt lgkmcnt(0)
    v_mfma_f32_32x32x16_bf16 v[160:175], a[228:231], a[200:203], v[160:175]
    ds_read_b64_tr_b16 a[224:225], v242 offset:18432
    ds_read_b64_tr_b16 a[226:227], v242 offset:18688
    v_mul_f32 v148, 0xbfb8aa3b, v148
    v_mul_f32 v149, 0xbfb8aa3b, v149
    v_mul_f32 v150, 0xbfb8aa3b, v150
    v_mfma_f32_32x32x16_bf16 v[176:191], a[228:231], a[204:207], v[176:191]
    v_mul_f32 v151, 0xbfb8aa3b, v151
    v_exp_f32 v144, v144
    v_exp_f32 v145, v145
    s_waitcnt lgkmcnt(0)
    v_mfma_f32_32x32x16_bf16 v[160:175], a[224:227], a[208:211], v[160:175]
    ds_read_b64_tr_b16 a[228:229], v242 offset:19456
    ds_read_b64_tr_b16 a[230:231], v242 offset:19712
    v_exp_f32 v146, v146
    v_mfma_f32_32x32x16_bf16 v[176:191], a[224:227], a[212:215], v[176:191]
    v_exp_f32 v147, v147
    v_exp_f32 v148, v148
    s_waitcnt lgkmcnt(0)
    v_mfma_f32_32x32x16_bf16 v[160:175], a[228:231], a[216:219], v[160:175]
    v_exp_f32 v149, v149
    v_exp_f32 v150, v150
    v_mfma_f32_32x32x16_bf16 v[176:191], a[228:231], a[220:223], v[176:191]
    v_exp_f32 v151, v151
    v_add_f32 v144, 1.0, v144
    v_add_f32 v145, 1.0, v145
    v_add_f32 v146, 1.0, v146
    v_add_f32 v147, 1.0, v147
    v_add_f32 v148, 1.0, v148
    v_add_f32 v149, 1.0, v149
    v_add_f32 v150, 1.0, v150
    v_add_f32 v151, 1.0, v151
    v_rcp_f32 v144, v144
    v_rcp_f32 v145, v145
    v_rcp_f32 v146, v146
    v_rcp_f32 v147, v147
    v_rcp_f32 v148, v148
    v_rcp_f32 v149, v149
    v_rcp_f32 v150, v150
    v_rcp_f32 v151, v151
    v_mul_f32 v144, v144, v152
    v_mul_f32 v145, v145, v153
    v_mul_f32 v146, v146, v154
    v_mul_f32 v147, v147, v155
    v_mul_f32 v148, v148, v156
    v_mul_f32 v149, v149, v157
    v_mul_f32 v150, v150, v158
    v_mul_f32 v151, v151, v159
    v_cvt_pk_bf16_f32 v152, v144, v145
    v_cvt_pk_bf16_f32 v153, v146, v147
    v_cvt_pk_bf16_f32 v154, v148, v149
    v_cvt_pk_bf16_f32 v155, v150, v151
    buffer_store_dwordx4 v[152:155], v246, s[52:55], s27 offen offset:1024 sc1
    v_mul_f32 v160, 0xbfb8aa3b, v160
    v_mul_f32 v176, 0xbfb8aa3b, v176
    v_mul_f32 v161, 0xbfb8aa3b, v161
    v_mul_f32 v177, 0xbfb8aa3b, v177
    v_mul_f32 v162, 0xbfb8aa3b, v162
    v_mul_f32 v178, 0xbfb8aa3b, v178
    v_mul_f32 v163, 0xbfb8aa3b, v163
    v_mul_f32 v179, 0xbfb8aa3b, v179
    v_mul_f32 v164, 0xbfb8aa3b, v164
    v_mul_f32 v180, 0xbfb8aa3b, v180
    v_mul_f32 v165, 0xbfb8aa3b, v165
    v_mul_f32 v181, 0xbfb8aa3b, v181
    v_mul_f32 v166, 0xbfb8aa3b, v166
    v_mul_f32 v182, 0xbfb8aa3b, v182
    v_mul_f32 v167, 0xbfb8aa3b, v167
    v_mul_f32 v183, 0xbfb8aa3b, v183
    buffer_load_dwordx2 v[218:219], v216, s[52:55], 0 offen offset:0 sc1
    v_exp_f32 v160, v160
    v_exp_f32 v176, v176
    v_exp_f32 v161, v161
    v_exp_f32 v177, v177
    v_exp_f32 v162, v162
    v_exp_f32 v178, v178
    v_exp_f32 v163, v163
    v_exp_f32 v179, v179
    v_exp_f32 v164, v164
    v_exp_f32 v180, v180
    v_exp_f32 v165, v165
    v_exp_f32 v181, v181
    v_exp_f32 v166, v166
    v_exp_f32 v182, v182
    v_exp_f32 v167, v167
    v_exp_f32 v183, v183
    v_add_f32 v160, 1.0, v160
    v_add_f32 v176, 1.0, v176
    v_add_f32 v161, 1.0, v161
    v_add_f32 v177, 1.0, v177
    v_add_f32 v162, 1.0, v162
    v_add_f32 v178, 1.0, v178
    v_add_f32 v163, 1.0, v163
    v_add_f32 v179, 1.0, v179
    v_add_f32 v164, 1.0, v164
    v_add_f32 v180, 1.0, v180
    v_add_f32 v165, 1.0, v165
    v_add_f32 v181, 1.0, v181
    v_add_f32 v166, 1.0, v166
    v_add_f32 v182, 1.0, v182
    v_add_f32 v167, 1.0, v167
    v_add_f32 v183, 1.0, v183
    v_rcp_f32 v160, v160
    v_rcp_f32 v176, v176
    v_rcp_f32 v161, v161
    v_rcp_f32 v177, v177
    v_rcp_f32 v162, v162
    v_rcp_f32 v178, v178
    v_rcp_f32 v163, v163
    v_rcp_f32 v179, v179
    v_rcp_f32 v164, v164
    v_rcp_f32 v180, v180
    v_rcp_f32 v165, v165
    v_rcp_f32 v181, v181
    v_rcp_f32 v166, v166
    v_rcp_f32 v182, v182
    v_rcp_f32 v167, v167
    v_rcp_f32 v183, v183
    v_mul_f32 v160, v160, v168
    v_mul_f32 v176, v176, v184
    v_mul_f32 v161, v161, v169
    v_mul_f32 v177, v177, v185
    v_mul_f32 v162, v162, v170
    v_mul_f32 v178, v178, v186
    v_mul_f32 v163, v163, v171
    v_mul_f32 v179, v179, v187
    v_mul_f32 v164, v164, v172
    v_mul_f32 v180, v180, v188
    v_mul_f32 v165, v165, v173
    v_mul_f32 v181, v181, v189
    v_mul_f32 v166, v166, v174
    v_mul_f32 v182, v182, v190
    v_mul_f32 v167, v167, v175
    v_mul_f32 v183, v183, v191
    v_cvt_pk_bf16_f32 v168, v160, v161
    v_cvt_pk_bf16_f32 v184, v176, v177
    v_cvt_pk_bf16_f32 v169, v162, v163
    v_cvt_pk_bf16_f32 v185, v178, v179
    v_cvt_pk_bf16_f32 v170, v164, v165
    v_cvt_pk_bf16_f32 v186, v180, v181
    v_cvt_pk_bf16_f32 v171, v166, v167
    v_cvt_pk_bf16_f32 v187, v182, v183
    buffer_store_dwordx4 v[168:171], v246, s[52:55], s27 offen offset:2048 sc1
    buffer_store_dwordx4 v[184:187], v246, s[52:55], s27 offen offset:3072 sc1
    s_waitcnt vmcnt(2)
    v_cmp_eq_u64 vcc, v[220:221], v[218:219]
    s_nop 0
    s_and_b32 s69, vcc_lo, 0xf
    s_cmp_eq_u32 s69, 15
    s_cbranch_scc1 L_fl_ok_h2_0
L_fl_loop_h2_0:
    s_sleep 2
    buffer_load_dwordx2 v[218:219], v216, s[52:55], 0 offen sc1
    s_waitcnt vmcnt(0)
    v_cmp_eq_u64 vcc, v[220:221], v[218:219]
    s_add_u32 s84, s84, 1
    s_cmp_gt_u32 s84, 20000
    s_cbranch_scc1 L_fl_ok_h2_0
    s_and_b32 s69, vcc_lo, 0xf
    s_cmp_eq_u32 s69, 0xf
    s_cbranch_scc0 L_fl_loop_h2_0
L_fl_ok_h2_0:
    buffer_load_dwordx4 a[72:75], v225, s[52:55], 0 offen offset:0 sc1
    buffer_load_dwordx4 a[76:79], v225, s[52:55], 0 offen offset:1024 sc1
    buffer_load_dwordx4 a[80:83], v225, s[52:55], 0 offen offset:2048 sc1
    buffer_load_dwordx4 a[84:87], v225, s[52:55], 0 offen offset:3072 sc1
    s_mov_b32 s76, 0x1000
    buffer_load_dwordx4 a[88:91], v225, s[52:55], s76 offen offset:0 sc1
    buffer_load_dwordx4 a[92:95], v225, s[52:55], s76 offen offset:1024 sc1
    s_mov_b32 s76, 0x1000
    buffer_load_dwordx4 a[96:99], v225, s[52:55], s76 offen offset:2048 sc1
    buffer_load_dwordx4 a[100:103], v225, s[52:55], s76 offen offset:3072 sc1
    s_barrier
    s_add_u32 m0, s70, 0x4000
    s_mov_b32 s75, 0x54000
    buffer_load_dwordx4 v223, s[56:59], s75 offen lds
    s_add_u32 m0, s70, 0x4400
    s_mov_b32 s75, 0x55c00
    buffer_load_dwordx4 v223, s[56:59], s75 offen lds
    s_add_u32 m0, s70, 0x4800
    s_mov_b32 s75, 0x57800
    buffer_load_dwordx4 v223, s[56:59], s75 offen lds
    s_add_u32 m0, s70, 0x4c00
    s_mov_b32 s75, 0x59400
    buffer_load_dwordx4 v223, s[56:59], s75 offen lds
    s_add_u32 m0, s70, 0x5000
    s_mov_b32 s75, 0x5b000
    buffer_load_dwordx4 v223, s[56:59], s75 offen lds
    s_add_u32 m0, s70, 0x5400
    s_mov_b32 s75, 0x5cc00
    buffer_load_dwordx4 v223, s[56:59], s75 offen lds
    s_add_u32 m0, s70, 0x5800
    s_mov_b32 s75, 0x5e800
    buffer_load_dwordx4 v223, s[56:59], s75 offen lds
    s_add_u32 m0, s70, 0x5c00
    s_mov_b32 s75, 0x60400
    buffer_load_dwordx4 v223, s[56:59], s75 offen lds
    s_mov_b32 s76, 0x2000
    buffer_load_dwordx4 a[104:107], v225, s[52:55], s76 offen offset:0 sc1
    buffer_load_dwordx4 a[108:111], v225, s[52:55], s76 offen offset:1024 sc1
    s_mov_b32 s76, 0x2000
    buffer_load_dwordx4 a[112:115], v225, s[52:55], s76 offen offset:2048 sc1
    buffer_load_dwordx4 a[116:119], v225, s[52:55], s76 offen offset:3072 sc1
    s_mov_b32 s76, 0x3000
    buffer_load_dwordx4 a[120:123], v225, s[52:55], s76 offen offset:0 sc1
    buffer_load_dwordx4 a[124:127], v225, s[52:55], s76 offen offset:1024 sc1
    s_waitcnt vmcnt(22)
    s_nop 0
    s_mov_b64 exec, 2
    buffer_store_dwordx2 v[220:221], v244, s[52:55], 0 offen offset:0 sc1
    s_mov_b64 exec, -1
    s_mov_b32 s76, 0x3000
    buffer_load_dwordx4 a[128:131], v225, s[52:55], s76 offen offset:2048 sc1
    buffer_load_dwordx4 a[132:135], v225, s[52:55], s76 offen offset:3072 sc1
    s_waitcnt vmcnt(24)
    v_mfma_f32_32x32x16_bf16 v[0:15], v[64:67], a[72:75], 0
    v_mfma_f32_32x32x16_bf16 v[16:31], v[68:71], a[72:75], 0
    s_mov_b32 s76, 0x4000
    buffer_load_dwordx4 a[136:139], v225, s[52:55], s76 offen offset:0 sc1
    buffer_load_dwordx4 a[140:143], v225, s[52:55], s76 offen offset:1024 sc1
    s_waitcnt vmcnt(25)
    v_mfma_f32_32x32x16_bf16 v[32:47], v[64:67], a[76:79], 0
    v_mfma_f32_32x32x16_bf16 v[48:63], v[68:71], a[76:79], 0
    s_waitcnt vmcnt(24)
    v_mfma_f32_32x32x16_bf16 v[0:15], v[72:75], a[80:83], v[0:15]
    v_mfma_f32_32x32x16_bf16 v[16:31], v[76:79], a[80:83], v[16:31]
    s_mov_b32 s76, 0x4000
    buffer_load_dwordx4 a[144:147], v225, s[52:55], s76 offen offset:2048 sc1
    buffer_load_dwordx4 a[148:151], v225, s[52:55], s76 offen offset:3072 sc1
    s_waitcnt vmcnt(25)
    v_mfma_f32_32x32x16_bf16 v[32:47], v[72:75], a[84:87], v[32:47]
    v_mfma_f32_32x32x16_bf16 v[48:63], v[76:79], a[84:87], v[48:63]
    s_waitcnt vmcnt(24)
    v_mfma_f32_32x32x16_bf16 v[0:15], v[80:83], a[88:91], v[0:15]
    v_mfma_f32_32x32x16_bf16 v[16:31], v[84:87], a[88:91], v[16:31]
    s_mov_b32 s76, 0x5000
    buffer_load_dwordx4 a[152:155], v225, s[52:55], s76 offen offset:0 sc1
    buffer_load_dwordx4 a[156:159], v225, s[52:55], s76 offen offset:1024 sc1
    s_waitcnt vmcnt(25)
    v_mfma_f32_32x32x16_bf16 v[32:47], v[80:83], a[92:95], v[32:47]
    v_mfma_f32_32x32x16_bf16 v[48:63], v[84:87], a[92:95], v[48:63]
    s_waitcnt vmcnt(24)
    v_mfma_f32_32x32x16_bf16 v[0:15], v[88:91], a[96:99], v[0:15]
    v_mfma_f32_32x32x16_bf16 v[16:31], v[92:95], a[96:99], v[16:31]
    s_mov_b32 s76, 0x5000
    buffer_load_dwordx4 a[160:163], v225, s[52:55], s76 offen offset:2048 sc1
    buffer_load_dwordx4 a[164:167], v225, s[52:55], s76 offen offset:3072 sc1
    s_waitcnt vmcnt(25)
    v_mfma_f32_32x32x16_bf16 v[32:47], v[88:91], a[100:103], v[32:47]
    v_mfma_f32_32x32x16_bf16 v[48:63], v[92:95], a[100:103], v[48:63]
    s_waitcnt vmcnt(16)
    v_mfma_f32_32x32x16_bf16 v[0:15], v[96:99], a[104:107], v[0:15]
    v_mfma_f32_32x32x16_bf16 v[16:31], v[100:103], a[104:107], v[16:31]
    s_mov_b32 s76, 0x6000
    buffer_load_dwordx4 a[168:171], v225, s[52:55], s76 offen offset:0 sc1
    buffer_load_dwordx4 a[172:175], v225, s[52:55], s76 offen offset:1024 sc1
    buffer_load_dwordx2 v[218:219], v216, s[52:55], 0 offen offset:0 sc1
    s_waitcnt vmcnt(18)
    v_mfma_f32_32x32x16_bf16 v[32:47], v[96:99], a[108:111], v[32:47]
    v_mfma_f32_32x32x16_bf16 v[48:63], v[100:103], a[108:111], v[48:63]
    s_waitcnt vmcnt(17)
    v_mfma_f32_32x32x16_bf16 v[0:15], v[104:107], a[112:115], v[0:15]
    v_mfma_f32_32x32x16_bf16 v[16:31], v[108:111], a[112:115], v[16:31]
    s_mov_b32 s76, 0x6000
    buffer_load_dwordx4 a[176:179], v225, s[52:55], s76 offen offset:2048 sc1
    buffer_load_dwordx4 a[180:183], v225, s[52:55], s76 offen offset:3072 sc1
    s_waitcnt vmcnt(18)
    v_mfma_f32_32x32x16_bf16 v[32:47], v[104:107], a[116:119], v[32:47]
    v_mfma_f32_32x32x16_bf16 v[48:63], v[108:111], a[116:119], v[48:63]
    s_waitcnt vmcnt(17)
    v_mfma_f32_32x32x16_bf16 v[0:15], v[112:115], a[120:123], v[0:15]
    v_mfma_f32_32x32x16_bf16 v[16:31], v[116:119], a[120:123], v[16:31]
    s_mov_b32 s76, 0x7000
    buffer_load_dwordx4 a[184:187], v225, s[52:55], s76 offen offset:0 sc1
    buffer_load_dwordx4 a[188:191], v225, s[52:55], s76 offen offset:1024 sc1
    s_waitcnt vmcnt(18)
    v_mfma_f32_32x32x16_bf16 v[32:47], v[112:115], a[124:127], v[32:47]
    v_mfma_f32_32x32x16_bf16 v[48:63], v[116:119], a[124:127], v[48:63]
    s_waitcnt vmcnt(16)
    v_mfma_f32_32x32x16_bf16 v[0:15], v[120:123], a[128:131], v[0:15]
    v_mfma_f32_32x32x16_bf16 v[16:31], v[124:127], a[128:131], v[16:31]
    s_mov_b32 s76, 0x7000
    buffer_load_dwordx4 a[192:195], v225, s[52:55], s76 offen offset:2048 sc1
    buffer_load_dwordx4 a[196:199], v225, s[52:55], s76 offen offset:3072 sc1
    s_waitcnt vmcnt(17)
    v_mfma_f32_32x32x16_bf16 v[32:47], v[120:123], a[132:135], v[32:47]
    v_mfma_f32_32x32x16_bf16 v[48:63], v[124:127], a[132:135], v[48:63]
    s_waitcnt vmcnt(16)
    v_mfma_f32_32x32x16_bf16 v[0:15], a[0:3], a[136:139], v[0:15]
    v_mfma_f32_32x32x16_bf16 v[16:31], a[4:7], a[136:139], v[16:31]
    s_waitcnt vmcnt(6)
    v_cmp_eq_u64 vcc, v[220:221], v[218:219]
    s_nop 0
    s_and_b32 s69, vcc_lo, 0xf0
    s_cmp_eq_u32 s69, 0xf0
    s_cbranch_scc1 L_fl_ok_h2_1
L_fl_loop_h2_1:
    s_sleep 2
    buffer_load_dwordx2 v[218:219], v216, s[52:55], 0 offen sc1
    s_waitcnt vmcnt(0)
    v_cmp_eq_u64 vcc, v[220:221], v[218:219]
    s_add_u32 s84, s84, 1
    s_cmp_gt_u32 s84, 20000
    s_cbranch_scc1 L_fl_ok_h2_1
    s_and_b32 s69, vcc_lo, 0xf0
    s_cmp_eq_u32 s69, 0xf0
    s_cbranch_scc0 L_fl_loop_h2_1
L_fl_ok_h2_1:
    buffer_load_dword v229, v238, s[52:55], 0 offen offset:0 sc1
    buffer_load_dword v231, v238, s[52:55], 0 offen offset:256 sc1
    s_mov_b32 s76, 0x8000
    buffer_load_dwordx4 a[200:203], v225, s[52:55], s76 offen offset:0 sc1
    buffer_load_dwordx4 a[204:207], v225, s[52:55], s76 offen offset:1024 sc1
    v_mfma_f32_32x32x16_bf16 v[32:47], a[0:3], a[140:143], v[32:47]
    v_mfma_f32_32x32x16_bf16 v[48:63], a[4:7], a[140:143], v[48:63]
    v_mfma_f32_32x32x16_bf16 v[0:15], a[8:11], a[144:147], v[0:15]
    v_mfma_f32_32x32x16_bf16 v[16:31], a[12:15], a[144:147], v[16:31]
    s_mov_b32 s76, 0x8000
    buffer_load_dwordx4 a[208:211], v225, s[52:55], s76 offen offset:2048 sc1
    buffer_load_dwordx4 a[212:215], v225, s[52:55], s76 offen offset:3072 sc1
    v_mfma_f32_32x32x16_bf16 v[32:47], a[8:11], a[148:151], v[32:47]
    v_mfma_f32_32x32x16_bf16 v[48:63], a[12:15], a[148:151], v[48:63]
    v_mfma_f32_32x32x16_bf16 v[0:15], a[16:19], a[152:155], v[0:15]
    v_mfma_f32_32x32x16_bf16 v[16:31], a[20:23], a[152:155], v[16:31]
    s_mov_b32 s76, 0x9000
    buffer_load_dwordx4 a[216:219], v225, s[52:55], s76 offen offset:0 sc1
    buffer_load_dwordx4 a[220:223], v225, s[52:55], s76 offen offset:1024 sc1
    v_mfma_f32_32x32x16_bf16 v[32:47], a[16:19], a[156:159], v[32:47]
    v_mfma_f32_32x32x16_bf16 v[48:63], a[20:23], a[156:159], v[48:63]
    v_mfma_f32_32x32x16_bf16 v[0:15], a[24:27], a[160:163], v[0:15]
    v_mfma_f32_32x32x16_bf16 v[16:31], a[28:31], a[160:163], v[16:31]
    s_mov_b32 s76, 0x9000
    buffer_load_dwordx4 a[224:227], v225, s[52:55], s76 offen offset:2048 sc1
    buffer_load_dwordx4 a[228:231], v225, s[52:55], s76 offen offset:3072 sc1
    v_mfma_f32_32x32x16_bf16 v[32:47], a[24:27], a[164:167], v[32:47]
    v_mfma_f32_32x32x16_bf16 v[48:63], a[28:31], a[164:167], v[48:63]
    v_mfma_f32_32x32x16_bf16 v[0:15], a[32:35], a[168:171], v[0:15]
    v_mfma_f32_32x32x16_bf16 v[16:31], a[36:39], a[168:171], v[16:31]
    s_mov_b32 s76, 0xa000
    buffer_load_dwordx4 a[232:235], v225, s[52:55], s76 offen offset:0 sc1
    buffer_load_dwordx4 a[236:239], v225, s[52:55], s76 offen offset:1024 sc1
    buffer_load_dwordx2 v[218:219], v216, s[52:55], 0 offen offset:0 sc1
    v_mfma_f32_32x32x16_bf16 v[32:47], a[32:35], a[172:175], v[32:47]
    v_mfma_f32_32x32x16_bf16 v[48:63], a[36:39], a[172:175], v[48:63]
    s_waitcnt vmcnt(18)
    v_mfma_f32_32x32x16_bf16 v[0:15], a[40:43], a[176:179], v[0:15]
    v_mfma_f32_32x32x16_bf16 v[16:31], a[44:47], a[176:179], v[16:31]
    s_mov_b32 s76, 0xa000
    buffer_load_dwordx4 a[240:243], v225, s[52:55], s76 offen offset:2048 sc1
    buffer_load_dwordx4 a[244:247], v225, s[52:55], s76 offen offset:3072 sc1
    s_waitcnt vmcnt(19)
    v_mfma_f32_32x32x16_bf16 v[32:47], a[40:43], a[180:183], v[32:47]
    v_mfma_f32_32x32x16_bf16 v[48:63], a[44:47], a[180:183], v[48:63]
    s_waitcnt vmcnt(18)
    v_mfma_f32_32x32x16_bf16 v[0:15], a[48:51], a[184:187], v[0:15]
    v_mfma_f32_32x32x16_bf16 v[16:31], a[52:55], a[184:187], v[16:31]
    s_mov_b32 s76, 0xb000
    buffer_load_dwordx4 a[248:251], v225, s[52:55], s76 offen offset:0 sc1
    buffer_load_dwordx4 a[252:255], v225, s[52:55], s76 offen offset:1024 sc1
    s_waitcnt vmcnt(19)
    v_mfma_f32_32x32x16_bf16 v[32:47], a[48:51], a[188:191], v[32:47]
    v_mfma_f32_32x32x16_bf16 v[48:63], a[52:55], a[188:191], v[48:63]
    s_waitcnt vmcnt(18)
    v_mfma_f32_32x32x16_bf16 v[0:15], a[56:59], a[192:195], v[0:15]
    v_mfma_f32_32x32x16_bf16 v[16:31], a[60:63], a[192:195], v[16:31]
    s_mov_b32 s76, 0xb000
    buffer_load_dwordx4 a[72:75], v225, s[52:55], s76 offen offset:2048 sc1
    buffer_load_dwordx4 a[76:79], v225, s[52:55], s76 offen offset:3072 sc1
    s_waitcnt vmcnt(19)
    v_mfma_f32_32x32x16_bf16 v[32:47], a[56:59], a[196:199], v[32:47]
    v_mfma_f32_32x32x16_bf16 v[48:63], a[60:63], a[196:199], v[48:63]
    s_waitcnt vmcnt(16)
    v_mfma_f32_32x32x16_bf16 v[64:79], a[64:67], a[200:203], 0
    ds_read_b64_tr_b16 v[144:145], v236 offset:2048
    ds_read_b64_tr_b16 v[146:147], v236 offset:3072
    ds_read_b64_tr_b16 v[148:149], v237 offset:2048
    ds_read_b64_tr_b16 v[150:151], v237 offset:3072
    v_mfma_f32_32x32x16_bf16 v[80:95], a[68:71], a[200:203], 0
    s_waitcnt vmcnt(6)
    v_cmp_eq_u64 vcc, v[220:221], v[218:219]
    s_nop 0
    s_and_b32 s69, vcc_lo, 0xff00
    s_cmp_eq_u32 s69, 0xff00
    s_cbranch_scc1 L_fl_ok_h2_2
L_fl_loop_h2_2:
    s_sleep 2
    buffer_load_dwordx2 v[218:219], v216, s[52:55], 0 offen sc1
    s_waitcnt vmcnt(0)
    v_cmp_eq_u64 vcc, v[220:221], v[218:219]
    s_add_u32 s84, s84, 1
    s_cmp_gt_u32 s84, 20000
    s_cbranch_scc1 L_fl_ok_h2_2
    s_and_b32 s69, vcc_lo, 0xff00
    s_cmp_eq_u32 s69, 0xff00
    s_cbranch_scc0 L_fl_loop_h2_2
L_fl_ok_h2_2:
    s_mov_b32 s76, 0xc000
    buffer_load_dwordx4 a[80:83], v225, s[52:55], s76 offen offset:0 sc1
    buffer_load_dwordx4 a[84:87], v225, s[52:55], s76 offen offset:1024 sc1
    v_mfma_f32_32x32x16_bf16 v[96:111], a[64:67], a[204:207], 0
    v_mfma_f32_32x32x16_bf16 v[112:127], a[68:71], a[204:207], 0
    s_waitcnt lgkmcnt(2)
    v_mfma_f32_32x32x16_bf16 v[64:79], v[144:147], a[208:211], v[64:79]
    ds_read_b64_tr_b16 v[136:137], v236 offset:4096
    ds_read_b64_tr_b16 v[138:139], v236 offset:5120
    ds_read_b64_tr_b16 v[140:141], v237 offset:4096
    ds_read_b64_tr_b16 v[142:143], v237 offset:5120
    s_waitcnt lgkmcnt(4)
    v_mfma_f32_32x32x16_bf16 v[80:95], v[148:151], a[208:211], v[80:95]
    s_mov_b32 s76, 0xc000
    buffer_load_dwordx4 a[88:91], v225, s[52:55], s76 offen offset:2048 sc1
    buffer_load_dwordx4 a[92:95], v225, s[52:55], s76 offen offset:3072 sc1
    v_mfma_f32_32x32x16_bf16 v[96:111], v[144:147], a[212:215], v[96:111]
    v_mfma_f32_32x32x16_bf16 v[112:127], v[148:151], a[212:215], v[112:127]
    s_waitcnt lgkmcnt(2)
    v_mfma_f32_32x32x16_bf16 v[64:79], v[136:139], a[216:219], v[64:79]
    ds_read_b64_tr_b16 v[144:145], v236 offset:6144
    ds_read_b64_tr_b16 v[146:147], v236 offset:7168
    ds_read_b64_tr_b16 v[148:149], v237 offset:6144
    ds_read_b64_tr_b16 v[150:151], v237 offset:7168
    s_waitcnt lgkmcnt(4)
    v_mfma_f32_32x32x16_bf16 v[80:95], v[140:143], a[216:219], v[80:95]
    s_mov_b32 s76, 0xd000
    buffer_load_dwordx4 a[96:99], v225, s[52:55], s76 offen offset:0 sc1
    buffer_load_dwordx4 a[100:103], v225, s[52:55], s76 offen offset:1024 sc1
    v_mfma_f32_32x32x16_bf16 v[96:111], v[136:139], a[220:223], v[96:111]
    v_mfma_f32_32x32x16_bf16 v[112:127], v[140:143], a[220:223], v[112:127]
    s_waitcnt lgkmcnt(2)
    v_mfma_f32_32x32x16_bf16 v[64:79], v[144:147], a[224:227], v[64:79]
    ds_read_b64_tr_b16 v[136:137], v236 offset:8192
    ds_read_b64_tr_b16 v[138:139], v236 offset:9216
    ds_read_b64_tr_b16 v[140:141], v237 offset:8192
    ds_read_b64_tr_b16 v[142:143], v237 offset:9216
    s_waitcnt lgkmcnt(4)
    v_mfma_f32_32x32x16_bf16 v[80:95], v[148:151], a[224:227], v[80:95]
    s_mov_b32 s76, 0xd000
    buffer_load_dwordx4 a[104:107], v225, s[52:55], s76 offen offset:2048 sc1
    buffer_load_dwordx4 a[108:111], v225, s[52:55], s76 offen offset:3072 sc1
    v_mfma_f32_32x32x16_bf16 v[96:111], v[144:147], a[228:231], v[96:111]
    v_mfma_f32_32x32x16_bf16 v[112:127], v[148:151], a[228:231], v[112:127]
    s_waitcnt lgkmcnt(2)
    v_mfma_f32_32x32x16_bf16 v[64:79], v[136:139], a[232:235], v[64:79]
    ds_read_b64_tr_b16 v[144:145], v236 offset:10240
    ds_read_b64_tr_b16 v[146:147], v236 offset:11264
    ds_read_b64_tr_b16 v[148:149], v237 offset:10240
    ds_read_b64_tr_b16 v[150:151], v237 offset:11264
    s_waitcnt lgkmcnt(4)
    v_mfma_f32_32x32x16_bf16 v[80:95], v[140:143], a[232:235], v[80:95]
    s_mov_b32 s76, 0xe000
    buffer_load_dwordx4 a[112:115], v225, s[52:55], s76 offen offset:0 sc1
    buffer_load_dwordx4 a[116:119], v225, s[52:55], s76 offen offset:1024 sc1
    v_mfma_f32_32x32x16_bf16 v[96:111], v[136:139], a[236:239], v[96:111]
    v_mfma_f32_32x32x16_bf16 v[112:127], v[140:143], a[236:239], v[112:127]
    s_waitcnt vmcnt(15) lgkmcnt(2)
    v_mfma_f32_32x32x16_bf16 v[64:79], v[144:147], a[240:243], v[64:79]
    ds_read_b64_tr_b16 v[136:137], v234 offset:0
    ds_read_b64_tr_b16 v[138:139], v234 offset:1024
    ds_read_b64_tr_b16 v[140:141], v235 offset:0
    ds_read_b64_tr_b16 v[142:143], v235 offset:1024
    s_waitcnt lgkmcnt(4)
    v_mfma_f32_32x32x16_bf16 v[80:95], v[148:151], a[240:243], v[80:95]
    s_mov_b32 s76, 0xe000
    buffer_load_dwordx4 a[120:123], v225, s[52:55], s76 offen offset:2048 sc1
    buffer_load_dwordx4 a[124:127], v225, s[52:55], s76 offen offset:3072 sc1
    s_waitcnt vmcnt(16)
    v_mfma_f32_32x32x16_bf16 v[96:111], v[144:147], a[244:247], v[96:111]
    v_mfma_f32_32x32x16_bf16 v[112:127], v[148:151], a[244:247], v[112:127]
    s_waitcnt vmcnt(15) lgkmcnt(2)
    v_mfma_f32_32x32x16_bf16 v[64:79], v[136:139], a[248:251], v[64:79]
    ds_read_b64_tr_b16 v[144:145], v232 offset:0
    ds_read_b64_tr_b16 v[146:147], v232 offset:1024
    ds_read_b64_tr_b16 v[148:149], v233 offset:0
    ds_read_b64_tr_b16 v[150:151], v233 offset:1024
    s_waitcnt lgkmcnt(4)
    v_mfma_f32_32x32x16_bf16 v[80:95], v[140:143], a[248:251], v[80:95]
    s_mov_b32 s76, 0xf000
    buffer_load_dwordx4 a[128:131], v225, s[52:55], s76 offen offset:0 sc1
    buffer_load_dwordx4 a[132:135], v225, s[52:55], s76 offen offset:1024 sc1
    s_waitcnt vmcnt(16)
    v_mfma_f32_32x32x16_bf16 v[96:111], v[136:139], a[252:255], v[96:111]
    v_mfma_f32_32x32x16_bf16 v[112:127], v[140:143], a[252:255], v[112:127]
    s_waitcnt vmcnt(15) lgkmcnt(2)
    v_mfma_f32_32x32x16_bf16 v[64:79], v[144:147], a[72:75], v[64:79]
    ds_read_b64_tr_b16 v[136:137], v232 offset:2048
    ds_read_b64_tr_b16 v[138:139], v232 offset:3072
    ds_read_b64_tr_b16 v[140:141], v233 offset:2048
    ds_read_b64_tr_b16 v[142:143], v233 offset:3072
    s_waitcnt lgkmcnt(4)
    v_mfma_f32_32x32x16_bf16 v[80:95], v[148:151], a[72:75], v[80:95]
    s_mov_b32 s76, 0xf000
    buffer_load_dwordx4 a[136:139], v225, s[52:55], s76 offen offset:2048 sc1
    buffer_load_dwordx4 a[140:143], v225, s[52:55], s76 offen offset:3072 sc1
    s_waitcnt vmcnt(16)
    v_mfma_f32_32x32x16_bf16 v[96:111], v[144:147], a[76:79], v[96:111]
    v_mfma_f32_32x32x16_bf16 v[112:127], v[148:151], a[76:79], v[112:127]
    s_waitcnt vmcnt(15) lgkmcnt(2)
    v_mfma_f32_32x32x16_bf16 v[0:15], v[136:139], a[80:83], v[0:15]
    ds_read_b64_tr_b16 v[144:145], v232 offset:4096
    ds_read_b64_tr_b16 v[146:147], v232 offset:5120
    ds_read_b64_tr_b16 v[148:149], v233 offset:4096
    ds_read_b64_tr_b16 v[150:151], v233 offset:5120
    s_waitcnt lgkmcnt(4)
    v_mfma_f32_32x32x16_bf16 v[16:31], v[140:143], a[80:83], v[16:31]
    s_mov_b32 s76, 0x10000
    buffer_load_dwordx4 a[144:147], v225, s[52:55], s76 offen offset:0 sc1
    buffer_load_dwordx4 a[148:151], v225, s[52:55], s76 offen offset:1024 sc1
    s_waitcnt vmcnt(16)
    v_mfma_f32_32x32x16_bf16 v[32:47], v[136:139], a[84:87], v[32:47]
    v_mfma_f32_32x32x16_bf16 v[48:63], v[140:143], a[84:87], v[48:63]
    s_waitcnt vmcnt(15) lgkmcnt(2)
    v_mfma_f32_32x32x16_bf16 v[0:15], v[144:147], a[88:91], v[0:15]
    ds_read_b64_tr_b16 v[136:137], v232 offset:6144
    ds_read_b64_tr_b16 v[138:139], v232 offset:7168
    ds_read_b64_tr_b16 v[140:141], v233 offset:6144
    ds_read_b64_tr_b16 v[142:143], v233 offset:7168
    s_waitcnt lgkmcnt(4)
    v_mfma_f32_32x32x16_bf16 v[16:31], v[148:151], a[88:91], v[16:31]
    s_mov_b32 s76, 0x10000
    buffer_load_dwordx4 a[152:155], v225, s[52:55], s76 offen offset:2048 sc1
    buffer_load_dwordx4 a[156:159], v225, s[52:55], s76 offen offset:3072 sc1
    s_waitcnt vmcnt(16)
    v_mfma_f32_32x32x16_bf16 v[32:47], v[144:147], a[92:95], v[32:47]
    v_sub_f32 v208, 1.0, v229
    v_sub_f32 v209, 1.0, v231
    v_mul_f32 v64, v64, v229
    v_mul_f32 v65, v65, v229
    v_mfma_f32_32x32x16_bf16 v[48:63], v[148:151], a[92:95], v[48:63]
    v_mul_f32 v66, v66, v229
    v_mul_f32 v67, v67, v229
    v_mul_f32 v68, v68, v229
    v_mul_f32 v69, v69, v229
    s_waitcnt vmcnt(15) lgkmcnt(2)
    v_mfma_f32_32x32x16_bf16 v[0:15], v[136:139], a[96:99], v[0:15]
    ds_read_b64_tr_b16 v[144:145], v236 offset:0
    ds_read_b64_tr_b16 v[146:147], v236 offset:1024
    ds_read_b64_tr_b16 v[148:149], v237 offset:0
    ds_read_b64_tr_b16 v[150:151], v237 offset:1024
    s_waitcnt lgkmcnt(4)
    v_mfma_f32_32x32x16_bf16 v[16:31], v[140:143], a[96:99], v[16:31]
    s_mov_b32 s76, 0x11000
    buffer_load_dwordx4 a[160:163], v225, s[52:55], s76 offen offset:0 sc1
    buffer_load_dwordx4 a[164:167], v225, s[52:55], s76 offen offset:1024 sc1
    s_waitcnt vmcnt(16)
    v_mfma_f32_32x32x16_bf16 v[32:47], v[136:139], a[100:103], v[32:47]
    v_mul_f32 v70, v70, v229
    v_mul_f32 v71, v71, v229
    v_mul_f32 v72, v72, v229
    v_mul_f32 v73, v73, v229
    v_mfma_f32_32x32x16_bf16 v[48:63], v[140:143], a[100:103], v[48:63]
    v_mul_f32 v74, v74, v229
    v_mul_f32 v75, v75, v229
    v_mul_f32 v76, v76, v229
    v_mul_f32 v77, v77, v229
    s_waitcnt vmcnt(15) lgkmcnt(2)
    v_mfma_f32_32x32x16_bf16 v[0:15], v[144:147], a[104:107], v[0:15]
    ds_read_b64_tr_b16 v[136:137], v232 offset:8192
    ds_read_b64_tr_b16 v[138:139], v232 offset:9216
    ds_read_b64_tr_b16 v[140:141], v233 offset:8192
    ds_read_b64_tr_b16 v[142:143], v233 offset:9216
    s_waitcnt lgkmcnt(4)
    v_mfma_f32_32x32x16_bf16 v[16:31], v[148:151], a[104:107], v[16:31]
    s_mov_b32 s76, 0x11000
    buffer_load_dwordx4 a[168:171], v225, s[52:55], s76 offen offset:2048 sc1
    buffer_load_dwordx4 a[172:175], v225, s[52:55], s76 offen offset:3072 sc1
    s_waitcnt vmcnt(16)
    v_mfma_f32_32x32x16_bf16 v[32:47], v[144:147], a[108:111], v[32:47]
    v_mul_f32 v78, v78, v229
    v_mul_f32 v79, v79, v229
    v_mul_f32 v80, v80, v229
    v_mul_f32 v81, v81, v229
    v_mfma_f32_32x32x16_bf16 v[48:63], v[148:151], a[108:111], v[48:63]
    v_mul_f32 v82, v82, v229
    v_mul_f32 v83, v83, v229
    v_mul_f32 v84, v84, v229
    v_mul_f32 v85, v85, v229
    s_waitcnt vmcnt(15) lgkmcnt(2)
    v_mfma_f32_32x32x16_bf16 v[0:15], v[136:139], a[112:115], v[0:15]
    ds_read_b64_tr_b16 v[144:145], v232 offset:10240
    ds_read_b64_tr_b16 v[146:147], v232 offset:11264
    ds_read_b64_tr_b16 v[148:149], v233 offset:10240
    ds_read_b64_tr_b16 v[150:151], v233 offset:11264
    s_waitcnt lgkmcnt(4)
    v_mfma_f32_32x32x16_bf16 v[16:31], v[140:143], a[112:115], v[16:31]
    s_waitcnt vmcnt(14)
    v_mfma_f32_32x32x16_bf16 v[32:47], v[136:139], a[116:119], v[32:47]
    v_mul_f32 v86, v86, v229
    v_mul_f32 v87, v87, v229
    v_mul_f32 v88, v88, v229
    v_mul_f32 v89, v89, v229
    v_mfma_f32_32x32x16_bf16 v[48:63], v[140:143], a[116:119], v[48:63]
    v_mul_f32 v90, v90, v229
    v_mul_f32 v91, v91, v229
    v_mul_f32 v92, v92, v229
    v_mul_f32 v93, v93, v229
    s_waitcnt vmcnt(13) lgkmcnt(2)
    v_mfma_f32_32x32x16_bf16 v[0:15], v[144:147], a[120:123], v[0:15]
    ds_read_b64_tr_b16 v[136:137], v232 offset:12288
    ds_read_b64_tr_b16 v[138:139], v232 offset:13312
    ds_read_b64_tr_b16 v[140:141], v233 offset:12288
    ds_read_b64_tr_b16 v[142:143], v233 offset:13312
    s_waitcnt lgkmcnt(4)
    v_mfma_f32_32x32x16_bf16 v[16:31], v[148:151], a[120:123], v[16:31]
    s_waitcnt vmcnt(12)
    v_mfma_f32_32x32x16_bf16 v[32:47], v[144:147], a[124:127], v[32:47]
    v_mul_f32 v94, v94, v229
    v_mul_f32 v95, v95, v229
    v_mul_f32 v96, v96, v231
    v_mul_f32 v97, v97, v231
    v_mfma_f32_32x32x16_bf16 v[48:63], v[148:151], a[124:127], v[48:63]
    v_mul_f32 v98, v98, v231
    v_mul_f32 v99, v99, v231
    v_mul_f32 v100, v100, v231
    v_mul_f32 v101, v101, v231
    s_waitcnt vmcnt(11) lgkmcnt(2)
    v_mfma_f32_32x32x16_bf16 v[0:15], v[136:139], a[128:131], v[0:15]
    ds_read_b64_tr_b16 v[144:145], v232 offset:14336
    ds_read_b64_tr_b16 v[146:147], v232 offset:15360
    ds_read_b64_tr_b16 v[148:149], v233 offset:14336
    ds_read_b64_tr_b16 v[150:151], v233 offset:15360
    s_waitcnt lgkmcnt(4)
    v_mfma_f32_32x32x16_bf16 v[16:31], v[140:143], a[128:131], v[16:31]
    s_waitcnt vmcnt(10)
    v_mfma_f32_32x32x16_bf16 v[32:47], v[136:139], a[132:135], v[32:47]
    v_mul_f32 v102, v102, v231
    v_mul_f32 v103, v103, v231
    v_mul_f32 v104, v104, v231
    v_mul_f32 v105, v105, v231
    v_mfma_f32_32x32x16_bf16 v[48:63], v[140:143], a[132:135], v[48:63]
    v_mul_f32 v106, v106, v231
    v_mul_f32 v107, v107, v231
    v_mul_f32 v108, v108, v231
    v_mul_f32 v109, v109, v231
    s_waitcnt vmcnt(9) lgkmcnt(2)
    v_mfma_f32_32x32x16_bf16 v[0:15], v[144:147], a[136:139], v[0:15]
    ds_read_b64_tr_b16 v[136:137], v232 offset:16384
    ds_read_b64_tr_b16 v[138:139], v232 offset:17408
    ds_read_b64_tr_b16 v[140:141], v233 offset:16384
    ds_read_b64_tr_b16 v[142:143], v233 offset:17408
    s_waitcnt lgkmcnt(4)
    v_mfma_f32_32x32x16_bf16 v[16:31], v[148:151], a[136:139], v[16:31]
    s_waitcnt vmcnt(8)
    v_mfma_f32_32x32x16_bf16 v[32:47], v[144:147], a[140:143], v[32:47]
    v_mul_f32 v110, v110, v231
    v_mul_f32 v111, v111, v231
    v_mul_f32 v112, v112, v231
    v_mul_f32 v113, v113, v231
    v_mfma_f32_32x32x16_bf16 v[48:63], v[148:151], a[140:143], v[48:63]
    v_mul_f32 v114, v114, v231
    v_mul_f32 v115, v115, v231
    v_mul_f32 v116, v116, v231
    v_mul_f32 v117, v117, v231
    s_waitcnt vmcnt(7) lgkmcnt(2)
    v_mfma_f32_32x32x16_bf16 v[0:15], v[136:139], a[144:147], v[0:15]
    ds_read_b64_tr_b16 v[144:145], v232 offset:18432
    ds_read_b64_tr_b16 v[146:147], v232 offset:19456
    ds_read_b64_tr_b16 v[148:149], v233 offset:18432
    ds_read_b64_tr_b16 v[150:151], v233 offset:19456
    s_waitcnt lgkmcnt(4)
    v_mfma_f32_32x32x16_bf16 v[16:31], v[140:143], a[144:147], v[16:31]
    s_waitcnt vmcnt(6)
    v_mfma_f32_32x32x16_bf16 v[32:47], v[136:139], a[148:151], v[32:47]
    v_mul_f32 v118, v118, v231
    v_mul_f32 v119, v119, v231
    v_mul_f32 v120, v120, v231
    v_mul_f32 v121, v121, v231
    v_mfma_f32_32x32x16_bf16 v[48:63], v[140:143], a[148:151], v[48:63]
    v_mul_f32 v122, v122, v231
    v_mul_f32 v123, v123, v231
    v_mul_f32 v124, v124, v231
    v_mul_f32 v125, v125, v231
    s_waitcnt vmcnt(5) lgkmcnt(2)
    v_mfma_f32_32x32x16_bf16 v[0:15], v[144:147], a[152:155], v[0:15]
    ds_read_b64_tr_b16 v[136:137], v232 offset:20480
    ds_read_b64_tr_b16 v[138:139], v232 offset:21504
    ds_read_b64_tr_b16 v[140:141], v233 offset:20480
    ds_read_b64_tr_b16 v[142:143], v233 offset:21504
    s_waitcnt lgkmcnt(4)
    v_mfma_f32_32x32x16_bf16 v[16:31], v[148:151], a[152:155], v[16:31]
    s_waitcnt vmcnt(4)
    v_mfma_f32_32x32x16_bf16 v[32:47], v[144:147], a[156:159], v[32:47]
    v_mul_f32 v126, v126, v231
    v_mul_f32 v127, v127, v231
    v_mfma_f32_32x32x16_bf16 v[48:63], v[148:151], a[156:159], v[48:63]
    s_waitcnt vmcnt(3) lgkmcnt(2)
    v_mfma_f32_32x32x16_bf16 v[0:15], v[136:139], a[160:163], v[0:15]
    ds_read_b64_tr_b16 v[144:145], v232 offset:22528
    ds_read_b64_tr_b16 v[146:147], v232 offset:23552
    ds_read_b64_tr_b16 v[148:149], v233 offset:22528
    ds_read_b64_tr_b16 v[150:151], v233 offset:23552
    s_waitcnt lgkmcnt(4)
    v_mfma_f32_32x32x16_bf16 v[16:31], v[140:143], a[160:163], v[16:31]
    s_waitcnt vmcnt(2)
    v_mfma_f32_32x32x16_bf16 v[32:47], v[136:139], a[164:167], v[32:47]
    v_mfma_f32_32x32x16_bf16 v[48:63], v[140:143], a[164:167], v[48:63]
    s_waitcnt vmcnt(1) lgkmcnt(2)
    v_mfma_f32_32x32x16_bf16 v[0:15], v[144:147], a[168:171], v[0:15]
    s_waitcnt lgkmcnt(0)
    v_mfma_f32_32x32x16_bf16 v[16:31], v[148:151], a[168:171], v[16:31]
    s_waitcnt vmcnt(0)
    v_mfma_f32_32x32x16_bf16 v[32:47], v[144:147], a[172:175], v[32:47]
    v_mfma_f32_32x32x16_bf16 v[48:63], v[148:151], a[172:175], v[48:63]
    s_cmp_eq_u32 s60, 0
    s_cbranch_scc0 L_red_h2_1
    s_nop 6
    v_fmac_f32 v80, v16, v208
    v_fmac_f32 v81, v17, v208
    v_fmac_f32 v82, v18, v208
    v_fmac_f32 v83, v19, v208
    v_fmac_f32 v84, v20, v208
    v_fmac_f32 v85, v21, v208
    v_fmac_f32 v86, v22, v208
    v_fmac_f32 v87, v23, v208
    v_fmac_f32 v88, v24, v208
    v_fmac_f32 v89, v25, v208
    v_fmac_f32 v90, v26, v208
    v_fmac_f32 v91, v27, v208
    v_fmac_f32 v92, v28, v208
    v_fmac_f32 v93, v29, v208
    v_fmac_f32 v94, v30, v208
    v_fmac_f32 v95, v31, v208
    ds_write_b128 v226, v[80:83] offset:0
    ds_write_b128 v226, v[84:87] offset:1024
    ds_write_b128 v226, v[88:91] offset:2048
    ds_write_b128 v226, v[92:95] offset:3072
    v_fmac_f32 v96, v32, v209
    v_fmac_f32 v97, v33, v209
    v_fmac_f32 v98, v34, v209
    v_fmac_f32 v99, v35, v209
    v_fmac_f32 v100, v36, v209
    v_fmac_f32 v101, v37, v209
    v_fmac_f32 v102, v38, v209
    v_fmac_f32 v103, v39, v209
    v_fmac_f32 v104, v40, v209
    v_fmac_f32 v105, v41, v209
    v_fmac_f32 v106, v42, v209
    v_fmac_f32 v107, v43, v209
    v_fmac_f32 v108, v44, v209
    v_fmac_f32 v109, v45, v209
    v_fmac_f32 v110, v46, v209
    v_fmac_f32 v111, v47, v209
    ds_write_b128 v226, v[96:99] offset:4096
    ds_write_b128 v226, v[100:103] offset:5120
    ds_write_b128 v226, v[104:107] offset:6144
    ds_write_b128 v226, v[108:111] offset:7168
    v_fmac_f32 v112, v48, v209
    v_fmac_f32 v113, v49, v209
    v_fmac_f32 v114, v50, v209
    v_fmac_f32 v115, v51, v209
    v_fmac_f32 v116, v52, v209
    v_fmac_f32 v117, v53, v209
    v_fmac_f32 v118, v54, v209
    v_fmac_f32 v119, v55, v209
    v_fmac_f32 v120, v56, v209
    v_fmac_f32 v121, v57, v209
    v_fmac_f32 v122, v58, v209
    v_fmac_f32 v123, v59, v209
    v_fmac_f32 v124, v60, v209
    v_fmac_f32 v125, v61, v209
    v_fmac_f32 v126, v62, v209
    v_fmac_f32 v127, v63, v209
    ds_write_b128 v226, v[112:115] offset:8192
    ds_write_b128 v226, v[116:119] offset:9216
    ds_write_b128 v226, v[120:123] offset:10240
    ds_write_b128 v226, v[124:127] offset:11264
    v_fmac_f32 v64, v0, v208
    v_fmac_f32 v65, v1, v208
    v_fmac_f32 v66, v2, v208
    v_fmac_f32 v67, v3, v208
    v_fmac_f32 v68, v4, v208
    v_fmac_f32 v69, v5, v208
    v_fmac_f32 v70, v6, v208
    v_fmac_f32 v71, v7, v208
    v_fmac_f32 v72, v8, v208
    v_fmac_f32 v73, v9, v208
    v_fmac_f32 v74, v10, v208
    v_fmac_f32 v75, v11, v208
    v_fmac_f32 v76, v12, v208
    v_fmac_f32 v77, v13, v208
    v_fmac_f32 v78, v14, v208
    v_fmac_f32 v79, v15, v208
    s_waitcnt lgkmcnt(0)
    s_barrier
    ds_read_b128 v[0:3], v227 offset:20480
    ds_read_b128 v[4:7], v227 offset:21504
    ds_read_b128 v[8:11], v227 offset:22528
    ds_read_b128 v[12:15], v227 offset:23552
    ds_read_b128 v[16:19], v227 offset:28672
    ds_read_b128 v[20:23], v227 offset:29696
    ds_read_b128 v[24:27], v227 offset:30720
    ds_read_b128 v[28:31], v227 offset:31744
    ds_read_b128 v[32:35], v227 offset:36864
    ds_read_b128 v[36:39], v227 offset:37888
    ds_read_b128 v[40:43], v227 offset:38912
    ds_read_b128 v[44:47], v227 offset:39936
    s_waitcnt lgkmcnt(11)
    v_add_f32 v64, v64, v0
    v_add_f32 v65, v65, v1
    v_add_f32 v66, v66, v2
    v_add_f32 v67, v67, v3
    s_waitcnt lgkmcnt(10)
    v_add_f32 v68, v68, v4
    v_add_f32 v69, v69, v5
    v_add_f32 v70, v70, v6
    v_add_f32 v71, v71, v7
    s_waitcnt lgkmcnt(9)
    v_add_f32 v72, v72, v8
    v_add_f32 v73, v73, v9
    v_add_f32 v74, v74, v10
    v_add_f32 v75, v75, v11
    s_waitcnt lgkmcnt(8)
    v_add_f32 v76, v76, v12
    v_add_f32 v77, v77, v13
    v_add_f32 v78, v78, v14
    v_add_f32 v79, v79, v15
    s_waitcnt lgkmcnt(7)
    v_add_f32 v64, v64, v16
    v_add_f32 v65, v65, v17
    v_add_f32 v66, v66, v18
    v_add_f32 v67, v67, v19
    s_waitcnt lgkmcnt(6)
    v_add_f32 v68, v68, v20
    v_add_f32 v69, v69, v21
    v_add_f32 v70, v70, v22
    v_add_f32 v71, v71, v23
    s_waitcnt lgkmcnt(5)
    v_add_f32 v72, v72, v24
    v_add_f32 v73, v73, v25
    v_add_f32 v74, v74, v26
    v_add_f32 v75, v75, v27
    s_waitcnt lgkmcnt(4)
    v_add_f32 v76, v76, v28
    v_add_f32 v77, v77, v29
    v_add_f32 v78, v78, v30
    v_add_f32 v79, v79, v31
    s_waitcnt lgkmcnt(3)
    v_add_f32 v64, v64, v32
    v_add_f32 v65, v65, v33
    v_add_f32 v66, v66, v34
    v_add_f32 v67, v67, v35
    s_waitcnt lgkmcnt(2)
    v_add_f32 v68, v68, v36
    v_add_f32 v69, v69, v37
    v_add_f32 v70, v70, v38
    v_add_f32 v71, v71, v39
    s_waitcnt lgkmcnt(1)
    v_add_f32 v72, v72, v40
    v_add_f32 v73, v73, v41
    v_add_f32 v74, v74, v42
    v_add_f32 v75, v75, v43
    s_waitcnt lgkmcnt(0)
    v_add_f32 v76, v76, v44
    v_add_f32 v77, v77, v45
    v_add_f32 v78, v78, v46
    v_add_f32 v79, v79, v47
    v_cvt_pk_bf16_f32 v64, v64, v65
    v_cvt_pk_bf16_f32 v65, v66, v67
    v_cvt_pk_bf16_f32 v66, v68, v69
    v_cvt_pk_bf16_f32 v67, v70, v71
    v_cvt_pk_bf16_f32 v68, v72, v73
    v_cvt_pk_bf16_f32 v69, v74, v75
    v_cvt_pk_bf16_f32 v70, v76, v77
    v_cvt_pk_bf16_f32 v71, v78, v79
    buffer_store_dwordx4 v[64:67], v228, s[48:51], 0 offen offset:0
    buffer_store_dwordx4 v[68:71], v228, s[48:51], 0 offen offset:16
    s_branch L_fin_h2
L_red_h2_1:
    s_cmp_eq_u32 s60, 1
    s_cbranch_scc0 L_red_h2_2
    s_nop 8
    v_fmac_f32 v96, v32, v209
    v_fmac_f32 v97, v33, v209
    v_fmac_f32 v98, v34, v209
    v_fmac_f32 v99, v35, v209
    v_fmac_f32 v100, v36, v209
    v_fmac_f32 v101, v37, v209
    v_fmac_f32 v102, v38, v209
    v_fmac_f32 v103, v39, v209
    v_fmac_f32 v104, v40, v209
    v_fmac_f32 v105, v41, v209
    v_fmac_f32 v106, v42, v209
    v_fmac_f32 v107, v43, v209
    v_fmac_f32 v108, v44, v209
    v_fmac_f32 v109, v45, v209
    v_fmac_f32 v110, v46, v209
    v_fmac_f32 v111, v47, v209
    ds_write_b128 v226, v[96:99] offset:0
    ds_write_b128 v226, v[100:103] offset:1024
    ds_write_b128 v226, v[104:107] offset:2048
    ds_write_b128 v226, v[108:111] offset:3072
    v_fmac_f32 v112, v48, v209
    v_fmac_f32 v113, v49, v209
    v_fmac_f32 v114, v50, v209
    v_fmac_f32 v115, v51, v209
    v_fmac_f32 v116, v52, v209
    v_fmac_f32 v117, v53, v209
    v_fmac_f32 v118, v54, v209
    v_fmac_f32 v119, v55, v209
    v_fmac_f32 v120, v56, v209
    v_fmac_f32 v121, v57, v209
    v_fmac_f32 v122, v58, v209
    v_fmac_f32 v123, v59, v209
    v_fmac_f32 v124, v60, v209
    v_fmac_f32 v125, v61, v209
    v_fmac_f32 v126, v62, v209
    v_fmac_f32 v127, v63, v209
    ds_write_b128 v226, v[112:115] offset:4096
    ds_write_b128 v226, v[116:119] offset:5120
    ds_write_b128 v226, v[120:123] offset:6144
    ds_write_b128 v226, v[124:127] offset:7168
    v_fmac_f32 v64, v0, v208
    v_fmac_f32 v65, v1, v208
    v_fmac_f32 v66, v2, v208
    v_fmac_f32 v67, v3, v208
    v_fmac_f32 v68, v4, v208
    v_fmac_f32 v69, v5, v208
    v_fmac_f32 v70, v6, v208
    v_fmac_f32 v71, v7, v208
    v_fmac_f32 v72, v8, v208
    v_fmac_f32 v73, v9, v208
    v_fmac_f32 v74, v10, v208
    v_fmac_f32 v75, v11, v208
    v_fmac_f32 v76, v12, v208
    v_fmac_f32 v77, v13, v208
    v_fmac_f32 v78, v14, v208
    v_fmac_f32 v79, v15, v208
    ds_write_b128 v226, v[64:67] offset:8192
    ds_write_b128 v226, v[68:71] offset:9216
    ds_write_b128 v226, v[72:75] offset:10240
    ds_write_b128 v226, v[76:79] offset:11264
    v_fmac_f32 v80, v16, v208
    v_fmac_f32 v81, v17, v208
    v_fmac_f32 v82, v18, v208
    v_fmac_f32 v83, v19, v208
    v_fmac_f32 v84, v20, v208
    v_fmac_f32 v85, v21, v208
    v_fmac_f32 v86, v22, v208
    v_fmac_f32 v87, v23, v208
    v_fmac_f32 v88, v24, v208
    v_fmac_f32 v89, v25, v208
    v_fmac_f32 v90, v26, v208
    v_fmac_f32 v91, v27, v208
    v_fmac_f32 v92, v28, v208
    v_fmac_f32 v93, v29, v208
    v_fmac_f32 v94, v30, v208
    v_fmac_f32 v95, v31, v208
    s_waitcnt lgkmcnt(0)
    s_barrier
    ds_read_b128 v[0:3], v227 offset:0
    ds_read_b128 v[4:7], v227 offset:1024
    ds_read_b128 v[8:11], v227 offset:2048
    ds_read_b128 v[12:15], v227 offset:3072
    ds_read_b128 v[16:19], v227 offset:32768
    ds_read_b128 v[20:23], v227 offset:33792
    ds_read_b128 v[24:27], v227 offset:34816
    ds_read_b128 v[28:31], v227 offset:35840
    ds_read_b128 v[32:35], v227 offset:40960
    ds_read_b128 v[36:39], v227 offset:41984
    ds_read_b128 v[40:43], v227 offset:43008
    ds_read_b128 v[44:47], v227 offset:44032
    s_waitcnt lgkmcnt(11)
    v_add_f32 v80, v80, v0
    v_add_f32 v81, v81, v1
    v_add_f32 v82, v82, v2
    v_add_f32 v83, v83, v3
    s_waitcnt lgkmcnt(10)
    v_add_f32 v84, v84, v4
    v_add_f32 v85, v85, v5
    v_add_f32 v86, v86, v6
    v_add_f32 v87, v87, v7
    s_waitcnt lgkmcnt(9)
    v_add_f32 v88, v88, v8
    v_add_f32 v89, v89, v9
    v_add_f32 v90, v90, v10
    v_add_f32 v91, v91, v11
    s_waitcnt lgkmcnt(8)
    v_add_f32 v92, v92, v12
    v_add_f32 v93, v93, v13
    v_add_f32 v94, v94, v14
    v_add_f32 v95, v95, v15
    s_waitcnt lgkmcnt(7)
    v_add_f32 v80, v80, v16
    v_add_f32 v81, v81, v17
    v_add_f32 v82, v82, v18
    v_add_f32 v83, v83, v19
    s_waitcnt lgkmcnt(6)
    v_add_f32 v84, v84, v20
    v_add_f32 v85, v85, v21
    v_add_f32 v86, v86, v22
    v_add_f32 v87, v87, v23
    s_waitcnt lgkmcnt(5)
    v_add_f32 v88, v88, v24
    v_add_f32 v89, v89, v25
    v_add_f32 v90, v90, v26
    v_add_f32 v91, v91, v27
    s_waitcnt lgkmcnt(4)
    v_add_f32 v92, v92, v28
    v_add_f32 v93, v93, v29
    v_add_f32 v94, v94, v30
    v_add_f32 v95, v95, v31
    s_waitcnt lgkmcnt(3)
    v_add_f32 v80, v80, v32
    v_add_f32 v81, v81, v33
    v_add_f32 v82, v82, v34
    v_add_f32 v83, v83, v35
    s_waitcnt lgkmcnt(2)
    v_add_f32 v84, v84, v36
    v_add_f32 v85, v85, v37
    v_add_f32 v86, v86, v38
    v_add_f32 v87, v87, v39
    s_waitcnt lgkmcnt(1)
    v_add_f32 v88, v88, v40
    v_add_f32 v89, v89, v41
    v_add_f32 v90, v90, v42
    v_add_f32 v91, v91, v43
    s_waitcnt lgkmcnt(0)
    v_add_f32 v92, v92, v44
    v_add_f32 v93, v93, v45
    v_add_f32 v94, v94, v46
    v_add_f32 v95, v95, v47
    v_cvt_pk_bf16_f32 v80, v80, v81
    v_cvt_pk_bf16_f32 v81, v82, v83
    v_cvt_pk_bf16_f32 v82, v84, v85
    v_cvt_pk_bf16_f32 v83, v86, v87
    v_cvt_pk_bf16_f32 v84, v88, v89
    v_cvt_pk_bf16_f32 v85, v90, v91
    v_cvt_pk_bf16_f32 v86, v92, v93
    v_cvt_pk_bf16_f32 v87, v94, v95
    buffer_store_dwordx4 v[80:83], v228, s[48:51], 0 offen offset:0
    buffer_store_dwordx4 v[84:87], v228, s[48:51], 0 offen offset:16
    s_branch L_fin_h2
L_red_h2_2:
    s_cmp_eq_u32 s60, 2
    s_cbranch_scc0 L_red_h2_3
    s_nop 9
    v_fmac_f32 v112, v48, v209
    v_fmac_f32 v113, v49, v209
    v_fmac_f32 v114, v50, v209
    v_fmac_f32 v115, v51, v209
    v_fmac_f32 v116, v52, v209
    v_fmac_f32 v117, v53, v209
    v_fmac_f32 v118, v54, v209
    v_fmac_f32 v119, v55, v209
    v_fmac_f32 v120, v56, v209
    v_fmac_f32 v121, v57, v209
    v_fmac_f32 v122, v58, v209
    v_fmac_f32 v123, v59, v209
    v_fmac_f32 v124, v60, v209
    v_fmac_f32 v125, v61, v209
    v_fmac_f32 v126, v62, v209
    v_fmac_f32 v127, v63, v209
    ds_write_b128 v226, v[112:115] offset:0
    ds_write_b128 v226, v[116:119] offset:1024
    ds_write_b128 v226, v[120:123] offset:2048
    ds_write_b128 v226, v[124:127] offset:3072
    v_fmac_f32 v64, v0, v208
    v_fmac_f32 v65, v1, v208
    v_fmac_f32 v66, v2, v208
    v_fmac_f32 v67, v3, v208
    v_fmac_f32 v68, v4, v208
    v_fmac_f32 v69, v5, v208
    v_fmac_f32 v70, v6, v208
    v_fmac_f32 v71, v7, v208
    v_fmac_f32 v72, v8, v208
    v_fmac_f32 v73, v9, v208
    v_fmac_f32 v74, v10, v208
    v_fmac_f32 v75, v11, v208
    v_fmac_f32 v76, v12, v208
    v_fmac_f32 v77, v13, v208
    v_fmac_f32 v78, v14, v208
    v_fmac_f32 v79, v15, v208
    ds_write_b128 v226, v[64:67] offset:4096
    ds_write_b128 v226, v[68:71] offset:5120
    ds_write_b128 v226, v[72:75] offset:6144
    ds_write_b128 v226, v[76:79] offset:7168
    v_fmac_f32 v80, v16, v208
    v_fmac_f32 v81, v17, v208
    v_fmac_f32 v82, v18, v208
    v_fmac_f32 v83, v19, v208
    v_fmac_f32 v84, v20, v208
    v_fmac_f32 v85, v21, v208
    v_fmac_f32 v86, v22, v208
    v_fmac_f32 v87, v23, v208
    v_fmac_f32 v88, v24, v208
    v_fmac_f32 v89, v25, v208
    v_fmac_f32 v90, v26, v208
    v_fmac_f32 v91, v27, v208
    v_fmac_f32 v92, v28, v208
    v_fmac_f32 v93, v29, v208
    v_fmac_f32 v94, v30, v208
    v_fmac_f32 v95, v31, v208
    ds_write_b128 v226, v[80:83] offset:8192
    ds_write_b128 v226, v[84:87] offset:9216
    ds_write_b128 v226, v[88:91] offset:10240
    ds_write_b128 v226, v[92:95] offset:11264
    v_fmac_f32 v96, v32, v209
    v_fmac_f32 v97, v33, v209
    v_fmac_f32 v98, v34, v209
    v_fmac_f32 v99, v35, v209
    v_fmac_f32 v100, v36, v209
    v_fmac_f32 v101, v37, v209
    v_fmac_f32 v102, v38, v209
    v_fmac_f32 v103, v39, v209
    v_fmac_f32 v104, v40, v209
    v_fmac_f32 v105, v41, v209
    v_fmac_f32 v106, v42, v209
    v_fmac_f32 v107, v43, v209
    v_fmac_f32 v108, v44, v209
    v_fmac_f32 v109, v45, v209
    v_fmac_f32 v110, v46, v209
    v_fmac_f32 v111, v47, v209
    s_waitcnt lgkmcnt(0)
    s_barrier
    ds_read_b128 v[0:3], v227 offset:4096
    ds_read_b128 v[4:7], v227 offset:5120
    ds_read_b128 v[8:11], v227 offset:6144
    ds_read_b128 v[12:15], v227 offset:7168
    ds_read_b128 v[16:19], v227 offset:12288
    ds_read_b128 v[20:23], v227 offset:13312
    ds_read_b128 v[24:27], v227 offset:14336
    ds_read_b128 v[28:31], v227 offset:15360
    ds_read_b128 v[32:35], v227 offset:45056
    ds_read_b128 v[36:39], v227 offset:46080
    ds_read_b128 v[40:43], v227 offset:47104
    ds_read_b128 v[44:47], v227 offset:48128
    s_waitcnt lgkmcnt(11)
    v_add_f32 v96, v96, v0
    v_add_f32 v97, v97, v1
    v_add_f32 v98, v98, v2
    v_add_f32 v99, v99, v3
    s_waitcnt lgkmcnt(10)
    v_add_f32 v100, v100, v4
    v_add_f32 v101, v101, v5
    v_add_f32 v102, v102, v6
    v_add_f32 v103, v103, v7
    s_waitcnt lgkmcnt(9)
    v_add_f32 v104, v104, v8
    v_add_f32 v105, v105, v9
    v_add_f32 v106, v106, v10
    v_add_f32 v107, v107, v11
    s_waitcnt lgkmcnt(8)
    v_add_f32 v108, v108, v12
    v_add_f32 v109, v109, v13
    v_add_f32 v110, v110, v14
    v_add_f32 v111, v111, v15
    s_waitcnt lgkmcnt(7)
    v_add_f32 v96, v96, v16
    v_add_f32 v97, v97, v17
    v_add_f32 v98, v98, v18
    v_add_f32 v99, v99, v19
    s_waitcnt lgkmcnt(6)
    v_add_f32 v100, v100, v20
    v_add_f32 v101, v101, v21
    v_add_f32 v102, v102, v22
    v_add_f32 v103, v103, v23
    s_waitcnt lgkmcnt(5)
    v_add_f32 v104, v104, v24
    v_add_f32 v105, v105, v25
    v_add_f32 v106, v106, v26
    v_add_f32 v107, v107, v27
    s_waitcnt lgkmcnt(4)
    v_add_f32 v108, v108, v28
    v_add_f32 v109, v109, v29
    v_add_f32 v110, v110, v30
    v_add_f32 v111, v111, v31
    s_waitcnt lgkmcnt(3)
    v_add_f32 v96, v96, v32
    v_add_f32 v97, v97, v33
    v_add_f32 v98, v98, v34
    v_add_f32 v99, v99, v35
    s_waitcnt lgkmcnt(2)
    v_add_f32 v100, v100, v36
    v_add_f32 v101, v101, v37
    v_add_f32 v102, v102, v38
    v_add_f32 v103, v103, v39
    s_waitcnt lgkmcnt(1)
    v_add_f32 v104, v104, v40
    v_add_f32 v105, v105, v41
    v_add_f32 v106, v106, v42
    v_add_f32 v107, v107, v43
    s_waitcnt lgkmcnt(0)
    v_add_f32 v108, v108, v44
    v_add_f32 v109, v109, v45
    v_add_f32 v110, v110, v46
    v_add_f32 v111, v111, v47
    v_cvt_pk_bf16_f32 v96, v96, v97
    v_cvt_pk_bf16_f32 v97, v98, v99
    v_cvt_pk_bf16_f32 v98, v100, v101
    v_cvt_pk_bf16_f32 v99, v102, v103
    v_cvt_pk_bf16_f32 v100, v104, v105
    v_cvt_pk_bf16_f32 v101, v106, v107
    v_cvt_pk_bf16_f32 v102, v108, v109
    v_cvt_pk_bf16_f32 v103, v110, v111
    buffer_store_dwordx4 v[96:99], v228, s[48:51], 0 offen offset:0
    buffer_store_dwordx4 v[100:103], v228, s[48:51], 0 offen offset:16
    s_branch L_fin_h2
L_red_h2_3:
    s_nop 6
    v_fmac_f32 v64, v0, v208
    v_fmac_f32 v65, v1, v208
    v_fmac_f32 v66, v2, v208
    v_fmac_f32 v67, v3, v208
    v_fmac_f32 v68, v4, v208
    v_fmac_f32 v69, v5, v208
    v_fmac_f32 v70, v6, v208
    v_fmac_f32 v71, v7, v208
    v_fmac_f32 v72, v8, v208
    v_fmac_f32 v73, v9, v208
    v_fmac_f32 v74, v10, v208
    v_fmac_f32 v75, v11, v208
    v_fmac_f32 v76, v12, v208
    v_fmac_f32 v77, v13, v208
    v_fmac_f32 v78, v14, v208
    v_fmac_f32 v79, v15, v208
    ds_write_b128 v226, v[64:67] offset:0
    ds_write_b128 v226, v[68:71] offset:1024
    ds_write_b128 v226, v[72:75] offset:2048
    ds_write_b128 v226, v[76:79] offset:3072
    v_fmac_f32 v80, v16, v208
    v_fmac_f32 v81, v17, v208
    v_fmac_f32 v82, v18, v208
    v_fmac_f32 v83, v19, v208
    v_fmac_f32 v84, v20, v208
    v_fmac_f32 v85, v21, v208
    v_fmac_f32 v86, v22, v208
    v_fmac_f32 v87, v23, v208
    v_fmac_f32 v88, v24, v208
    v_fmac_f32 v89, v25, v208
    v_fmac_f32 v90, v26, v208
    v_fmac_f32 v91, v27, v208
    v_fmac_f32 v92, v28, v208
    v_fmac_f32 v93, v29, v208
    v_fmac_f32 v94, v30, v208
    v_fmac_f32 v95, v31, v208
    ds_write_b128 v226, v[80:83] offset:4096
    ds_write_b128 v226, v[84:87] offset:5120
    ds_write_b128 v226, v[88:91] offset:6144
    ds_write_b128 v226, v[92:95] offset:7168
    v_fmac_f32 v96, v32, v209
    v_fmac_f32 v97, v33, v209
    v_fmac_f32 v98, v34, v209
    v_fmac_f32 v99, v35, v209
    v_fmac_f32 v100, v36, v209
    v_fmac_f32 v101, v37, v209
    v_fmac_f32 v102, v38, v209
    v_fmac_f32 v103, v39, v209
    v_fmac_f32 v104, v40, v209
    v_fmac_f32 v105, v41, v209
    v_fmac_f32 v106, v42, v209
    v_fmac_f32 v107, v43, v209
    v_fmac_f32 v108, v44, v209
    v_fmac_f32 v109, v45, v209
    v_fmac_f32 v110, v46, v209
    v_fmac_f32 v111, v47, v209
    ds_write_b128 v226, v[96:99] offset:8192
    ds_write_b128 v226, v[100:103] offset:9216
    ds_write_b128 v226, v[104:107] offset:10240
    ds_write_b128 v226, v[108:111] offset:11264
    v_fmac_f32 v112, v48, v209
    v_fmac_f32 v113, v49, v209
    v_fmac_f32 v114, v50, v209
    v_fmac_f32 v115, v51, v209
    v_fmac_f32 v116, v52, v209
    v_fmac_f32 v117, v53, v209
    v_fmac_f32 v118, v54, v209
    v_fmac_f32 v119, v55, v209
    v_fmac_f32 v120, v56, v209
    v_fmac_f32 v121, v57, v209
    v_fmac_f32 v122, v58, v209
    v_fmac_f32 v123, v59, v209
    v_fmac_f32 v124, v60, v209
    v_fmac_f32 v125, v61, v209
    v_fmac_f32 v126, v62, v209
    v_fmac_f32 v127, v63, v209
    s_waitcnt lgkmcnt(0)
    s_barrier
    ds_read_b128 v[0:3], v227 offset:8192
    ds_read_b128 v[4:7], v227 offset:9216
    ds_read_b128 v[8:11], v227 offset:10240
    ds_read_b128 v[12:15], v227 offset:11264
    ds_read_b128 v[16:19], v227 offset:16384
    ds_read_b128 v[20:23], v227 offset:17408
    ds_read_b128 v[24:27], v227 offset:18432
    ds_read_b128 v[28:31], v227 offset:19456
    ds_read_b128 v[32:35], v227 offset:24576
    ds_read_b128 v[36:39], v227 offset:25600
    ds_read_b128 v[40:43], v227 offset:26624
    ds_read_b128 v[44:47], v227 offset:27648
    s_waitcnt lgkmcnt(11)
    v_add_f32 v112, v112, v0
    v_add_f32 v113, v113, v1
    v_add_f32 v114, v114, v2
    v_add_f32 v115, v115, v3
    s_waitcnt lgkmcnt(10)
    v_add_f32 v116, v116, v4
    v_add_f32 v117, v117, v5
    v_add_f32 v118, v118, v6
    v_add_f32 v119, v119, v7
    s_waitcnt lgkmcnt(9)
    v_add_f32 v120, v120, v8
    v_add_f32 v121, v121, v9
    v_add_f32 v122, v122, v10
    v_add_f32 v123, v123, v11
    s_waitcnt lgkmcnt(8)
    v_add_f32 v124, v124, v12
    v_add_f32 v125, v125, v13
    v_add_f32 v126, v126, v14
    v_add_f32 v127, v127, v15
    s_waitcnt lgkmcnt(7)
    v_add_f32 v112, v112, v16
    v_add_f32 v113, v113, v17
    v_add_f32 v114, v114, v18
    v_add_f32 v115, v115, v19
    s_waitcnt lgkmcnt(6)
    v_add_f32 v116, v116, v20
    v_add_f32 v117, v117, v21
    v_add_f32 v118, v118, v22
    v_add_f32 v119, v119, v23
    s_waitcnt lgkmcnt(5)
    v_add_f32 v120, v120, v24
    v_add_f32 v121, v121, v25
    v_add_f32 v122, v122, v26
    v_add_f32 v123, v123, v27
    s_waitcnt lgkmcnt(4)
    v_add_f32 v124, v124, v28
    v_add_f32 v125, v125, v29
    v_add_f32 v126, v126, v30
    v_add_f32 v127, v127, v31
    s_waitcnt lgkmcnt(3)
    v_add_f32 v112, v112, v32
    v_add_f32 v113, v113, v33
    v_add_f32 v114, v114, v34
    v_add_f32 v115, v115, v35
    s_waitcnt lgkmcnt(2)
    v_add_f32 v116, v116, v36
    v_add_f32 v117, v117, v37
    v_add_f32 v118, v118, v38
    v_add_f32 v119, v119, v39
    s_waitcnt lgkmcnt(1)
    v_add_f32 v120, v120, v40
    v_add_f32 v121, v121, v41
    v_add_f32 v122, v122, v42
    v_add_f32 v123, v123, v43
    s_waitcnt lgkmcnt(0)
    v_add_f32 v124, v124, v44
    v_add_f32 v125, v125, v45
    v_add_f32 v126, v126, v46
    v_add_f32 v127, v127, v47
    v_cvt_pk_bf16_f32 v112, v112, v113
    v_cvt_pk_bf16_f32 v113, v114, v115
    v_cvt_pk_bf16_f32 v114, v116, v117
    v_cvt_pk_bf16_f32 v115, v118, v119
    v_cvt_pk_bf16_f32 v116, v120, v121
    v_cvt_pk_bf16_f32 v117, v122, v123
    v_cvt_pk_bf16_f32 v118, v124, v125
    v_cvt_pk_bf16_f32 v119, v126, v127
    buffer_store_dwordx4 v[112:115], v228, s[48:51], 0 offen offset:0
    buffer_store_dwordx4 v[116:119], v228, s[48:51], 0 offen offset:16
L_fin_h2:
    s_endpgm
L_h0:
    s_waitcnt lgkmcnt(5)
    v_mfma_f32_32x32x16_bf16 v[0:15], a[224:227], a[0:3], 0
    ds_read_b128 a[8:11], v233 offset:0
    ds_read_b64_tr_b16 a[236:237], v236 offset:3072
    ds_read_b64_tr_b16 a[238:239], v236 offset:3840
    s_add_u32 m0, s70, 0x3000
    s_add_u32 s75, s5, 0x7000
    buffer_load_dwordx4 v225, s[28:31], s75 offen lds
    s_waitcnt lgkmcnt(7)
    v_mfma_f32_32x32x16_bf16 v[16:31], a[224:227], a[4:7], 0
    s_mov_b64 exec, s[78:79]
    ds_read_b128 a[236:239], v255 offset:32
    s_mov_b64 exec, -1
    s_add_u32 m0, s70, 0x3400
    s_add_u32 s75, s5, 0x7000
    buffer_load_dwordx4 v226, s[28:31], s75 offen lds
    s_waitcnt lgkmcnt(6)
    v_mfma_f32_32x32x16_bf16 v[32:47], a[228:231], a[0:3], 0
    ds_read_b128 a[12:15], v233 offset:4096
    ds_read_b64_tr_b16 a[240:241], v236 offset:3136
    ds_read_b64_tr_b16 a[242:243], v236 offset:3904
    s_add_u32 m0, s73, 0x1000
    s_nop 0
    buffer_load_dwordx4 v231, s[28:31], s5 offen lds
    v_mfma_f32_32x32x16_bf16 v[48:63], a[228:231], a[4:7], 0
    ds_read_b64_tr_b16 a[244:245], v236 offset:3200
    ds_read_b64_tr_b16 a[246:247], v236 offset:3968
    ds_read_b128 a[248:251], v238 offset:0
    s_add_u32 m0, s70, 0x3800
    s_add_u32 s75, s5, 0xa800
    buffer_load_dwordx4 v225, s[28:31], s75 offen lds
    s_waitcnt lgkmcnt(10)
    v_mfma_f32_32x32x16_bf16 v[64:79], a[0:3], a[232:235], 0
    ds_read_b64_tr_b16 v[192:193], v237 offset:64
    ds_read_b64_tr_b16 v[194:195], v237 offset:832
    s_add_u32 m0, s70, 0x3c00
    s_add_u32 s75, s5, 0xa800
    buffer_load_dwordx4 v226, s[28:31], s75 offen lds
    v_mfma_f32_32x32x16_bf16 v[80:95], a[4:7], a[232:235], 0
    ds_read_b64_tr_b16 v[196:197], v237 offset:128
    ds_read_b64_tr_b16 v[198:199], v237 offset:896
    s_add_u32 m0, s71, 0x6200
    s_mul_i32 s75, s6, 0x540
    buffer_load_dwordx4 v227, s[32:35], s75 offen lds
    s_waitcnt lgkmcnt(10)
    v_mfma_f32_32x32x16_bf16 v[0:15], a[236:239], a[8:11], v[0:15]
    ds_read_b128 a[16:19], v234 offset:0
    ds_read_b64_tr_b16 a[224:225], v236 offset:6144
    s_add_u32 m0, s70, 0x4000
    s_nop 0
    buffer_load_dwordx4 v225, s[28:31], s6 offen lds
    s_mov_b32 s56, s16
    s_waitcnt lgkmcnt(11)
    v_mfma_f32_32x32x16_bf16 v[16:31], a[236:239], a[12:15], v[16:31]
    ds_read_b64_tr_b16 a[226:227], v236 offset:6912
    s_mov_b64 exec, s[78:79]
    ds_read_b128 a[224:227], v255 offset:64
    s_mov_b64 exec, -1
    s_add_u32 m0, s70, 0x4400
    s_nop 0
    buffer_load_dwordx4 v226, s[28:31], s6 offen lds
    s_waitcnt lgkmcnt(11)
    v_mfma_f32_32x32x16_bf16 v[32:47], a[240:243], a[8:11], v[32:47]
    ds_read_b128 a[20:23], v234 offset:4096
    ds_read_b64_tr_b16 a[228:229], v236 offset:6208
    s_add_u32 m0, s71, 0x6600
    s_mul_i32 s75, s6, 0x540
    buffer_load_dwordx4 v228, s[32:35], s75 offen lds
    v_mfma_f32_32x32x16_bf16 v[48:63], a[240:243], a[12:15], v[48:63]
    ds_read_b64_tr_b16 a[230:231], v236 offset:6976
    ds_read_b64_tr_b16 a[232:233], v236 offset:6272
    s_add_u32 m0, s70, 0x4800
    s_add_u32 s75, s6, 0x3800
    buffer_load_dwordx4 v225, s[28:31], s75 offen lds
    s_waitcnt lgkmcnt(13)
    v_mfma_f32_32x32x16_bf16 v[64:79], a[8:11], a[244:247], v[64:79]
    ds_read_b64_tr_b16 a[234:235], v236 offset:7040
    s_add_u32 m0, s70, 0x4c00
    s_add_u32 s75, s6, 0x3800
    buffer_load_dwordx4 v226, s[28:31], s75 offen lds
    s_mov_b32 s57, s17
    v_mfma_f32_32x32x16_bf16 v[80:95], a[12:15], a[244:247], v[80:95]
    s_add_u32 m0, s71, 0x6a00
    s_mul_i32 s75, s6, 0x540
    buffer_load_dwordx4 v229, s[32:35], s75 offen lds
    s_mov_b32 s58, 0x188000
    s_mov_b32 s59, 0x20000
    s_waitcnt lgkmcnt(5)
    v_mfma_f32_32x32x16_bf16 v[0:15], a[224:227], a[16:19], v[0:15]
    ds_read_b128 a[24:27], v235 offset:0
    ds_read_b64_tr_b16 a[236:237], v236 offset:9216
    ds_read_b64_tr_b16 a[238:239], v236 offset:9984
    s_add_u32 m0, s70, 0x5000
    s_add_u32 s75, s6, 0x7000
    buffer_load_dwordx4 v225, s[28:31], s75 offen lds
    s_waitcnt lgkmcnt(7)
    v_mfma_f32_32x32x16_bf16 v[16:31], a[224:227], a[20:23], v[16:31]
    s_mov_b64 exec, s[78:79]
    ds_read_b128 a[236:239], v255 offset:96
    s_mov_b64 exec, -1
    s_lshr_b32 s64, s2, 3
    s_and_b32 s65, s2, 7
    s_waitcnt lgkmcnt(6)
    v_mfma_f32_32x32x16_bf16 v[32:47], a[228:231], a[16:19], v[32:47]
    ds_read_b128 a[28:31], v235 offset:4096
    ds_read_b64_tr_b16 a[240:241], v236 offset:9280
    ds_read_b64_tr_b16 a[242:243], v236 offset:10048
    s_add_u32 m0, s70, 0x5400
    s_add_u32 s75, s6, 0x7000
    buffer_load_dwordx4 v226, s[28:31], s75 offen lds
    v_mfma_f32_32x32x16_bf16 v[48:63], a[228:231], a[20:23], v[48:63]
    ds_read_b64_tr_b16 a[244:245], v236 offset:9344
    ds_read_b64_tr_b16 a[246:247], v236 offset:10112
    s_lshl_b32 s76, s2, 2
    s_add_u32 s76, s76, s60
    s_mul_i32 s76, s76, 0x680
    v_min_u32 v217, 12, v247
    v_lshlrev_b32 v217, 7, v217
    buffer_load_dword v217, v217, s[56:59], s76 offen offset:0
    s_waitcnt lgkmcnt(9)
    v_mfma_f32_32x32x16_bf16 v[64:79], a[16:19], a[232:235], v[64:79]
    s_lshl_b32 s76, s2, 2
    s_add_u32 s76, s76, s60
    s_lshl_b32 s76, s76, 9
    v_min_u32 v215, 3, v247
    v_lshlrev_b32 v215, 7, v215
    buffer_load_dword v215, v215, s[40:43], s76 offen offset:0
    s_add_u32 m0, s73, 0x2000
    s_nop 0
    buffer_load_dwordx4 v231, s[28:31], s6 offen lds
    v_mfma_f32_32x32x16_bf16 v[80:95], a[20:23], a[232:235], v[80:95]
    s_add_u32 m0, s70, 0x5800
    s_add_u32 s75, s6, 0xa800
    buffer_load_dwordx4 v225, s[28:31], s75 offen lds
    s_lshl_b32 s65, s65, 2
    s_add_u32 s64, s64, s65
    v_mfma_f32_32x32x16_bf16 v[96:111], v[192:195], a[248:251], 0
    s_and_b32 s64, s64, 31
    s_lshl_b32 s64, s64, 2
    s_add_u32 s64, s64, s60
    v_min_u32 v206, 24, v247
    v_lshlrev_b32 v206, 7, v206
    v_mfma_f32_32x32x16_bf16 v[112:127], a[248:251], v[196:199], 0
    s_add_u32 m0, s70, 0x5c00
    s_add_u32 s75, s6, 0xa800
    buffer_load_dwordx4 v226, s[28:31], s75 offen lds
    s_mul_i32 s65, s64, 0x3100
    v_add_u32 v213, s65, v206
    s_waitcnt lgkmcnt(5)
    v_mfma_f32_32x32x16_bf16 v[0:15], a[236:239], a[24:27], v[0:15]
    s_mul_i32 s65, s64, 0xc80
    v_add_u32 v214, s65, v206
    s_and_b32 s64, s60, 1
    s_lshl_b32 s64, s64, 5
    s_and_b32 s65, s60, 2
    s_waitcnt lgkmcnt(4)
    v_mfma_f32_32x32x16_bf16 v[16:31], a[236:239], a[28:31], v[16:31]
    s_waitcnt lgkmcnt(0)
    s_waitcnt vmcnt(14)
    s_barrier
    v_add_u32 v255, s5, v243
    ds_read_b128 a[32:35], v232 offset:8192
    ds_read_b64_tr_b16 a[224:225], v236 offset:12544
    s_add_u32 m0, s71, 0
    s_mul_i32 s75, s7, 0x540
    buffer_load_dwordx4 v227, s[32:35], s75 offen lds
    v_mfma_f32_32x32x16_bf16 v[32:47], a[240:243], a[24:27], v[32:47]
    ds_read_b64_tr_b16 a[226:227], v236 offset:13312
    s_mov_b64 exec, s[78:79]
    ds_read_b128 a[224:227], v255 offset:0
    s_mov_b64 exec, -1
    v_lshrrev_b32 v205, 2, v247
    v_mfma_f32_32x32x16_bf16 v[48:63], a[240:243], a[28:31], v[48:63]
    ds_read_b128 a[36:39], v232 offset:12288
    ds_read_b64_tr_b16 a[228:229], v236 offset:12608
    s_add_u32 m0, s70, 0
    s_nop 0
    buffer_load_dwordx4 v225, s[28:31], s7 offen lds
    v_add_u32 v205, s64, v205
    v_mfma_f32_32x32x16_bf16 v[64:79], a[24:27], a[244:247], v[64:79]
    ds_read_b64_tr_b16 a[230:231], v236 offset:13376
    ds_read_b64_tr_b16 a[232:233], v236 offset:12672
    v_mul_u32_u24 v205, 0xe00, v205
    v_and_b32 v206, 3, v247
    v_xor_b32 v206, s65, v206
    v_mfma_f32_32x32x16_bf16 v[80:95], a[28:31], a[244:247], v[80:95]
    ds_read_b64_tr_b16 a[234:235], v236 offset:13440
    s_add_u32 m0, s70, 0x400
    s_nop 0
    buffer_load_dwordx4 v226, s[28:31], s7 offen lds
    v_lshl_add_u32 v205, v206, 4, v205
    v_add_u32 v230, s68, v205
    s_waitcnt lgkmcnt(5)
    v_mfma_f32_32x32x16_bf16 v[0:15], a[224:227], a[32:35], v[0:15]
    ds_read_b128 a[40:43], v233 offset:8192
    ds_read_b64_tr_b16 a[236:237], v236 offset:15616
    ds_read_b64_tr_b16 a[238:239], v236 offset:16384
    s_lshl_b32 s72, s60, 11
    s_sub_u32 s27, s77, s63
    s_waitcnt lgkmcnt(7)
    v_mfma_f32_32x32x16_bf16 v[16:31], a[224:227], a[36:39], v[16:31]
    s_mov_b64 exec, s[78:79]
    ds_read_b128 a[236:239], v255 offset:32
    s_mov_b64 exec, -1
    s_add_u32 m0, s71, 0x400
    s_mul_i32 s75, s7, 0x540
    buffer_load_dwordx4 v228, s[32:35], s75 offen lds
    s_waitcnt lgkmcnt(6)
    v_mfma_f32_32x32x16_bf16 v[32:47], a[228:231], a[32:35], v[32:47]
    ds_read_b128 a[44:47], v233 offset:12288
    ds_read_b64_tr_b16 a[240:241], v236 offset:15680
    ds_read_b64_tr_b16 a[242:243], v236 offset:16448
    s_lshl_b32 s27, s27, 12
    s_add_u32 s27, s27, 0xc000
    v_mfma_f32_32x32x16_bf16 v[48:63], a[228:231], a[36:39], v[48:63]
    ds_read_b64_tr_b16 a[244:245], v236 offset:15744
    ds_read_b64_tr_b16 a[246:247], v236 offset:16512
    ds_read_b128 a[248:251], v238 offset:4096
    s_add_u32 m0, s70, 0x800
    s_add_u32 s75, s7, 0x3800
    buffer_load_dwordx4 v225, s[28:31], s75 offen lds
    s_waitcnt lgkmcnt(10)
    v_mfma_f32_32x32x16_bf16 v[64:79], a[32:35], a[232:235], v[64:79]
    ds_read_b64_tr_b16 v[192:193], v237 offset:12608
    ds_read_b64_tr_b16 v[194:195], v237 offset:13376
    s_lshl_b32 s64, s61, 2
    s_add_u32 s64, s64, s60
    s_mul_i32 s64, s64, 0x90
    v_mfma_f32_32x32x16_bf16 v[80:95], a[36:39], a[232:235], v[80:95]
    ds_read_b64_tr_b16 v[196:197], v237 offset:12672
    ds_read_b64_tr_b16 v[198:199], v237 offset:13440
    s_add_u32 m0, s70, 0xc00
    s_add_u32 s75, s7, 0x3800
    buffer_load_dwordx4 v226, s[28:31], s75 offen lds
    s_waitcnt lgkmcnt(10)
    v_mfma_f32_32x32x16_bf16 v[0:15], a[236:239], a[40:43], v[0:15]
    ds_read_b128 a[48:51], v234 offset:8192
    ds_read_b64_tr_b16 a[224:225], v236 offset:18688
    s_mul_i32 s65, s62, 36
    s_add_u32 s64, s64, s65
    s_lshl_b32 s65, s63, 1
    s_waitcnt lgkmcnt(11)
    v_mfma_f32_32x32x16_bf16 v[16:31], a[236:239], a[44:47], v[16:31]
    ds_read_b64_tr_b16 a[226:227], v236 offset:19456
    s_mov_b64 exec, s[78:79]
    ds_read_b128 a[224:227], v255 offset:64
    s_mov_b64 exec, -1
    s_add_u32 m0, s71, 0x800
    s_mul_i32 s75, s7, 0x540
    buffer_load_dwordx4 v229, s[32:35], s75 offen lds
    s_waitcnt lgkmcnt(11)
    v_mfma_f32_32x32x16_bf16 v[32:47], a[240:243], a[40:43], v[32:47]
    ds_read_b128 a[52:55], v234 offset:12288
    ds_read_b64_tr_b16 a[228:229], v236 offset:18752
    s_add_u32 s64, s64, 8
    s_add_u32 s64, s64, s65
    s_lshl_b32 s64, s64, 11
    v_mfma_f32_32x32x16_bf16 v[48:63], a[240:243], a[44:47], v[48:63]
    ds_read_b64_tr_b16 a[230:231], v236 offset:19520
    ds_read_b64_tr_b16 a[232:233], v236 offset:18816
    s_add_u32 m0, s70, 0x1000
    s_add_u32 s75, s7, 0x7000
    buffer_load_dwordx4 v225, s[28:31], s75 offen lds
    s_waitcnt lgkmcnt(13)
    v_mfma_f32_32x32x16_bf16 v[64:79], a[40:43], a[244:247], v[64:79]
    ds_read_b64_tr_b16 a[234:235], v236 offset:19584
    v_add_u32 v246, s64, v224
    s_lshl_b32 s64, s61, 2
    s_add_u32 s64, s64, s60
    s_lshl_b32 s64, s64, 2
    v_mfma_f32_32x32x16_bf16 v[80:95], a[44:47], a[244:247], v[80:95]
    s_add_u32 m0, s70, 0x1400
    s_add_u32 s75, s7, 0x7000
    buffer_load_dwordx4 v226, s[28:31], s75 offen lds
    s_add_u32 s64, s64, s62
    s_lshl_b32 s64, s64, 4
    s_waitcnt lgkmcnt(5)
    v_mfma_f32_32x32x16_bf16 v[0:15], a[224:227], a[48:51], v[0:15]
    ds_read_b128 a[56:59], v235 offset:8192
    ds_read_b64_tr_b16 a[236:237], v236 offset:21760
    s_add_u32 s64, s64, s63
    s_lshl_b32 s64, s64, 3
    s_add_u32 s64, s64, 0xd00000
    s_waitcnt lgkmcnt(6)
    v_mfma_f32_32x32x16_bf16 v[16:31], a[224:227], a[52:55], v[16:31]
    ds_read_b64_tr_b16 a[238:239], v236 offset:22528
    s_mov_b64 exec, s[78:79]
    ds_read_b128 a[236:239], v255 offset:96
    s_mov_b64 exec, -1
    s_add_u32 m0, s73, 0
    s_nop 0
    buffer_load_dwordx4 v231, s[28:31], s7 offen lds
    s_waitcnt lgkmcnt(6)
    v_mfma_f32_32x32x16_bf16 v[32:47], a[228:231], a[48:51], v[32:47]
    ds_read_b128 a[60:63], v235 offset:12288
    ds_read_b64_tr_b16 a[240:241], v236 offset:21824
    v_and_b32 v205, 1, v247
    v_lshlrev_b32 v205, 6, v205
    v_add_u32 v244, s64, v205
    v_mfma_f32_32x32x16_bf16 v[48:63], a[228:231], a[52:55], v[48:63]
    ds_read_b64_tr_b16 a[242:243], v236 offset:22592
    ds_read_b64_tr_b16 a[244:245], v236 offset:21888
    s_mov_b32 s64, 0x19660d
    v_mul_lo_u32 v220, v220, s64
    v_add_u32 v220, 0x3c6ef35f, v220
    s_waitcnt lgkmcnt(8)
    v_mfma_f32_32x32x16_bf16 v[64:79], a[48:51], a[232:235], v[64:79]
    ds_read_b64_tr_b16 a[246:247], v236 offset:22656
    s_add_u32 m0, s70, 0x1800
    s_add_u32 s75, s7, 0xa800
    buffer_load_dwordx4 v225, s[28:31], s75 offen lds
    v_mfma_f32_32x32x16_bf16 v[80:95], a[52:55], a[232:235], v[80:95]
    s_mov_b32 s64, 0x15a4e35
    v_mul_lo_u32 v221, v221, s64
    v_add_u32 v221, 1, v221
    v_mfma_f32_32x32x16_bf16 v[96:111], v[192:195], a[248:251], v[96:111]
    s_add_u32 m0, s70, 0x1c00
    s_add_u32 s75, s7, 0xa800
    buffer_load_dwordx4 v226, s[28:31], s75 offen lds
    v_mfma_f32_32x32x16_bf16 v[112:127], a[248:251], v[196:199], v[112:127]
    s_cmp_gt_u32 s63, 3
    s_cselect_b32 s64, 1, 0
    s_sub_u32 s85, s63, s64
    v_bfe_u32 v205, v247, 4, 1
    v_lshlrev_b32 v205, 2, v205
    s_waitcnt lgkmcnt(5)
    v_mfma_f32_32x32x16_bf16 v[0:15], a[236:239], a[56:59], v[0:15]
    v_xor_b32 v205, v205, v201
    v_mul_u32_u24 v206, 0x380, v200
    v_lshl_add_u32 v206, v205, 4, v206
    s_lshl_b32 s64, s85, 7
    s_mul_i32 s65, s60, 0x18800
    s_waitcnt lgkmcnt(4)
    v_mfma_f32_32x32x16_bf16 v[16:31], a[236:239], a[60:63], v[16:31]
    s_waitcnt lgkmcnt(0)
    s_waitcnt vmcnt(12)
    s_barrier
    v_add_u32 v255, s6, v243
    ds_read_b128 a[64:67], v232 offset:16384
    ds_read_b64_tr_b16 a[224:225], v236 offset:25088
    s_add_u32 m0, s71, 0x3100
    s_mul_i32 s75, s8, 0x540
    buffer_load_dwordx4 v227, s[32:35], s75 offen lds
    v_mfma_f32_32x32x16_bf16 v[32:47], a[240:243], a[56:59], v[32:47]
    ds_read_b64_tr_b16 a[226:227], v236 offset:25856
    s_mov_b64 exec, s[78:79]
    ds_read_b128 a[224:227], v255 offset:0
    s_mov_b64 exec, -1
    s_add_u32 s65, s65, s64
    v_mfma_f32_32x32x16_bf16 v[48:63], a[240:243], a[60:63], v[48:63]
    ds_read_b128 a[68:71], v232 offset:20480
    ds_read_b64_tr_b16 a[228:229], v236 offset:25152
    s_add_u32 m0, s70, 0x2000
    s_nop 0
    buffer_load_dwordx4 v225, s[28:31], s8 offen lds
    v_add_u32 v245, s65, v206
    v_mfma_f32_32x32x16_bf16 v[64:79], a[56:59], a[244:247], v[64:79]
    ds_read_b64_tr_b16 a[230:231], v236 offset:25920
    ds_read_b64_tr_b16 a[232:233], v236 offset:25216
    s_mul_i32 s65, s60, 0x62000
    s_add_u32 s65, s65, s64
    v_add_u32 v223, s65, v206
    v_mfma_f32_32x32x16_bf16 v[80:95], a[60:63], a[244:247], v[80:95]
    ds_read_b64_tr_b16 a[234:235], v236 offset:25984
    s_add_u32 m0, s70, 0x2400
    s_nop 0
    buffer_load_dwordx4 v226, s[28:31], s8 offen lds
    s_lshl_b32 s64, s61, 2
    s_add_u32 s64, s64, s62
    s_waitcnt lgkmcnt(5)
    v_mfma_f32_32x32x16_bf16 v[0:15], a[224:227], a[64:67], v[0:15]
    ds_read_b128 a[72:75], v233 offset:16384
    ds_read_b64_tr_b16 a[236:237], v236 offset:28160
    ds_read_b64_tr_b16 a[238:239], v236 offset:28928
    s_lshl_b32 s64, s64, 2
    s_add_u32 s64, s64, s60
    s_waitcnt lgkmcnt(7)
    v_mfma_f32_32x32x16_bf16 v[16:31], a[224:227], a[68:71], v[16:31]
    s_mov_b64 exec, s[78:79]
    ds_read_b128 a[236:239], v255 offset:32
    s_mov_b64 exec, -1
    s_add_u32 m0, s71, 0x3500
    s_mul_i32 s75, s8, 0x540
    buffer_load_dwordx4 v228, s[32:35], s75 offen lds
    s_waitcnt lgkmcnt(6)
    v_mfma_f32_32x32x16_bf16 v[32:47], a[228:231], a[64:67], v[32:47]
    ds_read_b128 a[76:79], v233 offset:20480
    ds_read_b64_tr_b16 a[240:241], v236 offset:28224
    ds_read_b64_tr_b16 a[242:243], v236 offset:28992
    s_lshl_b32 s64, s64, 7
    s_add_u32 s64, s64, 0xd00000
    v_mfma_f32_32x32x16_bf16 v[48:63], a[228:231], a[68:71], v[48:63]
    ds_read_b64_tr_b16 a[244:245], v236 offset:28288
    ds_read_b64_tr_b16 a[246:247], v236 offset:29056
    ds_read_b128 a[248:251], v238 offset:8192
    s_add_u32 m0, s70, 0x2800
    s_add_u32 s75, s8, 0x3800
    buffer_load_dwordx4 v225, s[28:31], s75 offen lds
    s_waitcnt lgkmcnt(10)
    v_mfma_f32_32x32x16_bf16 v[64:79], a[64:67], a[232:235], v[64:79]
    ds_read_b64_tr_b16 v[192:193], v237 offset:25152
    ds_read_b64_tr_b16 v[194:195], v237 offset:25920
    v_and_b32 v205, 15, v247
    v_lshlrev_b32 v205, 3, v205
    v_add_u32 v216, s64, v205
    v_mfma_f32_32x32x16_bf16 v[80:95], a[68:71], a[232:235], v[80:95]
    ds_read_b64_tr_b16 v[196:197], v237 offset:25216
    ds_read_b64_tr_b16 v[198:199], v237 offset:25984
    s_add_u32 m0, s70, 0x2c00
    s_add_u32 s75, s8, 0x3800
    buffer_load_dwordx4 v226, s[28:31], s75 offen lds
    s_waitcnt lgkmcnt(10)
    v_mfma_f32_32x32x16_bf16 v[0:15], a[236:239], a[72:75], v[0:15]
    ds_read_b128 a[80:83], v234 offset:16384
    ds_read_b64_tr_b16 a[224:225], v236 offset:31232
    s_lshl_b32 s64, s61, 2
    s_add_u32 s64, s64, s62
    s_mul_i32 s64, s64, 0x90
    s_waitcnt lgkmcnt(11)
    v_mfma_f32_32x32x16_bf16 v[16:31], a[236:239], a[76:79], v[16:31]
    ds_read_b64_tr_b16 a[226:227], v236 offset:32000
    s_mov_b64 exec, s[78:79]
    ds_read_b128 a[224:227], v255 offset:64
    s_mov_b64 exec, -1
    s_add_u32 m0, s71, 0x3900
    s_mul_i32 s75, s8, 0x540
    buffer_load_dwordx4 v229, s[32:35], s75 offen lds
    s_waitcnt lgkmcnt(11)
    v_mfma_f32_32x32x16_bf16 v[32:47], a[240:243], a[72:75], v[32:47]
    ds_read_b128 a[84:87], v234 offset:20480
    ds_read_b64_tr_b16 a[228:229], v236 offset:31296
    s_mul_i32 s65, s60, 36
    s_add_u32 s64, s64, s65
    s_lshl_b32 s64, s64, 11
    v_mfma_f32_32x32x16_bf16 v[48:63], a[240:243], a[76:79], v[48:63]
    ds_read_b64_tr_b16 a[230:231], v236 offset:32064
    ds_read_b64_tr_b16 a[232:233], v236 offset:31360
    s_add_u32 m0, s70, 0x3000
    s_add_u32 s75, s8, 0x7000
    buffer_load_dwordx4 v225, s[28:31], s75 offen lds
    s_waitcnt lgkmcnt(13)
    v_mfma_f32_32x32x16_bf16 v[64:79], a[72:75], a[244:247], v[64:79]
    ds_read_b64_tr_b16 a[234:235], v236 offset:32128
    s_mul_i32 s65, s85, 37
    v_min_u32 v205, 36, v247
    v_add_u32 v205, s65, v205
    v_min_u32 v205, 0xff, v205
    v_mfma_f32_32x32x16_bf16 v[80:95], a[76:79], a[244:247], v[80:95]
    s_add_u32 m0, s70, 0x3400
    s_add_u32 s75, s8, 0x7000
    buffer_load_dwordx4 v226, s[28:31], s75 offen lds
    v_lshlrev_b32 v205, 7, v205
    v_add_u32 v215, s64, v205
    s_waitcnt lgkmcnt(5)
    v_mfma_f32_32x32x16_bf16 v[0:15], a[224:227], a[80:83], v[0:15]
    ds_read_b128 a[88:91], v235 offset:16384
    ds_read_b64_tr_b16 a[236:237], v236 offset:34304
    s_mul_i32 s26, s60, 0xe00
    s_add_u32 s26, s26, 0x24800
    s_mul_i32 s3, s60, 0x3000
    s_waitcnt lgkmcnt(6)
    v_mfma_f32_32x32x16_bf16 v[16:31], a[224:227], a[84:87], v[16:31]
    ds_read_b64_tr_b16 a[238:239], v236 offset:35072
    s_mov_b64 exec, s[78:79]
    ds_read_b128 a[236:239], v255 offset:96
    s_mov_b64 exec, -1
    s_add_u32 m0, s73, 0x1000
    s_nop 0
    buffer_load_dwordx4 v231, s[28:31], s8 offen lds
    s_waitcnt lgkmcnt(6)
    v_mfma_f32_32x32x16_bf16 v[32:47], a[228:231], a[80:83], v[32:47]
    ds_read_b128 a[92:95], v235 offset:20480
    ds_read_b64_tr_b16 a[240:241], v236 offset:34368
    s_add_u32 s3, s3, 0x18000
    s_mov_b32 s48, s20
    s_mov_b32 s49, s21
    v_mfma_f32_32x32x16_bf16 v[48:63], a[228:231], a[84:87], v[48:63]
    ds_read_b64_tr_b16 a[242:243], v236 offset:35136
    ds_read_b64_tr_b16 a[244:245], v236 offset:34432
    s_mov_b32 s50, 0x1c0000
    s_mov_b32 s51, 0x20000
    v_mov_b32 v248, 0xf149f2ca
    s_waitcnt lgkmcnt(8)
    v_mfma_f32_32x32x16_bf16 v[64:79], a[80:83], a[232:235], v[64:79]
    ds_read_b64_tr_b16 a[246:247], v236 offset:35200
    s_add_u32 m0, s70, 0x3800
    s_add_u32 s75, s8, 0xa800
    buffer_load_dwordx4 v225, s[28:31], s75 offen lds
    s_mov_b32 s83, 0x3e8b97f6
    v_mfma_f32_32x32x16_bf16 v[80:95], a[84:87], a[232:235], v[80:95]
    s_mov_b32 s80, -1
    s_mov_b32 s81, 0
    s_or_b32 s64, s61, s60
    v_mfma_f32_32x32x16_bf16 v[96:111], v[192:195], a[248:251], v[96:111]
    s_add_u32 m0, s70, 0x3c00
    s_add_u32 s75, s8, 0xa800
    buffer_load_dwordx4 v226, s[28:31], s75 offen lds
    v_mfma_f32_32x32x16_bf16 v[112:127], a[248:251], v[196:199], v[112:127]
    s_cmp_eq_u32 s64, 0
    s_cselect_b32 s0, 0, -1
    s_cselect_b32 s1, 0, -1
    s_mul_i32 s64, s60, 0x1800
    s_add_u32 s64, s64, 0x18000
    s_waitcnt lgkmcnt(5)
    v_mfma_f32_32x32x16_bf16 v[0:15], a[236:239], a[88:91], v[0:15]
    v_add_u32 v249, s64, v224
    s_lshl_b32 s64, s60, 10
    s_add_u32 s64, s64, 0x18000
    v_add_u32 v250, s64, v224
    s_lshr_b32 s64, s60, 1
    s_waitcnt lgkmcnt(4)
    v_mfma_f32_32x32x16_bf16 v[16:31], a[236:239], a[92:95], v[16:31]
    s_waitcnt lgkmcnt(0)
    s_waitcnt vmcnt(12)
    s_barrier
    v_add_u32 v255, s7, v243
    ds_read_b128 a[96:99], v232 offset:0
    ds_read_b64_tr_b16 a[224:225], v236 offset:0
    s_add_u32 m0, s71, 0x6200
    s_mul_i32 s75, s9, 0x540
    buffer_load_dwordx4 v227, s[32:35], s75 offen lds
    v_mfma_f32_32x32x16_bf16 v[32:47], a[240:243], a[88:91], v[32:47]
    ds_read_b64_tr_b16 a[226:227], v236 offset:768
    s_mov_b64 exec, s[78:79]
    ds_read_b128 a[224:227], v255 offset:0
    s_mov_b64 exec, -1
    s_lshl_b32 s64, s64, 10
    v_mfma_f32_32x32x16_bf16 v[48:63], a[240:243], a[92:95], v[48:63]
    ds_read_b128 a[100:103], v232 offset:4096
    ds_read_b64_tr_b16 a[228:229], v236 offset:64
    s_add_u32 m0, s70, 0x4000
    s_nop 0
    buffer_load_dwordx4 v225, s[28:31], s9 offen lds
    s_and_b32 s65, s60, 1
    v_mfma_f32_32x32x16_bf16 v[64:79], a[88:91], a[244:247], v[64:79]
    ds_read_b64_tr_b16 a[230:231], v236 offset:832
    ds_read_b64_tr_b16 a[232:233], v236 offset:128
    s_lshl_b32 s65, s65, 3
    s_add_u32 s64, s64, s65
    s_add_u32 s65, s64, 0x19000
    v_mfma_f32_32x32x16_bf16 v[80:95], a[92:95], a[244:247], v[80:95]
    ds_read_b64_tr_b16 a[234:235], v236 offset:896
    s_add_u32 m0, s70, 0x4400
    s_nop 0
    buffer_load_dwordx4 v226, s[28:31], s9 offen lds
    v_add_u32 v251, s65, v224
    s_add_u32 s65, s64, 0x1e000
    s_waitcnt lgkmcnt(5)
    v_mfma_f32_32x32x16_bf16 v[0:15], a[224:227], a[96:99], v[0:15]
    ds_read_b128 a[104:107], v233 offset:0
    ds_read_b64_tr_b16 a[236:237], v236 offset:3072
    ds_read_b64_tr_b16 a[238:239], v236 offset:3840
    v_add_u32 v252, s65, v224
    s_lshl_b32 s65, s60, 2
    s_waitcnt lgkmcnt(7)
    v_mfma_f32_32x32x16_bf16 v[16:31], a[224:227], a[100:103], v[16:31]
    s_mov_b64 exec, s[78:79]
    ds_read_b128 a[236:239], v255 offset:32
    s_mov_b64 exec, -1
    s_add_u32 m0, s71, 0x6600
    s_mul_i32 s75, s9, 0x540
    buffer_load_dwordx4 v228, s[32:35], s75 offen lds
    s_waitcnt lgkmcnt(6)
    v_mfma_f32_32x32x16_bf16 v[32:47], a[228:231], a[96:99], v[32:47]
    ds_read_b128 a[108:111], v233 offset:4096
    ds_read_b64_tr_b16 a[240:241], v236 offset:3136
    ds_read_b64_tr_b16 a[242:243], v236 offset:3904
    s_add_u32 s65, s65, 0x1e800
    v_add_u32 v253, s65, v224
    v_mfma_f32_32x32x16_bf16 v[48:63], a[228:231], a[100:103], v[48:63]
    ds_read_b64_tr_b16 a[244:245], v236 offset:3200
    ds_read_b64_tr_b16 a[246:247], v236 offset:3968
    ds_read_b128 a[248:251], v238 offset:0
    s_add_u32 m0, s70, 0x4800
    s_add_u32 s75, s9, 0x3800
    buffer_load_dwordx4 v225, s[28:31], s75 offen lds
    s_waitcnt lgkmcnt(10)
    v_mfma_f32_32x32x16_bf16 v[64:79], a[96:99], a[232:235], v[64:79]
    ds_read_b64_tr_b16 v[192:193], v237 offset:64
    ds_read_b64_tr_b16 v[194:195], v237 offset:832
    s_mul_i32 s65, s60, 0xc00
    s_add_u32 s65, s65, 0x1e000
    v_add_u32 v254, s65, v224
    v_mfma_f32_32x32x16_bf16 v[80:95], a[100:103], a[232:235], v[80:95]
    ds_read_b64_tr_b16 v[196:197], v237 offset:128
    ds_read_b64_tr_b16 v[198:199], v237 offset:896
    s_add_u32 m0, s70, 0x4c00
    s_add_u32 s75, s9, 0x3800
    buffer_load_dwordx4 v226, s[28:31], s75 offen lds
    s_waitcnt lgkmcnt(10)
    v_mfma_f32_32x32x16_bf16 v[0:15], a[236:239], a[104:107], v[0:15]
    ds_read_b128 a[112:115], v234 offset:0
    ds_read_b64_tr_b16 a[224:225], v236 offset:6144
    s_mov_b32 vcc_lo, 0xffffaaaa
    s_mov_b32 vcc_hi, 0xfffaaaaf
    v_cndmask_b32 v128, 0, v248, vcc
    s_waitcnt lgkmcnt(11)
    v_mfma_f32_32x32x16_bf16 v[16:31], a[236:239], a[108:111], v[16:31]
    ds_read_b64_tr_b16 a[226:227], v236 offset:6912
    s_mov_b64 exec, s[78:79]
    ds_read_b128 a[224:227], v255 offset:64
    s_mov_b64 exec, -1
    s_add_u32 m0, s71, 0x6a00
    s_mul_i32 s75, s9, 0x540
    buffer_load_dwordx4 v229, s[32:35], s75 offen lds
    s_waitcnt lgkmcnt(11)
    v_mfma_f32_32x32x16_bf16 v[32:47], a[240:243], a[104:107], v[32:47]
    ds_read_b128 a[116:119], v234 offset:4096
    ds_read_b64_tr_b16 a[228:229], v236 offset:6208
    s_mov_b32 vcc_lo, 0xffff5555
    s_mov_b32 vcc_hi, 0xfff5555f
    v_cndmask_b32 v129, 0, v248, vcc
    v_mfma_f32_32x32x16_bf16 v[48:63], a[240:243], a[108:111], v[48:63]
    ds_read_b64_tr_b16 a[230:231], v236 offset:6976
    ds_read_b64_tr_b16 a[232:233], v236 offset:6272
    s_add_u32 m0, s70, 0x5000
    s_add_u32 s75, s9, 0x7000
    buffer_load_dwordx4 v225, s[28:31], s75 offen lds
    s_waitcnt lgkmcnt(13)
    v_mfma_f32_32x32x16_bf16 v[64:79], a[104:107], a[244:247], v[64:79]
    ds_read_b64_tr_b16 a[234:235], v236 offset:7040
    s_mov_b32 vcc_lo, 0xfffeaaab
    s_mov_b32 vcc_hi, 0xffeaaabf
    v_cndmask_b32 v130, 0, v248, vcc
    v_mfma_f32_32x32x16_bf16 v[80:95], a[108:111], a[244:247], v[80:95]
    s_add_u32 m0, s70, 0x5400
    s_add_u32 s75, s9, 0x7000
    buffer_load_dwordx4 v226, s[28:31], s75 offen lds
    s_waitcnt lgkmcnt(5)
    v_mfma_f32_32x32x16_bf16 v[0:15], a[224:227], a[112:115], v[0:15]
    ds_read_b128 a[120:123], v235 offset:0
    ds_read_b64_tr_b16 a[236:237], v236 offset:9216
    s_mov_b32 vcc_lo, 0xfffd5557
    s_mov_b32 vcc_hi, 0xffd5557f
    v_cndmask_b32 v131, 0, v248, vcc
    s_waitcnt lgkmcnt(6)
    v_mfma_f32_32x32x16_bf16 v[16:31], a[224:227], a[116:119], v[16:31]
    ds_read_b64_tr_b16 a[238:239], v236 offset:9984
    s_mov_b64 exec, s[78:79]
    ds_read_b128 a[236:239], v255 offset:96
    s_mov_b64 exec, -1
    s_add_u32 m0, s73, 0x2000
    s_nop 0
    buffer_load_dwordx4 v231, s[28:31], s9 offen lds
    s_waitcnt lgkmcnt(6)
    v_mfma_f32_32x32x16_bf16 v[32:47], a[228:231], a[112:115], v[32:47]
    ds_read_b128 a[124:127], v235 offset:4096
    ds_read_b64_tr_b16 a[240:241], v236 offset:9280
    s_mov_b32 vcc_lo, 0xffaaaaff
    s_mov_b32 vcc_hi, 0xfaaaafff
    v_cndmask_b32 v132, 0, v248, vcc
    v_mfma_f32_32x32x16_bf16 v[48:63], a[228:231], a[116:119], v[48:63]
    ds_read_b64_tr_b16 a[242:243], v236 offset:10048
    ds_read_b64_tr_b16 a[244:245], v236 offset:9344
    s_mov_b32 vcc_lo, 0xff5555ff
    s_mov_b32 vcc_hi, 0xf5555fff
    v_cndmask_b32 v133, 0, v248, vcc
    s_waitcnt lgkmcnt(8)
    v_mfma_f32_32x32x16_bf16 v[64:79], a[112:115], a[232:235], v[64:79]
    ds_read_b64_tr_b16 a[246:247], v236 offset:10112
    s_add_u32 m0, s70, 0x5800
    s_add_u32 s75, s9, 0xa800
    buffer_load_dwordx4 v225, s[28:31], s75 offen lds
    v_mfma_f32_32x32x16_bf16 v[80:95], a[116:119], a[232:235], v[80:95]
    s_mov_b32 vcc_lo, 0xfeaaabff
    s_mov_b32 vcc_hi, 0xeaaabfff
    v_cndmask_b32 v134, 0, v248, vcc
    v_mfma_f32_32x32x16_bf16 v[96:111], v[192:195], a[248:251], v[96:111]
    s_add_u32 m0, s70, 0x5c00
    s_add_u32 s75, s9, 0xa800
    buffer_load_dwordx4 v226, s[28:31], s75 offen lds
    v_mfma_f32_32x32x16_bf16 v[112:127], a[248:251], v[196:199], v[112:127]
    s_mov_b32 vcc_lo, 0xfd5557ff
    s_mov_b32 vcc_hi, 0xd5557fff
    v_cndmask_b32 v135, 0, v248, vcc
    s_waitcnt lgkmcnt(5)
    v_mfma_f32_32x32x16_bf16 v[0:15], a[236:239], a[120:123], v[0:15]
    s_mov_b32 vcc_lo, 0xaaaaffff
    s_mov_b32 vcc_hi, 0xaaafffff
    v_cndmask_b32 v136, 0, v248, vcc
    s_waitcnt lgkmcnt(4)
    v_mfma_f32_32x32x16_bf16 v[16:31], a[236:239], a[124:127], v[16:31]
    s_waitcnt lgkmcnt(0)
    s_waitcnt vmcnt(12)
    s_barrier
    v_add_u32 v255, s8, v243
    ds_read_b128 a[128:131], v232 offset:8192
    ds_read_b64_tr_b16 a[224:225], v236 offset:12544
    s_add_u32 m0, s71, 0
    s_mul_i32 s75, s10, 0x540
    buffer_load_dwordx4 v227, s[32:35], s75 offen lds
    v_mfma_f32_32x32x16_bf16 v[32:47], a[240:243], a[120:123], v[32:47]
    ds_read_b64_tr_b16 a[226:227], v236 offset:13312
    s_mov_b64 exec, s[78:79]
    ds_read_b128 a[224:227], v255 offset:0
    s_mov_b64 exec, -1
    v_mfma_f32_32x32x16_bf16 v[48:63], a[240:243], a[124:127], v[48:63]
    ds_read_b128 a[132:135], v232 offset:12288
    ds_read_b64_tr_b16 a[228:229], v236 offset:12608
    s_add_u32 m0, s70, 0
    s_nop 0
    buffer_load_dwordx4 v225, s[28:31], s10 offen lds
    v_mfma_f32_32x32x16_bf16 v[64:79], a[120:123], a[244:247], v[64:79]
    ds_read_b64_tr_b16 a[230:231], v236 offset:13376
    ds_read_b64_tr_b16 a[232:233], v236 offset:12672
    s_mov_b32 vcc_lo, 0x5555ffff
    s_mov_b32 vcc_hi, 0x555fffff
    v_cndmask_b32 v137, 0, v248, vcc
    v_mfma_f32_32x32x16_bf16 v[80:95], a[124:127], a[244:247], v[80:95]
    ds_read_b64_tr_b16 a[234:235], v236 offset:13440
    s_add_u32 m0, s70, 0x400
    s_nop 0
    buffer_load_dwordx4 v226, s[28:31], s10 offen lds
    s_waitcnt lgkmcnt(5)
    v_mfma_f32_32x32x16_bf16 v[0:15], a[224:227], a[128:131], v[0:15]
    ds_read_b128 a[136:139], v233 offset:8192
    ds_read_b64_tr_b16 a[236:237], v236 offset:15616
    ds_read_b64_tr_b16 a[238:239], v236 offset:16384
    s_waitcnt lgkmcnt(7)
    v_mfma_f32_32x32x16_bf16 v[16:31], a[224:227], a[132:135], v[16:31]
    s_mov_b64 exec, s[78:79]
    ds_read_b128 a[236:239], v255 offset:32
    s_mov_b64 exec, -1
    s_add_u32 m0, s71, 0x400
    s_mul_i32 s75, s10, 0x540
    buffer_load_dwordx4 v228, s[32:35], s75 offen lds
    s_waitcnt lgkmcnt(6)
    v_mfma_f32_32x32x16_bf16 v[32:47], a[228:231], a[128:131], v[32:47]
    ds_read_b128 a[140:143], v233 offset:12288
    ds_read_b64_tr_b16 a[240:241], v236 offset:15680
    ds_read_b64_tr_b16 a[242:243], v236 offset:16448
    v_mfma_f32_32x32x16_bf16 v[48:63], a[228:231], a[132:135], v[48:63]
    ds_read_b64_tr_b16 a[244:245], v236 offset:15744
    ds_read_b64_tr_b16 a[246:247], v236 offset:16512
    ds_read_b128 a[248:251], v238 offset:4096
    s_add_u32 m0, s70, 0x800
    s_add_u32 s75, s10, 0x3800
    buffer_load_dwordx4 v225, s[28:31], s75 offen lds
    s_waitcnt lgkmcnt(10)
    v_mfma_f32_32x32x16_bf16 v[64:79], a[128:131], a[232:235], v[64:79]
    ds_read_b64_tr_b16 v[192:193], v237 offset:12608
    ds_read_b64_tr_b16 v[194:195], v237 offset:13376
    s_mov_b32 vcc_lo, 0xaaabffff
    s_mov_b32 vcc_hi, 0xaabfffff
    v_cndmask_b32 v138, 0, v248, vcc
    v_mfma_f32_32x32x16_bf16 v[80:95], a[132:135], a[232:235], v[80:95]
    ds_read_b64_tr_b16 v[196:197], v237 offset:12672
    ds_read_b64_tr_b16 v[198:199], v237 offset:13440
    s_add_u32 m0, s70, 0xc00
    s_add_u32 s75, s10, 0x3800
    buffer_load_dwordx4 v226, s[28:31], s75 offen lds
    s_waitcnt lgkmcnt(10)
    v_mfma_f32_32x32x16_bf16 v[0:15], a[236:239], a[136:139], v[0:15]
    ds_read_b128 a[144:147], v234 offset:8192
    ds_read_b64_tr_b16 a[224:225], v236 offset:18688
    s_mov_b32 vcc_lo, 0x5557ffff
    s_mov_b32 vcc_hi, 0x557fffff
    v_cndmask_b32 v139, 0, v248, vcc
    s_waitcnt lgkmcnt(11)
    v_mfma_f32_32x32x16_bf16 v[16:31], a[236:239], a[140:143], v[16:31]
    ds_read_b64_tr_b16 a[226:227], v236 offset:19456
    s_mov_b64 exec, s[78:79]
    ds_read_b128 a[224:227], v255 offset:64
    s_mov_b64 exec, -1
    s_add_u32 m0, s71, 0x800
    s_mul_i32 s75, s10, 0x540
    buffer_load_dwordx4 v229, s[32:35], s75 offen lds
    s_waitcnt lgkmcnt(11)
    v_mfma_f32_32x32x16_bf16 v[32:47], a[240:243], a[136:139], v[32:47]
    ds_read_b128 a[148:151], v234 offset:12288
    ds_read_b64_tr_b16 a[228:229], v236 offset:18752
    s_mov_b32 vcc_lo, 0xaaffffff
    s_mov_b32 vcc_hi, 0xafffffff
    v_cndmask_b32 v140, 0, v248, vcc
    v_mfma_f32_32x32x16_bf16 v[48:63], a[240:243], a[140:143], v[48:63]
    ds_read_b64_tr_b16 a[230:231], v236 offset:19520
    ds_read_b64_tr_b16 a[232:233], v236 offset:18816
    s_add_u32 m0, s70, 0x1000
    s_add_u32 s75, s10, 0x7000
    buffer_load_dwordx4 v225, s[28:31], s75 offen lds
    s_waitcnt lgkmcnt(13)
    v_mfma_f32_32x32x16_bf16 v[64:79], a[136:139], a[244:247], v[64:79]
    ds_read_b64_tr_b16 a[234:235], v236 offset:19584
    s_mov_b32 vcc_lo, 0x55ffffff
    s_mov_b32 vcc_hi, 0x5fffffff
    v_cndmask_b32 v141, 0, v248, vcc
    v_mfma_f32_32x32x16_bf16 v[80:95], a[140:143], a[244:247], v[80:95]
    s_add_u32 m0, s70, 0x1400
    s_add_u32 s75, s10, 0x7000
    buffer_load_dwordx4 v226, s[28:31], s75 offen lds
    s_waitcnt lgkmcnt(5)
    v_mfma_f32_32x32x16_bf16 v[0:15], a[224:227], a[144:147], v[0:15]
    ds_read_b128 a[152:155], v235 offset:8192
    ds_read_b64_tr_b16 a[236:237], v236 offset:21760
    s_mov_b32 vcc_lo, 0xabffffff
    s_mov_b32 vcc_hi, 0xbfffffff
    v_cndmask_b32 v142, 0, v248, vcc
    s_waitcnt lgkmcnt(6)
    v_mfma_f32_32x32x16_bf16 v[16:31], a[224:227], a[148:151], v[16:31]
    ds_read_b64_tr_b16 a[238:239], v236 offset:22528
    s_mov_b64 exec, s[78:79]
    ds_read_b128 a[236:239], v255 offset:96
    s_mov_b64 exec, -1
    s_add_u32 m0, s73, 0
    s_nop 0
    buffer_load_dwordx4 v231, s[28:31], s10 offen lds
    s_waitcnt lgkmcnt(6)
    v_mfma_f32_32x32x16_bf16 v[32:47], a[228:231], a[144:147], v[32:47]
    ds_read_b128 a[156:159], v235 offset:12288
    ds_read_b64_tr_b16 a[240:241], v236 offset:21824
    s_mov_b32 vcc_lo, 0x57ffffff
    s_mov_b32 vcc_hi, 0x7fffffff
    v_cndmask_b32 v143, 0, v248, vcc
    v_mfma_f32_32x32x16_bf16 v[48:63], a[228:231], a[148:151], v[48:63]
    ds_read_b64_tr_b16 a[242:243], v236 offset:22592
    ds_read_b64_tr_b16 a[244:245], v236 offset:21888
    s_mov_b32 vcc_lo, 0xffffffff
    s_mov_b32 vcc_hi, 0xfffffffa
    v_cndmask_b32 v144, 0, v248, vcc
    s_waitcnt lgkmcnt(8)
    v_mfma_f32_32x32x16_bf16 v[64:79], a[144:147], a[232:235], v[64:79]
    ds_read_b64_tr_b16 a[246:247], v236 offset:22656
    s_add_u32 m0, s70, 0x1800
    s_add_u32 s75, s10, 0xa800
    buffer_load_dwordx4 v225, s[28:31], s75 offen lds
    v_mfma_f32_32x32x16_bf16 v[80:95], a[148:151], a[232:235], v[80:95]
    s_mov_b32 vcc_lo, 0xffffffff
    s_mov_b32 vcc_hi, 0xfffffff5
    v_cndmask_b32 v145, 0, v248, vcc
    v_mfma_f32_32x32x16_bf16 v[96:111], v[192:195], a[248:251], v[96:111]
    s_add_u32 m0, s70, 0x1c00
    s_add_u32 s75, s10, 0xa800
    buffer_load_dwordx4 v226, s[28:31], s75 offen lds
    v_mfma_f32_32x32x16_bf16 v[112:127], a[248:251], v[196:199], v[112:127]
    s_mov_b32 vcc_lo, 0xfffffffe
    s_mov_b32 vcc_hi, 0xffffffea
    v_cndmask_b32 v146, 0, v248, vcc
    s_waitcnt lgkmcnt(5)
    v_mfma_f32_32x32x16_bf16 v[0:15], a[236:239], a[152:155], v[0:15]
    s_mov_b32 vcc_lo, 0xfffffffd
    s_mov_b32 vcc_hi, 0xffffffd5
    v_cndmask_b32 v147, 0, v248, vcc
    s_waitcnt lgkmcnt(4)
    v_mfma_f32_32x32x16_bf16 v[16:31], a[236:239], a[156:159], v[16:31]
    s_waitcnt lgkmcnt(0)
    s_waitcnt vmcnt(12)
    s_barrier
    v_add_u32 v255, s9, v243
    ds_read_b128 a[160:163], v232 offset:16384
    ds_read_b64_tr_b16 a[224:225], v236 offset:25088
    v_mfma_f32_32x32x16_bf16 v[32:47], a[240:243], a[152:155], v[32:47]
    ds_read_b64_tr_b16 a[226:227], v236 offset:25856
    s_mov_b64 exec, s[78:79]
    ds_read_b128 a[224:227], v255 offset:0
    s_mov_b64 exec, -1
    v_mfma_f32_32x32x16_bf16 v[48:63], a[240:243], a[156:159], v[48:63]
    ds_read_b128 a[164:167], v232 offset:20480
    ds_read_b64_tr_b16 a[228:229], v236 offset:25152
    s_mov_b32 vcc_lo, 0xffffffaa
    s_mov_b32 vcc_hi, 0xfffffaaa
    v_cndmask_b32 v148, 0, v248, vcc
    v_mfma_f32_32x32x16_bf16 v[64:79], a[152:155], a[244:247], v[64:79]
    ds_read_b64_tr_b16 a[230:231], v236 offset:25920
    ds_read_b64_tr_b16 a[232:233], v236 offset:25216
    s_mov_b32 vcc_lo, 0xffffff55
    s_mov_b32 vcc_hi, 0xfffff555
    v_cndmask_b32 v149, 0, v248, vcc
    v_mfma_f32_32x32x16_bf16 v[80:95], a[156:159], a[244:247], v[80:95]
    ds_read_b64_tr_b16 a[234:235], v236 offset:25984
    s_mov_b32 vcc_lo, 0xfffffeaa
    s_mov_b32 vcc_hi, 0xffffeaaa
    v_cndmask_b32 v150, 0, v248, vcc
    s_waitcnt lgkmcnt(5)
    v_mfma_f32_32x32x16_bf16 v[0:15], a[224:227], a[160:163], v[0:15]
    ds_read_b128 a[168:171], v233 offset:16384
    ds_read_b64_tr_b16 a[236:237], v236 offset:28160
    ds_read_b64_tr_b16 a[238:239], v236 offset:28928
    s_waitcnt lgkmcnt(7)
    v_mfma_f32_32x32x16_bf16 v[16:31], a[224:227], a[164:167], v[16:31]
    s_mov_b64 exec, s[78:79]
    ds_read_b128 a[236:239], v255 offset:32
    s_mov_b64 exec, -1
    s_waitcnt lgkmcnt(6)
    v_mfma_f32_32x32x16_bf16 v[32:47], a[228:231], a[160:163], v[32:47]
    ds_read_b128 a[172:175], v233 offset:20480
    ds_read_b64_tr_b16 a[240:241], v236 offset:28224
    ds_read_b64_tr_b16 a[242:243], v236 offset:28992
    v_mfma_f32_32x32x16_bf16 v[48:63], a[228:231], a[164:167], v[48:63]
    ds_read_b64_tr_b16 a[244:245], v236 offset:28288
    ds_read_b64_tr_b16 a[246:247], v236 offset:29056
    ds_read_b128 a[248:251], v238 offset:8192
    s_waitcnt lgkmcnt(10)
    v_mfma_f32_32x32x16_bf16 v[64:79], a[160:163], a[232:235], v[64:79]
    ds_read_b64_tr_b16 v[192:193], v237 offset:25152
    ds_read_b64_tr_b16 v[194:195], v237 offset:25920
    s_mov_b32 vcc_lo, 0xfffffd55
    s_mov_b32 vcc_hi, 0xffffd555
    v_cndmask_b32 v151, 0, v248, vcc
    v_mfma_f32_32x32x16_bf16 v[80:95], a[164:167], a[232:235], v[80:95]
    ds_read_b64_tr_b16 v[196:197], v237 offset:25216
    ds_read_b64_tr_b16 v[198:199], v237 offset:25984
    s_waitcnt lgkmcnt(10)
    v_mfma_f32_32x32x16_bf16 v[0:15], a[236:239], a[168:171], v[0:15]
    ds_read_b128 a[176:179], v234 offset:16384
    ds_read_b64_tr_b16 a[224:225], v236 offset:31232
    s_waitcnt lgkmcnt(11)
    v_mfma_f32_32x32x16_bf16 v[16:31], a[236:239], a[172:175], v[16:31]
    ds_read_b64_tr_b16 a[226:227], v236 offset:32000
    s_mov_b64 exec, s[78:79]
    ds_read_b128 a[224:227], v255 offset:64
    s_mov_b64 exec, -1
    s_waitcnt lgkmcnt(11)
    v_mfma_f32_32x32x16_bf16 v[32:47], a[240:243], a[168:171], v[32:47]
    ds_read_b128 a[180:183], v234 offset:20480
    ds_read_b64_tr_b16 a[228:229], v236 offset:31296
    v_mfma_f32_32x32x16_bf16 v[48:63], a[240:243], a[172:175], v[48:63]
    ds_read_b64_tr_b16 a[230:231], v236 offset:32064
    ds_read_b64_tr_b16 a[232:233], v236 offset:31360
    s_waitcnt lgkmcnt(13)
    v_mfma_f32_32x32x16_bf16 v[64:79], a[168:171], a[244:247], v[64:79]
    ds_read_b64_tr_b16 a[234:235], v236 offset:32128
    v_mfma_f32_32x32x16_bf16 v[80:95], a[172:175], a[244:247], v[80:95]
    s_waitcnt lgkmcnt(5)
    v_mfma_f32_32x32x16_bf16 v[0:15], a[224:227], a[176:179], v[0:15]
    ds_read_b128 a[184:187], v235 offset:16384
    ds_read_b64_tr_b16 a[236:237], v236 offset:34304
    s_waitcnt lgkmcnt(6)
    v_mfma_f32_32x32x16_bf16 v[16:31], a[224:227], a[180:183], v[16:31]
    ds_read_b64_tr_b16 a[238:239], v236 offset:35072
    s_mov_b64 exec, s[78:79]
    ds_read_b128 a[236:239], v255 offset:96
    s_mov_b64 exec, -1
    s_waitcnt lgkmcnt(6)
    v_mfma_f32_32x32x16_bf16 v[32:47], a[228:231], a[176:179], v[32:47]
    ds_read_b128 a[188:191], v235 offset:20480
    ds_read_b64_tr_b16 a[240:241], v236 offset:34368
    v_mfma_f32_32x32x16_bf16 v[48:63], a[228:231], a[180:183], v[48:63]
    ds_read_b64_tr_b16 a[242:243], v236 offset:35136
    ds_read_b64_tr_b16 a[244:245], v236 offset:34432
    s_waitcnt lgkmcnt(8)
    v_mfma_f32_32x32x16_bf16 v[64:79], a[176:179], a[232:235], v[64:79]
    ds_read_b64_tr_b16 a[246:247], v236 offset:35200
    v_mfma_f32_32x32x16_bf16 v[80:95], a[180:183], a[232:235], v[80:95]
    v_mfma_f32_32x32x16_bf16 v[96:111], v[192:195], a[248:251], v[96:111]
    v_mfma_f32_32x32x16_bf16 v[112:127], a[248:251], v[196:199], v[112:127]
    s_waitcnt lgkmcnt(5)
    v_mfma_f32_32x32x16_bf16 v[0:15], a[236:239], a[184:187], v[0:15]
    s_waitcnt lgkmcnt(4)
    v_mfma_f32_32x32x16_bf16 v[16:31], a[236:239], a[188:191], v[16:31]
    s_waitcnt lgkmcnt(0)
    s_waitcnt vmcnt(0)
    s_barrier
    v_add_u32 v255, s10, v243
    ds_read_b128 a[192:195], v232 offset:0
    ds_read_b64_tr_b16 a[224:225], v236 offset:0
    v_mfma_f32_32x32x16_bf16 v[32:47], a[240:243], a[184:187], v[32:47]
    ds_read_b64_tr_b16 a[226:227], v236 offset:768
    s_mov_b64 exec, s[78:79]
    ds_read_b128 a[224:227], v255 offset:0
    s_mov_b64 exec, -1
    v_mfma_f32_32x32x16_bf16 v[48:63], a[240:243], a[188:191], v[48:63]
    ds_read_b128 a[196:199], v232 offset:4096
    ds_read_b64_tr_b16 a[228:229], v236 offset:64
    v_mfma_f32_32x32x16_bf16 v[64:79], a[184:187], a[244:247], v[64:79]
    ds_read_b64_tr_b16 a[230:231], v236 offset:832
    ds_read_b64_tr_b16 a[232:233], v236 offset:128
    v_mfma_f32_32x32x16_bf16 v[80:95], a[188:191], a[244:247], v[80:95]
    ds_read_b64_tr_b16 a[234:235], v236 offset:896
    s_waitcnt lgkmcnt(5)
    v_mfma_f32_32x32x16_bf16 v[0:15], a[224:227], a[192:195], v[0:15]
    ds_read_b128 a[200:203], v233 offset:0
    ds_read_b64_tr_b16 a[236:237], v236 offset:3072
    ds_read_b64_tr_b16 a[238:239], v236 offset:3840
    s_waitcnt lgkmcnt(7)
    v_mfma_f32_32x32x16_bf16 v[16:31], a[224:227], a[196:199], v[16:31]
    s_mov_b64 exec, s[78:79]
    ds_read_b128 a[236:239], v255 offset:32
    s_mov_b64 exec, -1
    s_waitcnt lgkmcnt(6)
    v_mfma_f32_32x32x16_bf16 v[32:47], a[228:231], a[192:195], v[32:47]
    ds_read_b128 a[204:207], v233 offset:4096
    ds_read_b64_tr_b16 a[240:241], v236 offset:3136
    ds_read_b64_tr_b16 a[242:243], v236 offset:3904
    v_mfma_f32_32x32x16_bf16 v[48:63], a[228:231], a[196:199], v[48:63]
    ds_read_b64_tr_b16 a[244:245], v236 offset:3200
    ds_read_b64_tr_b16 a[246:247], v236 offset:3968
    ds_read_b128 a[248:251], v238 offset:0
    s_waitcnt lgkmcnt(10)
    v_mfma_f32_32x32x16_bf16 v[64:79], a[192:195], a[232:235], v[64:79]
    ds_read_b64_tr_b16 v[192:193], v237 offset:64
    ds_read_b64_tr_b16 v[194:195], v237 offset:832
    v_mfma_f32_32x32x16_bf16 v[80:95], a[196:199], a[232:235], v[80:95]
    ds_read_b64_tr_b16 v[196:197], v237 offset:128
    ds_read_b64_tr_b16 v[198:199], v237 offset:896
    s_waitcnt lgkmcnt(10)
    v_mfma_f32_32x32x16_bf16 v[0:15], a[236:239], a[200:203], v[0:15]
    ds_read_b128 a[208:211], v234 offset:0
    ds_read_b64_tr_b16 a[224:225], v236 offset:6144
    s_waitcnt lgkmcnt(11)
    v_mfma_f32_32x32x16_bf16 v[16:31], a[236:239], a[204:207], v[16:31]
    ds_read_b64_tr_b16 a[226:227], v236 offset:6912
    s_mov_b64 exec, s[78:79]
    ds_read_b128 a[224:227], v255 offset:64
    s_mov_b64 exec, -1
    s_waitcnt lgkmcnt(11)
    v_mfma_f32_32x32x16_bf16 v[32:47], a[240:243], a[200:203], v[32:47]
    ds_read_b128 a[212:215], v234 offset:4096
    ds_read_b64_tr_b16 a[228:229], v236 offset:6208
    v_mfma_f32_32x32x16_bf16 v[48:63], a[240:243], a[204:207], v[48:63]
    ds_read_b64_tr_b16 a[230:231], v236 offset:6976
    ds_read_b64_tr_b16 a[232:233], v236 offset:6272
    s_waitcnt lgkmcnt(13)
    v_mfma_f32_32x32x16_bf16 v[64:79], a[200:203], a[244:247], v[64:79]
    ds_read_b64_tr_b16 a[234:235], v236 offset:7040
    v_mfma_f32_32x32x16_bf16 v[80:95], a[204:207], a[244:247], v[80:95]
    s_waitcnt lgkmcnt(5)
    v_mfma_f32_32x32x16_bf16 v[0:15], a[224:227], a[208:211], v[0:15]
    ds_read_b128 a[216:219], v235 offset:0
    ds_read_b64_tr_b16 a[236:237], v236 offset:9216
    s_waitcnt lgkmcnt(6)
    v_mfma_f32_32x32x16_bf16 v[16:31], a[224:227], a[212:215], v[16:31]
    ds_read_b64_tr_b16 a[238:239], v236 offset:9984
    s_mov_b64 exec, s[78:79]
    ds_read_b128 a[236:239], v255 offset:96
    s_mov_b64 exec, -1
    s_waitcnt lgkmcnt(6)
    v_mfma_f32_32x32x16_bf16 v[32:47], a[228:231], a[208:211], v[32:47]
    ds_read_b128 a[220:223], v235 offset:4096
    ds_read_b64_tr_b16 a[240:241], v236 offset:9280
    v_mfma_f32_32x32x16_bf16 v[48:63], a[228:231], a[212:215], v[48:63]
    ds_read_b64_tr_b16 a[242:243], v236 offset:10048
    ds_read_b64_tr_b16 a[244:245], v236 offset:9344
    s_waitcnt lgkmcnt(8)
    v_mfma_f32_32x32x16_bf16 v[64:79], a[208:211], a[232:235], v[64:79]
    ds_read_b64_tr_b16 a[246:247], v236 offset:10112
    v_mfma_f32_32x32x16_bf16 v[80:95], a[212:215], a[232:235], v[80:95]
    v_mfma_f32_32x32x16_bf16 v[96:111], v[192:195], a[248:251], v[96:111]
    v_mfma_f32_32x32x16_bf16 v[112:127], a[248:251], v[196:199], v[112:127]
    s_waitcnt lgkmcnt(5)
    v_mfma_f32_32x32x16_bf16 v[0:15], a[236:239], a[216:219], v[0:15]
    s_waitcnt lgkmcnt(4)
    v_mfma_f32_32x32x16_bf16 v[16:31], a[236:239], a[220:223], v[16:31]
    s_waitcnt lgkmcnt(0)
    s_barrier
    v_mfma_f32_32x32x16_bf16 v[32:47], a[240:243], a[216:219], v[32:47]
    v_mfma_f32_32x32x16_bf16 v[48:63], a[240:243], a[220:223], v[48:63]
    v_mfma_f32_32x32x16_bf16 v[64:79], a[216:219], a[244:247], v[64:79]
    v_mfma_f32_32x32x16_bf16 v[80:95], a[220:223], a[244:247], v[80:95]
    s_nop 3
    v_mov_b32 v192, v12
    s_nop 0
    v_mov_b32 v193, v28
    s_nop 1
    v_cvt_pk_bf16_f32 v32, v32, v33
    v_cvt_pk_bf16_f32 v33, v34, v35
    v_cvt_pk_bf16_f32 v34, v36, v37
    v_cvt_pk_bf16_f32 v35, v38, v39
    v_cvt_pk_bf16_f32 v36, v40, v41
    ds_write_b128 v249, v[96:99] offset:0
    v_cvt_pk_bf16_f32 v37, v42, v43
    v_cvt_pk_bf16_f32 v38, v44, v45
    v_cvt_pk_bf16_f32 v39, v46, v47
    v_cvt_pk_bf16_f32 v40, v48, v49
    v_cvt_pk_bf16_f32 v41, v50, v51
    ds_write_b128 v249, v[100:103] offset:1024
    v_cvt_pk_bf16_f32 v42, v52, v53
    v_cvt_pk_bf16_f32 v43, v54, v55
    v_cvt_pk_bf16_f32 v44, v56, v57
    v_cvt_pk_bf16_f32 v45, v58, v59
    v_cvt_pk_bf16_f32 v46, v60, v61
    ds_write_b128 v249, v[104:107] offset:2048
    v_cvt_pk_bf16_f32 v47, v62, v63
    v_cvt_pk_bf16_f32 v64, v64, v65
    v_cvt_pk_bf16_f32 v65, v66, v67
    v_cvt_pk_bf16_f32 v66, v68, v69
    v_cvt_pk_bf16_f32 v67, v70, v71
    ds_write_b128 v249, v[108:111] offset:3072
    v_cvt_pk_bf16_f32 v68, v72, v73
    v_cvt_pk_bf16_f32 v69, v74, v75
    v_cvt_pk_bf16_f32 v70, v76, v77
    v_cvt_pk_bf16_f32 v71, v78, v79
    v_cvt_pk_bf16_f32 v72, v80, v81
    ds_write_b128 v249, v[120:123] offset:4096
    v_cvt_pk_bf16_f32 v73, v82, v83
    v_cvt_pk_bf16_f32 v74, v84, v85
    v_cvt_pk_bf16_f32 v75, v86, v87
    v_cvt_pk_bf16_f32 v76, v88, v89
    v_cvt_pk_bf16_f32 v77, v90, v91
    ds_write_b128 v249, v[124:127] offset:5120
    v_cvt_pk_bf16_f32 v78, v92, v93
    v_cvt_pk_bf16_f32 v79, v94, v95
    s_add_u32 m0, s26, 0
    s_nop 0
    buffer_load_dwordx4 v223, s[56:59], 0 offen lds
    s_add_u32 m0, s26, 0x400
    s_mov_b32 s75, 0x1c00
    buffer_load_dwordx4 v223, s[56:59], s75 offen lds
    ds_write_b128 v254, v[40:43] offset:3072
    v_cvt_pk_bf16_f32 v0, v0, v1
    v_cvt_pk_bf16_f32 v1, v2, v3
    v_cvt_pk_bf16_f32 v2, v4, v5
    v_cvt_pk_bf16_f32 v3, v6, v7
    v_cvt_pk_bf16_f32 v4, v8, v9
    ds_write_b128 v254, v[44:47] offset:4096
    v_cvt_pk_bf16_f32 v5, v10, v11
    v_cvt_pk_bf16_f32 v6, v12, v13
    v_cvt_pk_bf16_f32 v7, v14, v15
    v_cvt_pk_bf16_f32 v8, v16, v17
    v_cvt_pk_bf16_f32 v9, v18, v19
    ds_write_b128 v254, v[76:79] offset:5120
    v_cvt_pk_bf16_f32 v10, v20, v21
    v_cvt_pk_bf16_f32 v11, v22, v23
    v_cvt_pk_bf16_f32 v12, v24, v25
    v_cvt_pk_bf16_f32 v13, v26, v27
    v_cvt_pk_bf16_f32 v14, v28, v29
    v_cvt_pk_bf16_f32 v15, v30, v31
    v_cndmask_b32 v6, 0, v6, s[80:81]
    v_cndmask_b32 v7, 0, v7, s[80:81]
    v_cndmask_b32 v14, 0, v14, s[80:81]
    v_cndmask_b32 v15, 0, v15, s[80:81]
    s_waitcnt lgkmcnt(0)
    s_barrier
    ds_read_b128 v[48:51], v250 offset:0
    ds_read_b64 v[200:201], v251 offset:0
    ds_read_b128 v[52:55], v250 offset:6144
    ds_read_b64 v[202:203], v251 offset:6144
    ds_read_b128 v[56:59], v250 offset:12288
    ds_read_b64 v[204:205], v251 offset:12288
    ds_read_b128 v[60:63], v250 offset:18432
    ds_read_b64 v[206:207], v251 offset:18432
    v_mfma_f32_32x32x16_bf16 v[80:95], v[40:43], v[8:11], v[128:143]
    v_mfma_f32_32x32x16_bf16 v[16:31], v[32:35], v[8:11], v[136:151]
    v_mfma_f32_32x32x16_bf16 v[80:95], v[44:47], v[12:15], v[80:95]
    v_mfma_f32_32x32x16_bf16 v[16:31], v[36:39], v[12:15], v[16:31]
    s_waitcnt lgkmcnt(5)
    v_add_f32 v48, v48, v52
    s_waitcnt lgkmcnt(1)
    v_add_f32 v56, v56, v60
    v_add_f32 v49, v49, v53
    v_add_f32 v57, v57, v61
    s_add_u32 m0, s70, 0
    s_mov_b32 s75, 0x3800
    buffer_load_dwordx4 v223, s[56:59], s75 offen lds
    s_add_u32 m0, s70, 0x400
    s_mov_b32 s75, 0x5400
    buffer_load_dwordx4 v223, s[56:59], s75 offen lds
    v_add_f32 v50, v50, v54
    v_add_f32 v58, v58, v62
    v_add_f32 v51, v51, v55
    v_add_f32 v59, v59, v63
    v_add_f32 v200, v200, v202
    s_waitcnt lgkmcnt(0)
    v_add_f32 v204, v204, v206
    v_add_f32 v201, v201, v203
    v_add_f32 v205, v205, v207
    v_add_f32 v48, v48, v56
    v_add_f32 v49, v49, v57
    v_add_f32 v50, v50, v58
    v_add_f32 v51, v51, v59
    v_add_f32 v200, v200, v204
    v_add_f32 v201, v201, v205
    v_cvt_pk_bf16_f32 v48, v48, v49
    v_cvt_pk_bf16_f32 v49, v50, v51
    v_cvt_pk_bf16_f32 v200, v200, v201
    ds_write_b64 v252, v[48:49] offset:0
    ds_write_b32 v253, v200 offset:0
    s_lshl_b32 s64, s61, 2
    s_add_u32 s64, s64, s60
    s_lshl_b32 s64, s64, 2
    s_add_u32 s64, s64, s62
    s_lshl_b32 s64, s64, 2
    s_add_u32 s64, s64, s63
    s_lshl_b32 s64, s64, 9
    s_add_u32 s64, s64, 0xbff800
    v_lshlrev_b32 v249, 2, v247
    v_add_u32 v249, s64, v249
    v_max3_f32 v120, v80, v81, v82
    v_max3_f32 v121, v83, v84, v85
    v_max3_f32 v120, v120, v86, v87
    v_max3_f32 v121, v121, v88, v89
    v_max3_f32 v120, v120, v90, v91
    v_max3_f32 v121, v121, v92, v93
    v_max3_f32 v120, v120, v94, v95
    v_max3_f32 v121, v121, v24, v25
    v_max3_f32 v120, v120, v26, v27
    v_max3_f32 v121, v121, v28, v29
    v_max3_f32 v120, v120, v30, v31
    v_max_f32 v120, v120, v121
    v_mov_b32 v121, v120
    v_mul_f32 v193, 0xbfb8aa3b, v193
    v_exp_f32 v193, v193
    v_permlane32_swap_b32 v120, v121
    v_max_f32 v120, v120, v121
    s_add_u32 m0, s70, 0x800
    s_mov_b32 s75, 0x7000
    buffer_load_dwordx4 v223, s[56:59], s75 offen lds
    s_add_u32 m0, s70, 0xc00
    s_mov_b32 s75, 0x8c00
    buffer_load_dwordx4 v223, s[56:59], s75 offen lds
    v_mul_f32 v124, 0xbe8b97f6, v120
    v_fma_f32 v80, v80, s83, v124
    v_fma_f32 v81, v81, s83, v124
    v_fma_f32 v82, v82, s83, v124
    v_fma_f32 v83, v83, s83, v124
    v_fma_f32 v84, v84, s83, v124
    v_fma_f32 v85, v85, s83, v124
    v_fma_f32 v86, v86, s83, v124
    v_fma_f32 v87, v87, s83, v124
    v_fma_f32 v88, v88, s83, v124
    v_fma_f32 v89, v89, s83, v124
    v_fma_f32 v90, v90, s83, v124
    v_fma_f32 v91, v91, s83, v124
    v_fma_f32 v92, v92, s83, v124
    v_fma_f32 v93, v93, s83, v124
    v_fma_f32 v94, v94, s83, v124
    v_fma_f32 v95, v95, s83, v124
    v_fma_f32 v24, v24, s83, v124
    v_fma_f32 v25, v25, s83, v124
    v_fma_f32 v26, v26, s83, v124
    v_fma_f32 v27, v27, s83, v124
    v_fma_f32 v28, v28, s83, v124
    v_fma_f32 v29, v29, s83, v124
    v_fma_f32 v30, v30, s83, v124
    v_fma_f32 v31, v31, s83, v124
    v_exp_f32 v80, v80
    v_exp_f32 v81, v81
    v_exp_f32 v82, v82
    v_exp_f32 v83, v83
    v_exp_f32 v84, v84
    v_exp_f32 v85, v85
    v_exp_f32 v86, v86
    v_exp_f32 v87, v87
    v_exp_f32 v88, v88
    v_exp_f32 v89, v89
    v_exp_f32 v90, v90
    v_exp_f32 v91, v91
    v_exp_f32 v92, v92
    v_exp_f32 v93, v93
    v_exp_f32 v94, v94
    s_add_u32 m0, s70, 0x1000
    s_mov_b32 s75, 0xa800
    buffer_load_dwordx4 v223, s[56:59], s75 offen lds
    s_add_u32 m0, s70, 0x1400
    s_mov_b32 s75, 0xc400
    buffer_load_dwordx4 v223, s[56:59], s75 offen lds
    v_exp_f32 v95, v95
    v_exp_f32 v24, v24
    v_exp_f32 v25, v25
    v_exp_f32 v26, v26
    v_exp_f32 v27, v27
    v_exp_f32 v28, v28
    v_exp_f32 v29, v29
    v_exp_f32 v30, v30
    v_exp_f32 v31, v31
    v_add_f32 v193, 1.0, v193
    v_add_f32 v122, v80, v81
    v_add_f32 v123, v82, v83
    v_add_f32 v122, v122, v84
    v_add_f32 v123, v123, v85
    v_add_f32 v122, v122, v86
    v_add_f32 v123, v123, v87
    v_add_f32 v122, v122, v88
    v_add_f32 v123, v123, v89
    v_add_f32 v122, v122, v90
    v_add_f32 v123, v123, v91
    v_add_f32 v122, v122, v92
    v_add_f32 v123, v123, v93
    v_add_f32 v122, v122, v94
    v_add_f32 v123, v123, v95
    v_add_f32 v122, v122, v24
    v_add_f32 v123, v123, v25
    v_add_f32 v122, v122, v26
    v_add_f32 v123, v123, v27
    v_add_f32 v122, v122, v28
    v_add_f32 v123, v123, v29
    v_add_f32 v122, v122, v30
    v_add_f32 v123, v123, v31
    v_cvt_pk_bf16_f32 v80, v80, v81
    v_cvt_pk_bf16_f32 v81, v82, v83
    v_cvt_pk_bf16_f32 v82, v84, v85
    v_cvt_pk_bf16_f32 v83, v86, v87
    v_cvt_pk_bf16_f32 v84, v88, v89
    v_cvt_pk_bf16_f32 v85, v90, v91
    v_cvt_pk_bf16_f32 v86, v92, v93
    v_cvt_pk_bf16_f32 v87, v94, v95
    s_add_u32 m0, s70, 0x1800
    s_mov_b32 s75, 0xe000
    buffer_load_dwordx4 v223, s[56:59], s75 offen lds
    s_add_u32 m0, s70, 0x1c00
    s_mov_b32 s75, 0xfc00
    buffer_load_dwordx4 v223, s[56:59], s75 offen lds
    v_cvt_pk_bf16_f32 v24, v24, v25
    v_cvt_pk_bf16_f32 v25, v26, v27
    v_cvt_pk_bf16_f32 v26, v28, v29
    v_cvt_pk_bf16_f32 v27, v30, v31
    v_add_f32 v122, v122, v123
    v_mov_b32 v123, v122
    v_mfma_f32_32x32x16_bf16 v[48:63], v[72:75], v[80:83], 0
    v_mfma_f32_32x32x16_bf16 v[48:63], v[76:79], v[84:87], v[48:63]
    v_mfma_f32_32x32x16_bf16 v[48:63], v[68:71], v[24:27], v[48:63]
    v_permlane32_swap_b32 v122, v123
    v_add_f32 v122, v122, v123
    v_rcp_f32 v125, v122
    v_rcp_f32 v193, v193
    v_cndmask_b32 v126, 0, v125, s[80:81]
    buffer_store_dword v193, v249, s[52:55], 0 offen offset:256 sc1
    s_waitcnt lgkmcnt(0)
    s_barrier
    ds_read_b128 a[240:243], v254 offset:0
    ds_read_b128 a[244:247], v254 offset:1024
    ds_read_b128 a[248:251], v254 offset:2048
    s_mov_b64 vcc, s[0:1]
    v_cndmask_b32 v144, v248, v144, vcc
    v_cndmask_b32 v145, v248, v145, vcc
    v_cndmask_b32 v146, v248, v146, vcc
    v_cndmask_b32 v147, v248, v147, vcc
    v_cndmask_b32 v148, v248, v148, vcc
    v_cndmask_b32 v149, v248, v149, vcc
    v_cndmask_b32 v150, v248, v150, vcc
    v_cndmask_b32 v151, v248, v151, vcc
    v_mfma_f32_32x32x16_bf16 v[80:95], v[32:35], v[0:3], v[128:143]
    s_waitcnt lgkmcnt(2)
    v_mfma_f32_32x32x16_bf16 v[16:31], a[240:243], v[0:3], v[136:151]
    v_mfma_f32_32x32x16_bf16 v[80:95], v[36:39], v[4:7], v[80:95]
    s_waitcnt lgkmcnt(1)
    v_mfma_f32_32x32x16_bf16 v[16:31], a[244:247], v[4:7], v[16:31]
    v_mul_f32 v48, v48, v125
    v_mul_f32 v49, v49, v125
    v_mul_f32 v50, v50, v125
    v_mul_f32 v51, v51, v125
    v_mul_f32 v52, v52, v125
    v_mul_f32 v53, v53, v125
    v_mul_f32 v54, v54, v125
    v_mul_f32 v55, v55, v125
    s_add_u32 m0, s70, 0x2000
    s_mov_b32 s75, 0x11800
    buffer_load_dwordx4 v223, s[56:59], s75 offen lds
    s_add_u32 m0, s70, 0x2400
    s_mov_b32 s75, 0x13400
    buffer_load_dwordx4 v223, s[56:59], s75 offen lds
    v_mul_f32 v56, v56, v125
    v_mul_f32 v57, v57, v125
    v_mul_f32 v58, v58, v125
    v_mul_f32 v59, v59, v125
    v_mul_f32 v60, v60, v126
    v_mul_f32 v61, v61, v126
    v_mul_f32 v62, v62, v126
    v_mul_f32 v63, v63, v126
    v_cvt_pk_bf16_f32 v48, v48, v49
    v_cvt_pk_bf16_f32 v49, v50, v51
    v_cvt_pk_bf16_f32 v50, v52, v53
    v_cvt_pk_bf16_f32 v51, v54, v55
    v_cvt_pk_bf16_f32 v52, v56, v57
    v_cvt_pk_bf16_f32 v53, v58, v59
    v_cvt_pk_bf16_f32 v54, v60, v61
    v_cvt_pk_bf16_f32 v55, v62, v63
    buffer_store_dwordx4 v[48:51], v246, s[52:55], 0 offen offset:1024 sc1
    buffer_store_dwordx4 v[52:55], v246, s[52:55], 0 offen offset:3072 sc1
    v_max3_f32 v120, v80, v81, v82
    v_max3_f32 v121, v83, v84, v85
    v_max3_f32 v120, v120, v86, v87
    v_max3_f32 v121, v121, v88, v89
    v_max3_f32 v120, v120, v90, v91
    v_max3_f32 v121, v121, v92, v93
    v_max3_f32 v120, v120, v94, v95
    v_max3_f32 v121, v121, v24, v25
    v_max3_f32 v120, v120, v26, v27
    v_max3_f32 v121, v121, v28, v29
    v_max3_f32 v120, v120, v30, v31
    v_max_f32 v120, v120, v121
    v_mov_b32 v121, v120
    v_mul_f32 v192, 0xbfb8aa3b, v192
    v_exp_f32 v192, v192
    v_permlane32_swap_b32 v120, v121
    v_max_f32 v120, v120, v121
    v_mul_f32 v124, 0xbe8b97f6, v120
    v_fma_f32 v80, v80, s83, v124
    v_fma_f32 v81, v81, s83, v124
    v_fma_f32 v82, v82, s83, v124
    v_fma_f32 v83, v83, s83, v124
    s_add_u32 m0, s70, 0x2800
    s_mov_b32 s75, 0x15000
    buffer_load_dwordx4 v223, s[56:59], s75 offen lds
    s_add_u32 m0, s70, 0x2c00
    s_mov_b32 s75, 0x16c00
    buffer_load_dwordx4 v223, s[56:59], s75 offen lds
    v_fma_f32 v84, v84, s83, v124
    v_fma_f32 v85, v85, s83, v124
    v_fma_f32 v86, v86, s83, v124
    v_fma_f32 v87, v87, s83, v124
    v_fma_f32 v88, v88, s83, v124
    v_fma_f32 v89, v89, s83, v124
    v_fma_f32 v90, v90, s83, v124
    v_fma_f32 v91, v91, s83, v124
    v_fma_f32 v92, v92, s83, v124
    v_fma_f32 v93, v93, s83, v124
    v_fma_f32 v94, v94, s83, v124
    v_fma_f32 v95, v95, s83, v124
    v_fma_f32 v24, v24, s83, v124
    v_fma_f32 v25, v25, s83, v124
    v_fma_f32 v26, v26, s83, v124
    v_fma_f32 v27, v27, s83, v124
    v_fma_f32 v28, v28, s83, v124
    v_fma_f32 v29, v29, s83, v124
    v_fma_f32 v30, v30, s83, v124
    v_fma_f32 v31, v31, s83, v124
    v_exp_f32 v80, v80
    v_exp_f32 v81, v81
    v_exp_f32 v82, v82
    v_exp_f32 v83, v83
    v_exp_f32 v84, v84
    v_exp_f32 v85, v85
    v_exp_f32 v86, v86
    v_exp_f32 v87, v87
    v_exp_f32 v88, v88
    v_exp_f32 v89, v89
    v_exp_f32 v90, v90
    v_exp_f32 v91, v91
    v_exp_f32 v92, v92
    v_exp_f32 v93, v93
    v_exp_f32 v94, v94
    v_exp_f32 v95, v95
    v_exp_f32 v24, v24
    v_exp_f32 v25, v25
    v_exp_f32 v26, v26
    v_exp_f32 v27, v27
    s_add_u32 m0, s70, 0x3000
    s_mov_b32 s75, 0x18800
    buffer_load_dwordx4 v223, s[56:59], s75 offen lds
    s_add_u32 m0, s70, 0x3400
    s_mov_b32 s75, 0x1a400
    buffer_load_dwordx4 v223, s[56:59], s75 offen lds
    v_exp_f32 v28, v28
    v_exp_f32 v29, v29
    v_exp_f32 v30, v30
    v_exp_f32 v31, v31
    v_add_f32 v192, 1.0, v192
    v_add_f32 v122, v80, v81
    v_add_f32 v123, v82, v83
    v_add_f32 v122, v122, v84
    v_add_f32 v123, v123, v85
    v_add_f32 v122, v122, v86
    v_add_f32 v123, v123, v87
    v_add_f32 v122, v122, v88
    v_add_f32 v123, v123, v89
    v_add_f32 v122, v122, v90
    v_add_f32 v123, v123, v91
    v_add_f32 v122, v122, v92
    v_add_f32 v123, v123, v93
    v_add_f32 v122, v122, v94
    v_add_f32 v123, v123, v95
    v_add_f32 v122, v122, v24
    v_add_f32 v123, v123, v25
    v_add_f32 v122, v122, v26
    v_add_f32 v123, v123, v27
    v_add_f32 v122, v122, v28
    v_add_f32 v123, v123, v29
    v_add_f32 v122, v122, v30
    v_add_f32 v123, v123, v31
    v_cvt_pk_bf16_f32 v80, v80, v81
    v_cvt_pk_bf16_f32 v81, v82, v83
    v_cvt_pk_bf16_f32 v82, v84, v85
    v_cvt_pk_bf16_f32 v83, v86, v87
    v_cvt_pk_bf16_f32 v84, v88, v89
    v_cvt_pk_bf16_f32 v85, v90, v91
    v_cvt_pk_bf16_f32 v86, v92, v93
    v_cvt_pk_bf16_f32 v87, v94, v95
    v_cvt_pk_bf16_f32 v24, v24, v25
    v_cvt_pk_bf16_f32 v25, v26, v27
    v_cvt_pk_bf16_f32 v26, v28, v29
    v_cvt_pk_bf16_f32 v27, v30, v31
    v_add_f32 v122, v122, v123
    s_add_u32 m0, s70, 0x3800
    s_mov_b32 s75, 0x1c000
    buffer_load_dwordx4 v223, s[56:59], s75 offen lds
    s_add_u32 m0, s70, 0x3c00
    s_mov_b32 s75, 0x1dc00
    buffer_load_dwordx4 v223, s[56:59], s75 offen lds
    v_mov_b32 v123, v122
    v_mfma_f32_32x32x16_bf16 v[48:63], v[64:67], v[80:83], 0
    v_mfma_f32_32x32x16_bf16 v[48:63], v[68:71], v[84:87], v[48:63]
    s_waitcnt lgkmcnt(0)
    v_mfma_f32_32x32x16_bf16 v[48:63], a[248:251], v[24:27], v[48:63]
    v_permlane32_swap_b32 v122, v123
    v_add_f32 v122, v122, v123
    v_rcp_f32 v125, v122
    v_rcp_f32 v192, v192
    v_cndmask_b32 v126, 0, v125, s[80:81]
    buffer_store_dword v192, v249, s[52:55], 0 offen offset:0 sc1
    v_lshrrev_b32 v243, 5, v247
    v_bfe_u32 v213, v247, 2, 2
    v_bfe_u32 v214, v247, 4, 1
    v_and_b32 v255, 3, v247
    v_lshl_add_u32 v214, v214, 2, v255
    v_and_b32 v255, 1, v214
    v_lshrrev_b32 v215, 1, v214
    v_lshl_add_u32 v215, v255, 2, v215
    v_lshl_add_u32 v255, v243, 2, v213
    v_lshlrev_b32 v255, 7, v255
    v_lshl_add_u32 v255, v215, 3, v255
    v_lshrrev_b32 v212, 1, v213
    v_lshl_add_u32 v214, v212, 6, v255
    v_xor_b32 v212, 1, v212
    v_lshl_add_u32 v215, v212, 6, v255
    v_add_u32 v232, s70, v214
    v_add_u32 v233, s70, v215
    v_add_u32 v234, s26, v214
    v_add_u32 v235, s26, v215
    v_add_u32 v236, s3, v214
    v_add_u32 v237, s3, v215
    s_lshl_b32 s82, s61, 2
    s_add_u32 s82, s82, s62
    s_mul_i32 s65, s82, 0x90
    s_mul_i32 s66, s60, 36
    s_add_u32 s65, s65, s66
    s_lshl_b32 s65, s65, 11
    v_add_u32 v225, s65, v224
    s_mov_b32 s68, s65
    v_min_u32 v255, 36, v247
    s_mul_i32 s66, s85, 37
    v_add_u32 v255, s66, v255
    v_min_u32 v255, 0xff, v255
    v_lshlrev_b32 v255, 7, v255
    s_add_u32 s66, s68, 0
    v_add_u32 v194, s66, v255
    v_min_u32 v255, 18, v247
    s_add_u32 m0, s70, 0x4000
    s_mov_b32 s75, 0x1f800
    buffer_load_dwordx4 v223, s[56:59], s75 offen lds
    s_add_u32 m0, s70, 0x4400
    s_mov_b32 s75, 0x21400
    buffer_load_dwordx4 v223, s[56:59], s75 offen lds
    s_mul_i32 s66, s85, 19
    v_add_u32 v255, s66, v255
    v_min_u32 v255, 0x7f, v255
    v_lshlrev_b32 v255, 7, v255
    s_add_u32 s66, s68, 0x8000
    v_add_u32 v195, s66, v255
    v_min_u32 v255, 27, v247
    s_mul_i32 s66, s85, 28
    v_add_u32 v255, s66, v255
    v_min_u32 v255, 0xbf, v255
    v_lshlrev_b32 v255, 7, v255
    s_add_u32 s66, s68, 0xc000
    v_add_u32 v196, s66, v255
    v_add_u32 v226, s3, v224
    v_add_u32 v227, 0x18000, v224
    v_and_b32 v255, 31, v247
    s_lshl_b32 s65, s82, 2
    s_add_u32 s65, s65, s60
    s_lshl_b32 s65, s65, 11
    s_add_u32 s65, s65, 0xc00080
    v_lshl_add_u32 v238, v255, 2, s65
    s_lshl_b32 s65, s82, 6
    s_lshr_b32 s66, s60, 1
    s_lshl_b32 s66, s66, 5
    s_add_u32 s65, s65, s66
    v_add_u32 v255, s65, v255
    v_mul_u32_u24 v255, 0x380, v255
    v_lshl_add_u32 v255, v243, 5, v255
    s_lshl_b32 s65, s85, 7
    s_and_b32 s66, s60, 1
    s_lshl_b32 s66, s66, 6
    s_add_u32 s65, s65, s66
    v_add_u32 v228, s65, v255
    s_mov_b32 s84, 0
    v_mul_f32 v48, v48, v125
    v_mul_f32 v49, v49, v125
    v_mul_f32 v50, v50, v125
    v_mul_f32 v51, v51, v125
    v_mul_f32 v52, v52, v125
    v_mul_f32 v53, v53, v125
    v_mul_f32 v54, v54, v125
    v_mul_f32 v55, v55, v125
    v_mul_f32 v56, v56, v125
    v_mul_f32 v57, v57, v125
    v_mul_f32 v58, v58, v125
    v_mul_f32 v59, v59, v125
    v_mul_f32 v60, v60, v126
    v_mul_f32 v61, v61, v126
    v_mul_f32 v62, v62, v126
    v_mul_f32 v63, v63, v126
    v_cvt_pk_bf16_f32 v48, v48, v49
    v_cvt_pk_bf16_f32 v49, v50, v51
    v_cvt_pk_bf16_f32 v50, v52, v53
    v_cvt_pk_bf16_f32 v51, v54, v55
    v_cvt_pk_bf16_f32 v52, v56, v57
    v_cvt_pk_bf16_f32 v53, v58, v59
    v_cvt_pk_bf16_f32 v54, v60, v61
    v_cvt_pk_bf16_f32 v55, v62, v63
    buffer_store_dwordx4 v[48:51], v246, s[52:55], 0 offen offset:0 sc1
    buffer_store_dwordx4 v[52:55], v246, s[52:55], 0 offen offset:2048 sc1
    s_add_u32 m0, s70, 0x4800
    s_mov_b32 s75, 0x23000
    buffer_load_dwordx4 v223, s[56:59], s75 offen lds
    s_add_u32 m0, s70, 0x4c00
    s_mov_b32 s75, 0x24c00
    buffer_load_dwordx4 v223, s[56:59], s75 offen lds
    s_add_u32 m0, s70, 0x5000
    s_mov_b32 s75, 0x26800
    buffer_load_dwordx4 v223, s[56:59], s75 offen lds
    s_add_u32 m0, s70, 0x5400
    s_mov_b32 s75, 0x28400
    buffer_load_dwordx4 v223, s[56:59], s75 offen lds
    s_add_u32 m0, s70, 0x5800
    s_mov_b32 s75, 0x2a000
    buffer_load_dwordx4 v223, s[56:59], s75 offen lds
    s_add_u32 m0, s70, 0x5c00
    s_mov_b32 s75, 0x2bc00
    buffer_load_dwordx4 v223, s[56:59], s75 offen lds
    s_waitcnt vmcnt(6)
    s_nop 0
    s_mov_b64 exec, 3
    buffer_store_dwordx2 v[220:221], v244, s[52:55], 0 offen offset:0 sc1
    s_mov_b64 exec, -1
    ds_read_b64_tr_b16 v[64:65], v234 offset:0
    ds_read_b64_tr_b16 v[66:67], v234 offset:1024
    ds_read_b64_tr_b16 v[68:69], v235 offset:0
    ds_read_b64_tr_b16 v[70:71], v235 offset:1024
    ds_read_b64_tr_b16 v[72:73], v232 offset:0
    ds_read_b64_tr_b16 v[74:75], v232 offset:1024
    ds_read_b64_tr_b16 v[76:77], v233 offset:0
    ds_read_b64_tr_b16 v[78:79], v233 offset:1024
    s_waitcnt lgkmcnt(4)
    s_add_u32 m0, s26, 0
    s_mov_b32 s75, 0x2d800
    buffer_load_dwordx4 v223, s[56:59], s75 offen lds
    s_add_u32 m0, s26, 0x400
    s_mov_b32 s75, 0x2f400
    buffer_load_dwordx4 v223, s[56:59], s75 offen lds
    ds_read_b64_tr_b16 v[80:81], v232 offset:2048
    ds_read_b64_tr_b16 v[82:83], v232 offset:3072
    ds_read_b64_tr_b16 v[84:85], v233 offset:2048
    ds_read_b64_tr_b16 v[86:87], v233 offset:3072
    s_waitcnt lgkmcnt(4)
    s_add_u32 m0, s70, 0
    s_mov_b32 s75, 0x31000
    buffer_load_dwordx4 v223, s[56:59], s75 offen lds
    s_add_u32 m0, s70, 0x400
    s_mov_b32 s75, 0x32c00
    buffer_load_dwordx4 v223, s[56:59], s75 offen lds
    ds_read_b64_tr_b16 v[88:89], v232 offset:4096
    ds_read_b64_tr_b16 v[90:91], v232 offset:5120
    ds_read_b64_tr_b16 v[92:93], v233 offset:4096
    ds_read_b64_tr_b16 v[94:95], v233 offset:5120
    s_waitcnt lgkmcnt(4)
    s_add_u32 m0, s70, 0x800
    s_mov_b32 s75, 0x34800
    buffer_load_dwordx4 v223, s[56:59], s75 offen lds
    s_add_u32 m0, s70, 0xc00
    s_mov_b32 s75, 0x36400
    buffer_load_dwordx4 v223, s[56:59], s75 offen lds
    ds_read_b64_tr_b16 v[96:97], v232 offset:6144
    ds_read_b64_tr_b16 v[98:99], v232 offset:7168
    ds_read_b64_tr_b16 v[100:101], v233 offset:6144
    ds_read_b64_tr_b16 v[102:103], v233 offset:7168
    s_waitcnt lgkmcnt(4)
    s_add_u32 m0, s70, 0x1000
    s_nop 0
    buffer_load_dwordx4 v245, s[40:43], 0 offen lds
    s_add_u32 m0, s70, 0x1400
    s_mov_b32 s75, 0x1c00
    buffer_load_dwordx4 v245, s[40:43], s75 offen lds
    ds_read_b64_tr_b16 v[104:105], v232 offset:8192
    ds_read_b64_tr_b16 v[106:107], v232 offset:9216
    ds_read_b64_tr_b16 v[108:109], v233 offset:8192
    ds_read_b64_tr_b16 v[110:111], v233 offset:9216
    s_waitcnt lgkmcnt(4)
    s_add_u32 m0, s70, 0x1800
    s_mov_b32 s75, 0x3800
    buffer_load_dwordx4 v245, s[40:43], s75 offen lds
    s_add_u32 m0, s70, 0x1c00
    s_mov_b32 s75, 0x5400
    buffer_load_dwordx4 v245, s[40:43], s75 offen lds
    ds_read_b64_tr_b16 v[112:113], v232 offset:10240
    ds_read_b64_tr_b16 v[114:115], v232 offset:11264
    ds_read_b64_tr_b16 v[116:117], v233 offset:10240
    ds_read_b64_tr_b16 v[118:119], v233 offset:11264
    s_waitcnt lgkmcnt(4)
    s_add_u32 m0, s70, 0x2000
    s_mov_b32 s75, 0x6200
    buffer_load_dwordx4 v245, s[40:43], s75 offen lds
    s_add_u32 m0, s70, 0x2400
    s_mov_b32 s75, 0x7e00
    buffer_load_dwordx4 v245, s[40:43], s75 offen lds
    ds_read_b64_tr_b16 v[120:121], v232 offset:12288
    ds_read_b64_tr_b16 v[122:123], v232 offset:13312
    ds_read_b64_tr_b16 v[124:125], v233 offset:12288
    ds_read_b64_tr_b16 v[126:127], v233 offset:13312
    s_waitcnt lgkmcnt(4)
    s_add_u32 m0, s70, 0x2800
    s_mov_b32 s75, 0x9a00
    buffer_load_dwordx4 v245, s[40:43], s75 offen lds
    s_add_u32 m0, s70, 0x2c00
    s_mov_b32 s75, 0xb600
    buffer_load_dwordx4 v245, s[40:43], s75 offen lds
    ds_read_b64_tr_b16 a[0:1], v232 offset:14336
    ds_read_b64_tr_b16 a[2:3], v232 offset:15360
    ds_read_b64_tr_b16 a[4:5], v233 offset:14336
    ds_read_b64_tr_b16 a[6:7], v233 offset:15360
    s_waitcnt lgkmcnt(4)
    s_add_u32 m0, s70, 0x3000
    s_mov_b32 s75, 0xc400
    buffer_load_dwordx4 v245, s[40:43], s75 offen lds
    s_add_u32 m0, s70, 0x3400
    s_mov_b32 s75, 0xe000
    buffer_load_dwordx4 v245, s[40:43], s75 offen lds
    ds_read_b64_tr_b16 a[8:9], v232 offset:16384
    ds_read_b64_tr_b16 a[10:11], v232 offset:17408
    ds_read_b64_tr_b16 a[12:13], v233 offset:16384
    ds_read_b64_tr_b16 a[14:15], v233 offset:17408
    s_waitcnt lgkmcnt(4)
    s_add_u32 m0, s70, 0x3800
    s_mov_b32 s75, 0xfc00
    buffer_load_dwordx4 v245, s[40:43], s75 offen lds
    s_add_u32 m0, s70, 0x3c00
    s_mov_b32 s75, 0x11800
    buffer_load_dwordx4 v245, s[40:43], s75 offen lds
    s_waitcnt vmcnt(23)
    ds_read_b64_tr_b16 a[16:17], v232 offset:18432
    ds_read_b64_tr_b16 a[18:19], v232 offset:19456
    ds_read_b64_tr_b16 a[20:21], v233 offset:18432
    ds_read_b64_tr_b16 a[22:23], v233 offset:19456
    s_waitcnt lgkmcnt(4)
    s_add_u32 m0, s70, 0x4000
    s_mov_b32 s75, 0x12600
    buffer_load_dwordx4 v245, s[40:43], s75 offen lds
    s_add_u32 m0, s70, 0x4400
    s_mov_b32 s75, 0x14200
    buffer_load_dwordx4 v245, s[40:43], s75 offen lds
    buffer_load_dwordx2 v[218:219], v216, s[52:55], 0 offen offset:0 sc1
    s_waitcnt vmcnt(24)
    ds_read_b64_tr_b16 a[24:25], v232 offset:20480
    ds_read_b64_tr_b16 a[26:27], v232 offset:21504
    ds_read_b64_tr_b16 a[28:29], v233 offset:20480
    ds_read_b64_tr_b16 a[30:31], v233 offset:21504
    s_waitcnt lgkmcnt(4)
    s_add_u32 m0, s70, 0x4800
    s_mov_b32 s75, 0x15e00
    buffer_load_dwordx4 v245, s[40:43], s75 offen lds
    s_add_u32 m0, s70, 0x4c00
    s_mov_b32 s75, 0x17a00
    buffer_load_dwordx4 v245, s[40:43], s75 offen lds
    s_waitcnt vmcnt(24)
    ds_read_b64_tr_b16 a[32:33], v232 offset:22528
    ds_read_b64_tr_b16 a[34:35], v232 offset:23552
    ds_read_b64_tr_b16 a[36:37], v233 offset:22528
    ds_read_b64_tr_b16 a[38:39], v233 offset:23552
    s_waitcnt lgkmcnt(4)
    s_add_u32 m0, s70, 0x5000
    s_mov_b32 s75, 0x38000
    buffer_load_dwordx4 v223, s[56:59], s75 offen lds
    s_add_u32 m0, s70, 0x5400
    s_mov_b32 s75, 0x39c00
    buffer_load_dwordx4 v223, s[56:59], s75 offen lds
    s_waitcnt vmcnt(23)
    ds_read_b64_tr_b16 a[40:41], v234 offset:0
    ds_read_b64_tr_b16 a[42:43], v234 offset:1024
    ds_read_b64_tr_b16 a[44:45], v235 offset:0
    ds_read_b64_tr_b16 a[46:47], v235 offset:1024
    s_waitcnt lgkmcnt(4)
    s_add_u32 m0, s70, 0x5800
    s_mov_b32 s75, 0x3b800
    buffer_load_dwordx4 v223, s[56:59], s75 offen lds
    s_add_u32 m0, s70, 0x5c00
    s_mov_b32 s75, 0x3d400
    buffer_load_dwordx4 v223, s[56:59], s75 offen lds
    s_waitcnt vmcnt(23)
    ds_read_b64_tr_b16 a[48:49], v232 offset:0
    ds_read_b64_tr_b16 a[50:51], v232 offset:1024
    ds_read_b64_tr_b16 a[52:53], v233 offset:0
    ds_read_b64_tr_b16 a[54:55], v233 offset:1024
    s_waitcnt lgkmcnt(4)
    s_add_u32 m0, s26, 0
    s_mov_b32 s75, 0x3f000
    buffer_load_dwordx4 v223, s[56:59], s75 offen lds
    s_add_u32 m0, s26, 0x400
    s_mov_b32 s75, 0x40c00
    buffer_load_dwordx4 v223, s[56:59], s75 offen lds
    s_waitcnt vmcnt(23)
    ds_read_b64_tr_b16 a[56:57], v232 offset:2048
    ds_read_b64_tr_b16 a[58:59], v232 offset:3072
    ds_read_b64_tr_b16 a[60:61], v233 offset:2048
    ds_read_b64_tr_b16 a[62:63], v233 offset:3072
    s_waitcnt lgkmcnt(4)
    s_add_u32 m0, s70, 0
    s_mov_b32 s75, 0x42800
    buffer_load_dwordx4 v223, s[56:59], s75 offen lds
    s_add_u32 m0, s70, 0x400
    s_mov_b32 s75, 0x44400
    buffer_load_dwordx4 v223, s[56:59], s75 offen lds
    s_waitcnt vmcnt(23)
    ds_read_b64_tr_b16 a[64:65], v232 offset:4096
    ds_read_b64_tr_b16 a[66:67], v232 offset:5120
    ds_read_b64_tr_b16 a[68:69], v233 offset:4096
    ds_read_b64_tr_b16 a[70:71], v233 offset:5120
    s_waitcnt lgkmcnt(4)
    s_add_u32 m0, s70, 0x800
    s_mov_b32 s75, 0x46000
    buffer_load_dwordx4 v223, s[56:59], s75 offen lds
    s_add_u32 m0, s70, 0xc00
    s_mov_b32 s75, 0x47c00
    buffer_load_dwordx4 v223, s[56:59], s75 offen lds
    s_waitcnt lgkmcnt(0)
    s_add_u32 m0, s70, 0x1000
    s_mov_b32 s75, 0x49800
    buffer_load_dwordx4 v223, s[56:59], s75 offen lds
    s_add_u32 m0, s70, 0x1400
    s_mov_b32 s75, 0x4b400
    buffer_load_dwordx4 v223, s[56:59], s75 offen lds
    s_waitcnt vmcnt(14)
    v_cmp_eq_u64 vcc, v[220:221], v[218:219]
    s_nop 0
    s_and_b32 s69, vcc_lo, 0xf
    s_cmp_eq_u32 s69, 15
    s_cbranch_scc1 L_fl_ok_h0_0
L_fl_loop_h0_0:
    s_sleep 2
    buffer_load_dwordx2 v[218:219], v216, s[52:55], 0 offen sc1
    s_waitcnt vmcnt(0)
    v_cmp_eq_u64 vcc, v[220:221], v[218:219]
    s_add_u32 s84, s84, 1
    s_cmp_gt_u32 s84, 20000
    s_cbranch_scc1 L_fl_ok_h0_0
    s_and_b32 s69, vcc_lo, 0xf
    s_cmp_eq_u32 s69, 0xf
    s_cbranch_scc0 L_fl_loop_h0_0
L_fl_ok_h0_0:
    buffer_load_dwordx4 a[72:75], v225, s[52:55], 0 offen offset:0 sc1
    buffer_load_dwordx4 a[76:79], v225, s[52:55], 0 offen offset:1024 sc1
    buffer_load_dwordx4 a[80:83], v225, s[52:55], 0 offen offset:2048 sc1
    buffer_load_dwordx4 a[84:87], v225, s[52:55], 0 offen offset:3072 sc1
    s_mov_b32 s76, 0x1000
    buffer_load_dwordx4 a[88:91], v225, s[52:55], s76 offen offset:0 sc1
    buffer_load_dwordx4 a[92:95], v225, s[52:55], s76 offen offset:1024 sc1
    s_mov_b32 s76, 0x1000
    buffer_load_dwordx4 a[96:99], v225, s[52:55], s76 offen offset:2048 sc1
    buffer_load_dwordx4 a[100:103], v225, s[52:55], s76 offen offset:3072 sc1
    s_barrier
    s_add_u32 m0, s3, 0
    s_mov_b32 s75, 0x4d000
    buffer_load_dwordx4 v223, s[56:59], s75 offen lds
    s_add_u32 m0, s3, 0x400
    s_mov_b32 s75, 0x4ec00
    buffer_load_dwordx4 v223, s[56:59], s75 offen lds
    s_add_u32 m0, s3, 0x800
    s_mov_b32 s75, 0x50800
    buffer_load_dwordx4 v223, s[56:59], s75 offen lds
    s_add_u32 m0, s3, 0xc00
    s_mov_b32 s75, 0x52400
    buffer_load_dwordx4 v223, s[56:59], s75 offen lds
    s_add_u32 m0, s3, 0x1000
    s_mov_b32 s75, 0x54000
    buffer_load_dwordx4 v223, s[56:59], s75 offen lds
    s_add_u32 m0, s3, 0x1400
    s_mov_b32 s75, 0x55c00
    buffer_load_dwordx4 v223, s[56:59], s75 offen lds
    s_add_u32 m0, s3, 0x1800
    s_mov_b32 s75, 0x57800
    buffer_load_dwordx4 v223, s[56:59], s75 offen lds
    s_add_u32 m0, s3, 0x1c00
    s_mov_b32 s75, 0x59400
    buffer_load_dwordx4 v223, s[56:59], s75 offen lds
    s_add_u32 m0, s3, 0x2000
    s_mov_b32 s75, 0x5b000
    buffer_load_dwordx4 v223, s[56:59], s75 offen lds
    s_add_u32 m0, s3, 0x2400
    s_mov_b32 s75, 0x5cc00
    buffer_load_dwordx4 v223, s[56:59], s75 offen lds
    s_add_u32 m0, s3, 0x2800
    s_mov_b32 s75, 0x5e800
    buffer_load_dwordx4 v223, s[56:59], s75 offen lds
    s_add_u32 m0, s3, 0x2c00
    s_mov_b32 s75, 0x60400
    buffer_load_dwordx4 v223, s[56:59], s75 offen lds
    s_mov_b32 s76, 0x2000
    buffer_load_dwordx4 a[104:107], v225, s[52:55], s76 offen offset:0 sc1
    buffer_load_dwordx4 a[108:111], v225, s[52:55], s76 offen offset:1024 sc1
    s_mov_b32 s76, 0x2000
    buffer_load_dwordx4 a[112:115], v225, s[52:55], s76 offen offset:2048 sc1
    buffer_load_dwordx4 a[116:119], v225, s[52:55], s76 offen offset:3072 sc1
    s_mov_b32 s76, 0x3000
    buffer_load_dwordx4 a[120:123], v225, s[52:55], s76 offen offset:0 sc1
    buffer_load_dwordx4 a[124:127], v225, s[52:55], s76 offen offset:1024 sc1
    s_mov_b32 s76, 0x3000
    buffer_load_dwordx4 a[128:131], v225, s[52:55], s76 offen offset:2048 sc1
    buffer_load_dwordx4 a[132:135], v225, s[52:55], s76 offen offset:3072 sc1
    s_waitcnt vmcnt(27)
    v_mfma_f32_32x32x16_bf16 v[0:15], v[64:67], a[72:75], 0
    v_mfma_f32_32x32x16_bf16 v[16:31], v[68:71], a[72:75], 0
    s_mov_b32 s76, 0x4000
    buffer_load_dwordx4 a[136:139], v225, s[52:55], s76 offen offset:0 sc1
    buffer_load_dwordx4 a[140:143], v225, s[52:55], s76 offen offset:1024 sc1
    s_waitcnt vmcnt(28)
    v_mfma_f32_32x32x16_bf16 v[32:47], v[64:67], a[76:79], 0
    v_mfma_f32_32x32x16_bf16 v[48:63], v[68:71], a[76:79], 0
    s_waitcnt vmcnt(27)
    v_mfma_f32_32x32x16_bf16 v[0:15], v[72:75], a[80:83], v[0:15]
    v_mfma_f32_32x32x16_bf16 v[16:31], v[76:79], a[80:83], v[16:31]
    s_mov_b32 s76, 0x4000
    buffer_load_dwordx4 a[144:147], v225, s[52:55], s76 offen offset:2048 sc1
    buffer_load_dwordx4 a[148:151], v225, s[52:55], s76 offen offset:3072 sc1
    s_waitcnt vmcnt(28)
    v_mfma_f32_32x32x16_bf16 v[32:47], v[72:75], a[84:87], v[32:47]
    v_mfma_f32_32x32x16_bf16 v[48:63], v[76:79], a[84:87], v[48:63]
    s_waitcnt vmcnt(27)
    v_mfma_f32_32x32x16_bf16 v[0:15], v[80:83], a[88:91], v[0:15]
    v_mfma_f32_32x32x16_bf16 v[16:31], v[84:87], a[88:91], v[16:31]
    s_mov_b32 s76, 0x5000
    buffer_load_dwordx4 a[152:155], v225, s[52:55], s76 offen offset:0 sc1
    buffer_load_dwordx4 a[156:159], v225, s[52:55], s76 offen offset:1024 sc1
    s_waitcnt vmcnt(28)
    v_mfma_f32_32x32x16_bf16 v[32:47], v[80:83], a[92:95], v[32:47]
    v_mfma_f32_32x32x16_bf16 v[48:63], v[84:87], a[92:95], v[48:63]
    s_waitcnt vmcnt(27)
    v_mfma_f32_32x32x16_bf16 v[0:15], v[88:91], a[96:99], v[0:15]
    v_mfma_f32_32x32x16_bf16 v[16:31], v[92:95], a[96:99], v[16:31]
    s_mov_b32 s76, 0x5000
    buffer_load_dwordx4 a[160:163], v225, s[52:55], s76 offen offset:2048 sc1
    buffer_load_dwordx4 a[164:167], v225, s[52:55], s76 offen offset:3072 sc1
    s_waitcnt vmcnt(28)
    v_mfma_f32_32x32x16_bf16 v[32:47], v[88:91], a[100:103], v[32:47]
    v_mfma_f32_32x32x16_bf16 v[48:63], v[92:95], a[100:103], v[48:63]
    s_waitcnt vmcnt(15)
    v_mfma_f32_32x32x16_bf16 v[0:15], v[96:99], a[104:107], v[0:15]
    v_mfma_f32_32x32x16_bf16 v[16:31], v[100:103], a[104:107], v[16:31]
    s_mov_b32 s76, 0x6000
    buffer_load_dwordx4 a[168:171], v225, s[52:55], s76 offen offset:0 sc1
    buffer_load_dwordx4 a[172:175], v225, s[52:55], s76 offen offset:1024 sc1
    buffer_load_dwordx2 v[218:219], v216, s[52:55], 0 offen offset:0 sc1
    s_waitcnt vmcnt(17)
    v_mfma_f32_32x32x16_bf16 v[32:47], v[96:99], a[108:111], v[32:47]
    v_mfma_f32_32x32x16_bf16 v[48:63], v[100:103], a[108:111], v[48:63]
    s_waitcnt vmcnt(16)
    v_mfma_f32_32x32x16_bf16 v[0:15], v[104:107], a[112:115], v[0:15]
    v_mfma_f32_32x32x16_bf16 v[16:31], v[108:111], a[112:115], v[16:31]
    s_mov_b32 s76, 0x6000
    buffer_load_dwordx4 a[176:179], v225, s[52:55], s76 offen offset:2048 sc1
    buffer_load_dwordx4 a[180:183], v225, s[52:55], s76 offen offset:3072 sc1
    s_waitcnt vmcnt(17)
    v_mfma_f32_32x32x16_bf16 v[32:47], v[104:107], a[116:119], v[32:47]
    v_mfma_f32_32x32x16_bf16 v[48:63], v[108:111], a[116:119], v[48:63]
    s_waitcnt vmcnt(16)
    v_mfma_f32_32x32x16_bf16 v[0:15], v[112:115], a[120:123], v[0:15]
    v_mfma_f32_32x32x16_bf16 v[16:31], v[116:119], a[120:123], v[16:31]
    s_mov_b32 s76, 0x7000
    buffer_load_dwordx4 a[184:187], v225, s[52:55], s76 offen offset:0 sc1
    buffer_load_dwordx4 a[188:191], v225, s[52:55], s76 offen offset:1024 sc1
    s_waitcnt vmcnt(17)
    v_mfma_f32_32x32x16_bf16 v[32:47], v[112:115], a[124:127], v[32:47]
    v_mfma_f32_32x32x16_bf16 v[48:63], v[116:119], a[124:127], v[48:63]
    s_waitcnt vmcnt(16)
    v_mfma_f32_32x32x16_bf16 v[0:15], v[120:123], a[128:131], v[0:15]
    v_mfma_f32_32x32x16_bf16 v[16:31], v[124:127], a[128:131], v[16:31]
    s_mov_b32 s76, 0x7000
    buffer_load_dwordx4 a[192:195], v225, s[52:55], s76 offen offset:2048 sc1
    buffer_load_dwordx4 a[196:199], v225, s[52:55], s76 offen offset:3072 sc1
    s_waitcnt vmcnt(17)
    v_mfma_f32_32x32x16_bf16 v[32:47], v[120:123], a[132:135], v[32:47]
    v_mfma_f32_32x32x16_bf16 v[48:63], v[124:127], a[132:135], v[48:63]
    s_waitcnt vmcnt(16)
    v_mfma_f32_32x32x16_bf16 v[0:15], a[0:3], a[136:139], v[0:15]
    v_mfma_f32_32x32x16_bf16 v[16:31], a[4:7], a[136:139], v[16:31]
    s_waitcnt vmcnt(6)
    v_cmp_eq_u64 vcc, v[220:221], v[218:219]
    s_nop 0
    s_and_b32 s69, vcc_lo, 0xf0
    s_cmp_eq_u32 s69, 0xf0
    s_cbranch_scc1 L_fl_ok_h0_1
L_fl_loop_h0_1:
    s_sleep 2
    buffer_load_dwordx2 v[218:219], v216, s[52:55], 0 offen sc1
    s_waitcnt vmcnt(0)
    v_cmp_eq_u64 vcc, v[220:221], v[218:219]
    s_add_u32 s84, s84, 1
    s_cmp_gt_u32 s84, 20000
    s_cbranch_scc1 L_fl_ok_h0_1
    s_and_b32 s69, vcc_lo, 0xf0
    s_cmp_eq_u32 s69, 0xf0
    s_cbranch_scc0 L_fl_loop_h0_1
L_fl_ok_h0_1:
    buffer_load_dword v229, v238, s[52:55], 0 offen offset:0 sc1
    buffer_load_dword v231, v238, s[52:55], 0 offen offset:256 sc1
    s_mov_b32 s76, 0x8000
    buffer_load_dwordx4 a[200:203], v225, s[52:55], s76 offen offset:0 sc1
    buffer_load_dwordx4 a[204:207], v225, s[52:55], s76 offen offset:1024 sc1
    v_mfma_f32_32x32x16_bf16 v[32:47], a[0:3], a[140:143], v[32:47]
    v_mfma_f32_32x32x16_bf16 v[48:63], a[4:7], a[140:143], v[48:63]
    v_mfma_f32_32x32x16_bf16 v[0:15], a[8:11], a[144:147], v[0:15]
    v_mfma_f32_32x32x16_bf16 v[16:31], a[12:15], a[144:147], v[16:31]
    s_mov_b32 s76, 0x8000
    buffer_load_dwordx4 a[208:211], v225, s[52:55], s76 offen offset:2048 sc1
    buffer_load_dwordx4 a[212:215], v225, s[52:55], s76 offen offset:3072 sc1
    v_mfma_f32_32x32x16_bf16 v[32:47], a[8:11], a[148:151], v[32:47]
    v_mfma_f32_32x32x16_bf16 v[48:63], a[12:15], a[148:151], v[48:63]
    v_mfma_f32_32x32x16_bf16 v[0:15], a[16:19], a[152:155], v[0:15]
    v_mfma_f32_32x32x16_bf16 v[16:31], a[20:23], a[152:155], v[16:31]
    s_mov_b32 s76, 0x9000
    buffer_load_dwordx4 a[216:219], v225, s[52:55], s76 offen offset:0 sc1
    buffer_load_dwordx4 a[220:223], v225, s[52:55], s76 offen offset:1024 sc1
    v_mfma_f32_32x32x16_bf16 v[32:47], a[16:19], a[156:159], v[32:47]
    v_mfma_f32_32x32x16_bf16 v[48:63], a[20:23], a[156:159], v[48:63]
    v_mfma_f32_32x32x16_bf16 v[0:15], a[24:27], a[160:163], v[0:15]
    v_mfma_f32_32x32x16_bf16 v[16:31], a[28:31], a[160:163], v[16:31]
    s_mov_b32 s76, 0x9000
    buffer_load_dwordx4 a[224:227], v225, s[52:55], s76 offen offset:2048 sc1
    buffer_load_dwordx4 a[228:231], v225, s[52:55], s76 offen offset:3072 sc1
    v_mfma_f32_32x32x16_bf16 v[32:47], a[24:27], a[164:167], v[32:47]
    v_mfma_f32_32x32x16_bf16 v[48:63], a[28:31], a[164:167], v[48:63]
    v_mfma_f32_32x32x16_bf16 v[0:15], a[32:35], a[168:171], v[0:15]
    v_mfma_f32_32x32x16_bf16 v[16:31], a[36:39], a[168:171], v[16:31]
    s_mov_b32 s76, 0xa000
    buffer_load_dwordx4 a[232:235], v225, s[52:55], s76 offen offset:0 sc1
    buffer_load_dwordx4 a[236:239], v225, s[52:55], s76 offen offset:1024 sc1
    buffer_load_dwordx2 v[218:219], v216, s[52:55], 0 offen offset:0 sc1
    v_mfma_f32_32x32x16_bf16 v[32:47], a[32:35], a[172:175], v[32:47]
    v_mfma_f32_32x32x16_bf16 v[48:63], a[36:39], a[172:175], v[48:63]
    s_waitcnt vmcnt(18)
    v_mfma_f32_32x32x16_bf16 v[0:15], a[40:43], a[176:179], v[0:15]
    v_mfma_f32_32x32x16_bf16 v[16:31], a[44:47], a[176:179], v[16:31]
    s_mov_b32 s76, 0xa000
    buffer_load_dwordx4 a[240:243], v225, s[52:55], s76 offen offset:2048 sc1
    buffer_load_dwordx4 a[244:247], v225, s[52:55], s76 offen offset:3072 sc1
    s_waitcnt vmcnt(19)
    v_mfma_f32_32x32x16_bf16 v[32:47], a[40:43], a[180:183], v[32:47]
    v_mfma_f32_32x32x16_bf16 v[48:63], a[44:47], a[180:183], v[48:63]
    s_waitcnt vmcnt(18)
    v_mfma_f32_32x32x16_bf16 v[0:15], a[48:51], a[184:187], v[0:15]
    v_mfma_f32_32x32x16_bf16 v[16:31], a[52:55], a[184:187], v[16:31]
    s_mov_b32 s76, 0xb000
    buffer_load_dwordx4 a[248:251], v225, s[52:55], s76 offen offset:0 sc1
    buffer_load_dwordx4 a[252:255], v225, s[52:55], s76 offen offset:1024 sc1
    s_waitcnt vmcnt(19)
    v_mfma_f32_32x32x16_bf16 v[32:47], a[48:51], a[188:191], v[32:47]
    v_mfma_f32_32x32x16_bf16 v[48:63], a[52:55], a[188:191], v[48:63]
    s_waitcnt vmcnt(18)
    v_mfma_f32_32x32x16_bf16 v[0:15], a[56:59], a[192:195], v[0:15]
    v_mfma_f32_32x32x16_bf16 v[16:31], a[60:63], a[192:195], v[16:31]
    s_mov_b32 s76, 0xb000
    buffer_load_dwordx4 a[72:75], v225, s[52:55], s76 offen offset:2048 sc1
    buffer_load_dwordx4 a[76:79], v225, s[52:55], s76 offen offset:3072 sc1
    s_waitcnt vmcnt(19)
    v_mfma_f32_32x32x16_bf16 v[32:47], a[56:59], a[196:199], v[32:47]
    v_mfma_f32_32x32x16_bf16 v[48:63], a[60:63], a[196:199], v[48:63]
    s_waitcnt vmcnt(16)
    v_mfma_f32_32x32x16_bf16 v[64:79], a[64:67], a[200:203], 0
    ds_read_b64_tr_b16 v[144:145], v232 offset:6144
    ds_read_b64_tr_b16 v[146:147], v232 offset:7168
    ds_read_b64_tr_b16 v[148:149], v233 offset:6144
    ds_read_b64_tr_b16 v[150:151], v233 offset:7168
    v_mfma_f32_32x32x16_bf16 v[80:95], a[68:71], a[200:203], 0
    s_waitcnt vmcnt(6)
    v_cmp_eq_u64 vcc, v[220:221], v[218:219]
    s_nop 0
    s_and_b32 s69, vcc_lo, 0xff00
    s_cmp_eq_u32 s69, 0xff00
    s_cbranch_scc1 L_fl_ok_h0_2
L_fl_loop_h0_2:
    s_sleep 2
    buffer_load_dwordx2 v[218:219], v216, s[52:55], 0 offen sc1
    s_waitcnt vmcnt(0)
    v_cmp_eq_u64 vcc, v[220:221], v[218:219]
    s_add_u32 s84, s84, 1
    s_cmp_gt_u32 s84, 20000
    s_cbranch_scc1 L_fl_ok_h0_2
    s_and_b32 s69, vcc_lo, 0xff00
    s_cmp_eq_u32 s69, 0xff00
    s_cbranch_scc0 L_fl_loop_h0_2
L_fl_ok_h0_2:
    s_mov_b32 s76, 0xc000
    buffer_load_dwordx4 a[80:83], v225, s[52:55], s76 offen offset:0 sc1
    buffer_load_dwordx4 a[84:87], v225, s[52:55], s76 offen offset:1024 sc1
    v_mfma_f32_32x32x16_bf16 v[96:111], a[64:67], a[204:207], 0
    v_mfma_f32_32x32x16_bf16 v[112:127], a[68:71], a[204:207], 0
    s_waitcnt lgkmcnt(2)
    v_mfma_f32_32x32x16_bf16 v[64:79], v[144:147], a[208:211], v[64:79]
    ds_read_b64_tr_b16 v[136:137], v232 offset:8192
    ds_read_b64_tr_b16 v[138:139], v232 offset:9216
    ds_read_b64_tr_b16 v[140:141], v233 offset:8192
    ds_read_b64_tr_b16 v[142:143], v233 offset:9216
    s_waitcnt lgkmcnt(4)
    v_mfma_f32_32x32x16_bf16 v[80:95], v[148:151], a[208:211], v[80:95]
    s_mov_b32 s76, 0xc000
    buffer_load_dwordx4 a[88:91], v225, s[52:55], s76 offen offset:2048 sc1
    buffer_load_dwordx4 a[92:95], v225, s[52:55], s76 offen offset:3072 sc1
    v_mfma_f32_32x32x16_bf16 v[96:111], v[144:147], a[212:215], v[96:111]
    v_mfma_f32_32x32x16_bf16 v[112:127], v[148:151], a[212:215], v[112:127]
    s_waitcnt lgkmcnt(2)
    v_mfma_f32_32x32x16_bf16 v[64:79], v[136:139], a[216:219], v[64:79]
    ds_read_b64_tr_b16 v[144:145], v232 offset:10240
    ds_read_b64_tr_b16 v[146:147], v232 offset:11264
    ds_read_b64_tr_b16 v[148:149], v233 offset:10240
    ds_read_b64_tr_b16 v[150:151], v233 offset:11264
    s_waitcnt lgkmcnt(4)
    v_mfma_f32_32x32x16_bf16 v[80:95], v[140:143], a[216:219], v[80:95]
    s_mov_b32 s76, 0xd000
    buffer_load_dwordx4 a[96:99], v225, s[52:55], s76 offen offset:0 sc1
    buffer_load_dwordx4 a[100:103], v225, s[52:55], s76 offen offset:1024 sc1
    v_mfma_f32_32x32x16_bf16 v[96:111], v[136:139], a[220:223], v[96:111]
    v_mfma_f32_32x32x16_bf16 v[112:127], v[140:143], a[220:223], v[112:127]
    s_waitcnt lgkmcnt(2)
    v_mfma_f32_32x32x16_bf16 v[64:79], v[144:147], a[224:227], v[64:79]
    ds_read_b64_tr_b16 v[136:137], v232 offset:12288
    ds_read_b64_tr_b16 v[138:139], v232 offset:13312
    ds_read_b64_tr_b16 v[140:141], v233 offset:12288
    ds_read_b64_tr_b16 v[142:143], v233 offset:13312
    s_waitcnt lgkmcnt(4)
    v_mfma_f32_32x32x16_bf16 v[80:95], v[148:151], a[224:227], v[80:95]
    s_mov_b32 s76, 0xd000
    buffer_load_dwordx4 a[104:107], v225, s[52:55], s76 offen offset:2048 sc1
    buffer_load_dwordx4 a[108:111], v225, s[52:55], s76 offen offset:3072 sc1
    v_mfma_f32_32x32x16_bf16 v[96:111], v[144:147], a[228:231], v[96:111]
    v_mfma_f32_32x32x16_bf16 v[112:127], v[148:151], a[228:231], v[112:127]
    s_waitcnt lgkmcnt(2)
    v_mfma_f32_32x32x16_bf16 v[64:79], v[136:139], a[232:235], v[64:79]
    ds_read_b64_tr_b16 v[144:145], v232 offset:14336
    ds_read_b64_tr_b16 v[146:147], v232 offset:15360
    ds_read_b64_tr_b16 v[148:149], v233 offset:14336
    ds_read_b64_tr_b16 v[150:151], v233 offset:15360
    s_waitcnt lgkmcnt(4)
    v_mfma_f32_32x32x16_bf16 v[80:95], v[140:143], a[232:235], v[80:95]
    s_mov_b32 s76, 0xe000
    buffer_load_dwordx4 a[112:115], v225, s[52:55], s76 offen offset:0 sc1
    buffer_load_dwordx4 a[116:119], v225, s[52:55], s76 offen offset:1024 sc1
    v_mfma_f32_32x32x16_bf16 v[96:111], v[136:139], a[236:239], v[96:111]
    v_mfma_f32_32x32x16_bf16 v[112:127], v[140:143], a[236:239], v[112:127]
    s_waitcnt vmcnt(15) lgkmcnt(2)
    v_mfma_f32_32x32x16_bf16 v[64:79], v[144:147], a[240:243], v[64:79]
    ds_read_b64_tr_b16 v[136:137], v232 offset:16384
    ds_read_b64_tr_b16 v[138:139], v232 offset:17408
    ds_read_b64_tr_b16 v[140:141], v233 offset:16384
    ds_read_b64_tr_b16 v[142:143], v233 offset:17408
    s_waitcnt lgkmcnt(4)
    v_mfma_f32_32x32x16_bf16 v[80:95], v[148:151], a[240:243], v[80:95]
    s_mov_b32 s76, 0xe000
    buffer_load_dwordx4 a[120:123], v225, s[52:55], s76 offen offset:2048 sc1
    buffer_load_dwordx4 a[124:127], v225, s[52:55], s76 offen offset:3072 sc1
    s_waitcnt vmcnt(16)
    v_mfma_f32_32x32x16_bf16 v[96:111], v[144:147], a[244:247], v[96:111]
    v_mfma_f32_32x32x16_bf16 v[112:127], v[148:151], a[244:247], v[112:127]
    s_waitcnt vmcnt(15) lgkmcnt(2)
    v_mfma_f32_32x32x16_bf16 v[64:79], v[136:139], a[248:251], v[64:79]
    ds_read_b64_tr_b16 v[144:145], v232 offset:18432
    ds_read_b64_tr_b16 v[146:147], v232 offset:19456
    ds_read_b64_tr_b16 v[148:149], v233 offset:18432
    ds_read_b64_tr_b16 v[150:151], v233 offset:19456
    s_waitcnt lgkmcnt(4)
    v_mfma_f32_32x32x16_bf16 v[80:95], v[140:143], a[248:251], v[80:95]
    s_mov_b32 s76, 0xf000
    buffer_load_dwordx4 a[128:131], v225, s[52:55], s76 offen offset:0 sc1
    buffer_load_dwordx4 a[132:135], v225, s[52:55], s76 offen offset:1024 sc1
    s_waitcnt vmcnt(16)
    v_mfma_f32_32x32x16_bf16 v[96:111], v[136:139], a[252:255], v[96:111]
    v_mfma_f32_32x32x16_bf16 v[112:127], v[140:143], a[252:255], v[112:127]
    s_waitcnt vmcnt(15) lgkmcnt(2)
    v_mfma_f32_32x32x16_bf16 v[64:79], v[144:147], a[72:75], v[64:79]
    ds_read_b64_tr_b16 v[136:137], v232 offset:20480
    ds_read_b64_tr_b16 v[138:139], v232 offset:21504
    ds_read_b64_tr_b16 v[140:141], v233 offset:20480
    ds_read_b64_tr_b16 v[142:143], v233 offset:21504
    s_waitcnt lgkmcnt(4)
    v_mfma_f32_32x32x16_bf16 v[80:95], v[148:151], a[72:75], v[80:95]
    s_mov_b32 s76, 0xf000
    buffer_load_dwordx4 a[136:139], v225, s[52:55], s76 offen offset:2048 sc1
    buffer_load_dwordx4 a[140:143], v225, s[52:55], s76 offen offset:3072 sc1
    s_waitcnt vmcnt(16)
    v_mfma_f32_32x32x16_bf16 v[96:111], v[144:147], a[76:79], v[96:111]
    v_mfma_f32_32x32x16_bf16 v[112:127], v[148:151], a[76:79], v[112:127]
    s_waitcnt vmcnt(15) lgkmcnt(2)
    v_mfma_f32_32x32x16_bf16 v[0:15], v[136:139], a[80:83], v[0:15]
    ds_read_b64_tr_b16 v[144:145], v232 offset:22528
    ds_read_b64_tr_b16 v[146:147], v232 offset:23552
    ds_read_b64_tr_b16 v[148:149], v233 offset:22528
    ds_read_b64_tr_b16 v[150:151], v233 offset:23552
    s_waitcnt lgkmcnt(4)
    v_mfma_f32_32x32x16_bf16 v[16:31], v[140:143], a[80:83], v[16:31]
    s_mov_b32 s76, 0x10000
    buffer_load_dwordx4 a[144:147], v225, s[52:55], s76 offen offset:0 sc1
    buffer_load_dwordx4 a[148:151], v225, s[52:55], s76 offen offset:1024 sc1
    s_waitcnt vmcnt(16)
    v_mfma_f32_32x32x16_bf16 v[32:47], v[136:139], a[84:87], v[32:47]
    v_mfma_f32_32x32x16_bf16 v[48:63], v[140:143], a[84:87], v[48:63]
    s_waitcnt vmcnt(15) lgkmcnt(2)
    v_mfma_f32_32x32x16_bf16 v[0:15], v[144:147], a[88:91], v[0:15]
    ds_read_b64_tr_b16 v[136:137], v234 offset:0
    ds_read_b64_tr_b16 v[138:139], v234 offset:1024
    ds_read_b64_tr_b16 v[140:141], v235 offset:0
    ds_read_b64_tr_b16 v[142:143], v235 offset:1024
    s_waitcnt lgkmcnt(4)
    v_mfma_f32_32x32x16_bf16 v[16:31], v[148:151], a[88:91], v[16:31]
    s_mov_b32 s76, 0x10000
    buffer_load_dwordx4 a[152:155], v225, s[52:55], s76 offen offset:2048 sc1
    buffer_load_dwordx4 a[156:159], v225, s[52:55], s76 offen offset:3072 sc1
    s_waitcnt vmcnt(16)
    v_mfma_f32_32x32x16_bf16 v[32:47], v[144:147], a[92:95], v[32:47]
    v_sub_f32 v208, 1.0, v229
    v_sub_f32 v209, 1.0, v231
    v_mul_f32 v64, v64, v229
    v_mul_f32 v65, v65, v229
    v_mfma_f32_32x32x16_bf16 v[48:63], v[148:151], a[92:95], v[48:63]
    v_mul_f32 v66, v66, v229
    v_mul_f32 v67, v67, v229
    v_mul_f32 v68, v68, v229
    v_mul_f32 v69, v69, v229
    s_waitcnt vmcnt(15) lgkmcnt(2)
    v_mfma_f32_32x32x16_bf16 v[0:15], v[136:139], a[96:99], v[0:15]
    ds_read_b64_tr_b16 v[144:145], v232 offset:0
    ds_read_b64_tr_b16 v[146:147], v232 offset:1024
    ds_read_b64_tr_b16 v[148:149], v233 offset:0
    ds_read_b64_tr_b16 v[150:151], v233 offset:1024
    s_waitcnt lgkmcnt(4)
    v_mfma_f32_32x32x16_bf16 v[16:31], v[140:143], a[96:99], v[16:31]
    s_mov_b32 s76, 0x11000
    buffer_load_dwordx4 a[160:163], v225, s[52:55], s76 offen offset:0 sc1
    buffer_load_dwordx4 a[164:167], v225, s[52:55], s76 offen offset:1024 sc1
    s_waitcnt vmcnt(16)
    v_mfma_f32_32x32x16_bf16 v[32:47], v[136:139], a[100:103], v[32:47]
    v_mul_f32 v70, v70, v229
    v_mul_f32 v71, v71, v229
    v_mul_f32 v72, v72, v229
    v_mul_f32 v73, v73, v229
    v_mfma_f32_32x32x16_bf16 v[48:63], v[140:143], a[100:103], v[48:63]
    v_mul_f32 v74, v74, v229
    v_mul_f32 v75, v75, v229
    v_mul_f32 v76, v76, v229
    v_mul_f32 v77, v77, v229
    s_waitcnt vmcnt(15) lgkmcnt(2)
    v_mfma_f32_32x32x16_bf16 v[0:15], v[144:147], a[104:107], v[0:15]
    ds_read_b64_tr_b16 v[136:137], v232 offset:2048
    ds_read_b64_tr_b16 v[138:139], v232 offset:3072
    ds_read_b64_tr_b16 v[140:141], v233 offset:2048
    ds_read_b64_tr_b16 v[142:143], v233 offset:3072
    s_waitcnt lgkmcnt(4)
    v_mfma_f32_32x32x16_bf16 v[16:31], v[148:151], a[104:107], v[16:31]
    s_mov_b32 s76, 0x11000
    buffer_load_dwordx4 a[168:171], v225, s[52:55], s76 offen offset:2048 sc1
    buffer_load_dwordx4 a[172:175], v225, s[52:55], s76 offen offset:3072 sc1
    s_waitcnt vmcnt(16)
    v_mfma_f32_32x32x16_bf16 v[32:47], v[144:147], a[108:111], v[32:47]
    v_mul_f32 v78, v78, v229
    v_mul_f32 v79, v79, v229
    v_mul_f32 v80, v80, v229
    v_mul_f32 v81, v81, v229
    v_mfma_f32_32x32x16_bf16 v[48:63], v[148:151], a[108:111], v[48:63]
    v_mul_f32 v82, v82, v229
    v_mul_f32 v83, v83, v229
    v_mul_f32 v84, v84, v229
    v_mul_f32 v85, v85, v229
    s_waitcnt vmcnt(15) lgkmcnt(2)
    v_mfma_f32_32x32x16_bf16 v[0:15], v[136:139], a[112:115], v[0:15]
    ds_read_b64_tr_b16 v[144:145], v232 offset:4096
    ds_read_b64_tr_b16 v[146:147], v232 offset:5120
    ds_read_b64_tr_b16 v[148:149], v233 offset:4096
    ds_read_b64_tr_b16 v[150:151], v233 offset:5120
    s_waitcnt lgkmcnt(4)
    v_mfma_f32_32x32x16_bf16 v[16:31], v[140:143], a[112:115], v[16:31]
    s_waitcnt vmcnt(14)
    v_mfma_f32_32x32x16_bf16 v[32:47], v[136:139], a[116:119], v[32:47]
    v_mul_f32 v86, v86, v229
    v_mul_f32 v87, v87, v229
    v_mul_f32 v88, v88, v229
    v_mul_f32 v89, v89, v229
    v_mfma_f32_32x32x16_bf16 v[48:63], v[140:143], a[116:119], v[48:63]
    v_mul_f32 v90, v90, v229
    v_mul_f32 v91, v91, v229
    v_mul_f32 v92, v92, v229
    v_mul_f32 v93, v93, v229
    s_waitcnt vmcnt(13) lgkmcnt(2)
    v_mfma_f32_32x32x16_bf16 v[0:15], v[144:147], a[120:123], v[0:15]
    ds_read_b64_tr_b16 v[136:137], v236 offset:0
    ds_read_b64_tr_b16 v[138:139], v236 offset:1024
    ds_read_b64_tr_b16 v[140:141], v237 offset:0
    ds_read_b64_tr_b16 v[142:143], v237 offset:1024
    s_waitcnt lgkmcnt(4)
    v_mfma_f32_32x32x16_bf16 v[16:31], v[148:151], a[120:123], v[16:31]
    s_waitcnt vmcnt(12)
    v_mfma_f32_32x32x16_bf16 v[32:47], v[144:147], a[124:127], v[32:47]
    v_mul_f32 v94, v94, v229
    v_mul_f32 v95, v95, v229
    v_mul_f32 v96, v96, v231
    v_mul_f32 v97, v97, v231
    v_mfma_f32_32x32x16_bf16 v[48:63], v[148:151], a[124:127], v[48:63]
    v_mul_f32 v98, v98, v231
    v_mul_f32 v99, v99, v231
    v_mul_f32 v100, v100, v231
    v_mul_f32 v101, v101, v231
    s_waitcnt vmcnt(11) lgkmcnt(2)
    v_mfma_f32_32x32x16_bf16 v[0:15], v[136:139], a[128:131], v[0:15]
    ds_read_b64_tr_b16 v[144:145], v236 offset:2048
    ds_read_b64_tr_b16 v[146:147], v236 offset:3072
    ds_read_b64_tr_b16 v[148:149], v237 offset:2048
    ds_read_b64_tr_b16 v[150:151], v237 offset:3072
    s_waitcnt lgkmcnt(4)
    v_mfma_f32_32x32x16_bf16 v[16:31], v[140:143], a[128:131], v[16:31]
    s_waitcnt vmcnt(10)
    v_mfma_f32_32x32x16_bf16 v[32:47], v[136:139], a[132:135], v[32:47]
    v_mul_f32 v102, v102, v231
    v_mul_f32 v103, v103, v231
    v_mul_f32 v104, v104, v231
    v_mul_f32 v105, v105, v231
    v_mfma_f32_32x32x16_bf16 v[48:63], v[140:143], a[132:135], v[48:63]
    v_mul_f32 v106, v106, v231
    v_mul_f32 v107, v107, v231
    v_mul_f32 v108, v108, v231
    v_mul_f32 v109, v109, v231
    s_waitcnt vmcnt(9) lgkmcnt(2)
    v_mfma_f32_32x32x16_bf16 v[0:15], v[144:147], a[136:139], v[0:15]
    ds_read_b64_tr_b16 v[136:137], v236 offset:4096
    ds_read_b64_tr_b16 v[138:139], v236 offset:5120
    ds_read_b64_tr_b16 v[140:141], v237 offset:4096
    ds_read_b64_tr_b16 v[142:143], v237 offset:5120
    s_waitcnt lgkmcnt(4)
    v_mfma_f32_32x32x16_bf16 v[16:31], v[148:151], a[136:139], v[16:31]
    s_waitcnt vmcnt(8)
    v_mfma_f32_32x32x16_bf16 v[32:47], v[144:147], a[140:143], v[32:47]
    v_mul_f32 v110, v110, v231
    v_mul_f32 v111, v111, v231
    v_mul_f32 v112, v112, v231
    v_mul_f32 v113, v113, v231
    v_mfma_f32_32x32x16_bf16 v[48:63], v[148:151], a[140:143], v[48:63]
    v_mul_f32 v114, v114, v231
    v_mul_f32 v115, v115, v231
    v_mul_f32 v116, v116, v231
    v_mul_f32 v117, v117, v231
    s_waitcnt vmcnt(7) lgkmcnt(2)
    v_mfma_f32_32x32x16_bf16 v[0:15], v[136:139], a[144:147], v[0:15]
    ds_read_b64_tr_b16 v[144:145], v236 offset:6144
    ds_read_b64_tr_b16 v[146:147], v236 offset:7168
    ds_read_b64_tr_b16 v[148:149], v237 offset:6144
    ds_read_b64_tr_b16 v[150:151], v237 offset:7168
    s_waitcnt lgkmcnt(4)
    v_mfma_f32_32x32x16_bf16 v[16:31], v[140:143], a[144:147], v[16:31]
    s_waitcnt vmcnt(6)
    v_mfma_f32_32x32x16_bf16 v[32:47], v[136:139], a[148:151], v[32:47]
    v_mul_f32 v118, v118, v231
    v_mul_f32 v119, v119, v231
    v_mul_f32 v120, v120, v231
    v_mul_f32 v121, v121, v231
    v_mfma_f32_32x32x16_bf16 v[48:63], v[140:143], a[148:151], v[48:63]
    v_mul_f32 v122, v122, v231
    v_mul_f32 v123, v123, v231
    v_mul_f32 v124, v124, v231
    v_mul_f32 v125, v125, v231
    s_waitcnt vmcnt(5) lgkmcnt(2)
    v_mfma_f32_32x32x16_bf16 v[0:15], v[144:147], a[152:155], v[0:15]
    ds_read_b64_tr_b16 v[136:137], v236 offset:8192
    ds_read_b64_tr_b16 v[138:139], v236 offset:9216
    ds_read_b64_tr_b16 v[140:141], v237 offset:8192
    ds_read_b64_tr_b16 v[142:143], v237 offset:9216
    s_waitcnt lgkmcnt(4)
    v_mfma_f32_32x32x16_bf16 v[16:31], v[148:151], a[152:155], v[16:31]
    s_waitcnt vmcnt(4)
    v_mfma_f32_32x32x16_bf16 v[32:47], v[144:147], a[156:159], v[32:47]
    v_mul_f32 v126, v126, v231
    v_mul_f32 v127, v127, v231
    v_mfma_f32_32x32x16_bf16 v[48:63], v[148:151], a[156:159], v[48:63]
    s_waitcnt vmcnt(3) lgkmcnt(2)
    v_mfma_f32_32x32x16_bf16 v[0:15], v[136:139], a[160:163], v[0:15]
    ds_read_b64_tr_b16 v[144:145], v236 offset:10240
    ds_read_b64_tr_b16 v[146:147], v236 offset:11264
    ds_read_b64_tr_b16 v[148:149], v237 offset:10240
    ds_read_b64_tr_b16 v[150:151], v237 offset:11264
    s_waitcnt lgkmcnt(4)
    v_mfma_f32_32x32x16_bf16 v[16:31], v[140:143], a[160:163], v[16:31]
    s_waitcnt vmcnt(2)
    v_mfma_f32_32x32x16_bf16 v[32:47], v[136:139], a[164:167], v[32:47]
    v_mfma_f32_32x32x16_bf16 v[48:63], v[140:143], a[164:167], v[48:63]
    s_waitcnt vmcnt(1) lgkmcnt(2)
    v_mfma_f32_32x32x16_bf16 v[0:15], v[144:147], a[168:171], v[0:15]
    s_waitcnt lgkmcnt(0)
    v_mfma_f32_32x32x16_bf16 v[16:31], v[148:151], a[168:171], v[16:31]
    s_waitcnt vmcnt(0)
    v_mfma_f32_32x32x16_bf16 v[32:47], v[144:147], a[172:175], v[32:47]
    v_mfma_f32_32x32x16_bf16 v[48:63], v[148:151], a[172:175], v[48:63]
    s_cmp_eq_u32 s60, 0
    s_cbranch_scc0 L_red_h0_1
    s_nop 6
    v_fmac_f32 v80, v16, v208
    v_fmac_f32 v81, v17, v208
    v_fmac_f32 v82, v18, v208
    v_fmac_f32 v83, v19, v208
    v_fmac_f32 v84, v20, v208
    v_fmac_f32 v85, v21, v208
    v_fmac_f32 v86, v22, v208
    v_fmac_f32 v87, v23, v208
    v_fmac_f32 v88, v24, v208
    v_fmac_f32 v89, v25, v208
    v_fmac_f32 v90, v26, v208
    v_fmac_f32 v91, v27, v208
    v_fmac_f32 v92, v28, v208
    v_fmac_f32 v93, v29, v208
    v_fmac_f32 v94, v30, v208
    v_fmac_f32 v95, v31, v208
    ds_write_b128 v226, v[80:83] offset:0
    ds_write_b128 v226, v[84:87] offset:1024
    ds_write_b128 v226, v[88:91] offset:2048
    ds_write_b128 v226, v[92:95] offset:3072
    v_fmac_f32 v96, v32, v209
    v_fmac_f32 v97, v33, v209
    v_fmac_f32 v98, v34, v209
    v_fmac_f32 v99, v35, v209
    v_fmac_f32 v100, v36, v209
    v_fmac_f32 v101, v37, v209
    v_fmac_f32 v102, v38, v209
    v_fmac_f32 v103, v39, v209
    v_fmac_f32 v104, v40, v209
    v_fmac_f32 v105, v41, v209
    v_fmac_f32 v106, v42, v209
    v_fmac_f32 v107, v43, v209
    v_fmac_f32 v108, v44, v209
    v_fmac_f32 v109, v45, v209
    v_fmac_f32 v110, v46, v209
    v_fmac_f32 v111, v47, v209
    ds_write_b128 v226, v[96:99] offset:4096
    ds_write_b128 v226, v[100:103] offset:5120
    ds_write_b128 v226, v[104:107] offset:6144
    ds_write_b128 v226, v[108:111] offset:7168
    v_fmac_f32 v112, v48, v209
    v_fmac_f32 v113, v49, v209
    v_fmac_f32 v114, v50, v209
    v_fmac_f32 v115, v51, v209
    v_fmac_f32 v116, v52, v209
    v_fmac_f32 v117, v53, v209
    v_fmac_f32 v118, v54, v209
    v_fmac_f32 v119, v55, v209
    v_fmac_f32 v120, v56, v209
    v_fmac_f32 v121, v57, v209
    v_fmac_f32 v122, v58, v209
    v_fmac_f32 v123, v59, v209
    v_fmac_f32 v124, v60, v209
    v_fmac_f32 v125, v61, v209
    v_fmac_f32 v126, v62, v209
    v_fmac_f32 v127, v63, v209
    ds_write_b128 v226, v[112:115] offset:8192
    ds_write_b128 v226, v[116:119] offset:9216
    ds_write_b128 v226, v[120:123] offset:10240
    ds_write_b128 v226, v[124:127] offset:11264
    v_fmac_f32 v64, v0, v208
    v_fmac_f32 v65, v1, v208
    v_fmac_f32 v66, v2, v208
    v_fmac_f32 v67, v3, v208
    v_fmac_f32 v68, v4, v208
    v_fmac_f32 v69, v5, v208
    v_fmac_f32 v70, v6, v208
    v_fmac_f32 v71, v7, v208
    v_fmac_f32 v72, v8, v208
    v_fmac_f32 v73, v9, v208
    v_fmac_f32 v74, v10, v208
    v_fmac_f32 v75, v11, v208
    v_fmac_f32 v76, v12, v208
    v_fmac_f32 v77, v13, v208
    v_fmac_f32 v78, v14, v208
    v_fmac_f32 v79, v15, v208
    s_waitcnt lgkmcnt(0)
    s_barrier
    ds_read_b128 v[0:3], v227 offset:20480
    ds_read_b128 v[4:7], v227 offset:21504
    ds_read_b128 v[8:11], v227 offset:22528
    ds_read_b128 v[12:15], v227 offset:23552
    ds_read_b128 v[16:19], v227 offset:28672
    ds_read_b128 v[20:23], v227 offset:29696
    ds_read_b128 v[24:27], v227 offset:30720
    ds_read_b128 v[28:31], v227 offset:31744
    ds_read_b128 v[32:35], v227 offset:36864
    ds_read_b128 v[36:39], v227 offset:37888
    ds_read_b128 v[40:43], v227 offset:38912
    ds_read_b128 v[44:47], v227 offset:39936
    s_waitcnt lgkmcnt(11)
    v_add_f32 v64, v64, v0
    v_add_f32 v65, v65, v1
    v_add_f32 v66, v66, v2
    v_add_f32 v67, v67, v3
    s_waitcnt lgkmcnt(10)
    v_add_f32 v68, v68, v4
    v_add_f32 v69, v69, v5
    v_add_f32 v70, v70, v6
    v_add_f32 v71, v71, v7
    s_waitcnt lgkmcnt(9)
    v_add_f32 v72, v72, v8
    v_add_f32 v73, v73, v9
    v_add_f32 v74, v74, v10
    v_add_f32 v75, v75, v11
    s_waitcnt lgkmcnt(8)
    v_add_f32 v76, v76, v12
    v_add_f32 v77, v77, v13
    v_add_f32 v78, v78, v14
    v_add_f32 v79, v79, v15
    s_waitcnt lgkmcnt(7)
    v_add_f32 v64, v64, v16
    v_add_f32 v65, v65, v17
    v_add_f32 v66, v66, v18
    v_add_f32 v67, v67, v19
    s_waitcnt lgkmcnt(6)
    v_add_f32 v68, v68, v20
    v_add_f32 v69, v69, v21
    v_add_f32 v70, v70, v22
    v_add_f32 v71, v71, v23
    s_waitcnt lgkmcnt(5)
    v_add_f32 v72, v72, v24
    v_add_f32 v73, v73, v25
    v_add_f32 v74, v74, v26
    v_add_f32 v75, v75, v27
    s_waitcnt lgkmcnt(4)
    v_add_f32 v76, v76, v28
    v_add_f32 v77, v77, v29
    v_add_f32 v78, v78, v30
    v_add_f32 v79, v79, v31
    s_waitcnt lgkmcnt(3)
    v_add_f32 v64, v64, v32
    v_add_f32 v65, v65, v33
    v_add_f32 v66, v66, v34
    v_add_f32 v67, v67, v35
    s_waitcnt lgkmcnt(2)
    v_add_f32 v68, v68, v36
    v_add_f32 v69, v69, v37
    v_add_f32 v70, v70, v38
    v_add_f32 v71, v71, v39
    s_waitcnt lgkmcnt(1)
    v_add_f32 v72, v72, v40
    v_add_f32 v73, v73, v41
    v_add_f32 v74, v74, v42
    v_add_f32 v75, v75, v43
    s_waitcnt lgkmcnt(0)
    v_add_f32 v76, v76, v44
    v_add_f32 v77, v77, v45
    v_add_f32 v78, v78, v46
    v_add_f32 v79, v79, v47
    v_cvt_pk_bf16_f32 v64, v64, v65
    v_cvt_pk_bf16_f32 v65, v66, v67
    v_cvt_pk_bf16_f32 v66, v68, v69
    v_cvt_pk_bf16_f32 v67, v70, v71
    v_cvt_pk_bf16_f32 v68, v72, v73
    v_cvt_pk_bf16_f32 v69, v74, v75
    v_cvt_pk_bf16_f32 v70, v76, v77
    v_cvt_pk_bf16_f32 v71, v78, v79
    buffer_store_dwordx4 v[64:67], v228, s[48:51], 0 offen offset:0
    buffer_store_dwordx4 v[68:71], v228, s[48:51], 0 offen offset:16
    s_branch L_fin_h0
L_red_h0_1:
    s_cmp_eq_u32 s60, 1
    s_cbranch_scc0 L_red_h0_2
    s_nop 8
    v_fmac_f32 v96, v32, v209
    v_fmac_f32 v97, v33, v209
    v_fmac_f32 v98, v34, v209
    v_fmac_f32 v99, v35, v209
    v_fmac_f32 v100, v36, v209
    v_fmac_f32 v101, v37, v209
    v_fmac_f32 v102, v38, v209
    v_fmac_f32 v103, v39, v209
    v_fmac_f32 v104, v40, v209
    v_fmac_f32 v105, v41, v209
    v_fmac_f32 v106, v42, v209
    v_fmac_f32 v107, v43, v209
    v_fmac_f32 v108, v44, v209
    v_fmac_f32 v109, v45, v209
    v_fmac_f32 v110, v46, v209
    v_fmac_f32 v111, v47, v209
    ds_write_b128 v226, v[96:99] offset:0
    ds_write_b128 v226, v[100:103] offset:1024
    ds_write_b128 v226, v[104:107] offset:2048
    ds_write_b128 v226, v[108:111] offset:3072
    v_fmac_f32 v112, v48, v209
    v_fmac_f32 v113, v49, v209
    v_fmac_f32 v114, v50, v209
    v_fmac_f32 v115, v51, v209
    v_fmac_f32 v116, v52, v209
    v_fmac_f32 v117, v53, v209
    v_fmac_f32 v118, v54, v209
    v_fmac_f32 v119, v55, v209
    v_fmac_f32 v120, v56, v209
    v_fmac_f32 v121, v57, v209
    v_fmac_f32 v122, v58, v209
    v_fmac_f32 v123, v59, v209
    v_fmac_f32 v124, v60, v209
    v_fmac_f32 v125, v61, v209
    v_fmac_f32 v126, v62, v209
    v_fmac_f32 v127, v63, v209
    ds_write_b128 v226, v[112:115] offset:4096
    ds_write_b128 v226, v[116:119] offset:5120
    ds_write_b128 v226, v[120:123] offset:6144
    ds_write_b128 v226, v[124:127] offset:7168
    v_fmac_f32 v64, v0, v208
    v_fmac_f32 v65, v1, v208
    v_fmac_f32 v66, v2, v208
    v_fmac_f32 v67, v3, v208
    v_fmac_f32 v68, v4, v208
    v_fmac_f32 v69, v5, v208
    v_fmac_f32 v70, v6, v208
    v_fmac_f32 v71, v7, v208
    v_fmac_f32 v72, v8, v208
    v_fmac_f32 v73, v9, v208
    v_fmac_f32 v74, v10, v208
    v_fmac_f32 v75, v11, v208
    v_fmac_f32 v76, v12, v208
    v_fmac_f32 v77, v13, v208
    v_fmac_f32 v78, v14, v208
    v_fmac_f32 v79, v15, v208
    ds_write_b128 v226, v[64:67] offset:8192
    ds_write_b128 v226, v[68:71] offset:9216
    ds_write_b128 v226, v[72:75] offset:10240
    ds_write_b128 v226, v[76:79] offset:11264
    v_fmac_f32 v80, v16, v208
    v_fmac_f32 v81, v17, v208
    v_fmac_f32 v82, v18, v208
    v_fmac_f32 v83, v19, v208
    v_fmac_f32 v84, v20, v208
    v_fmac_f32 v85, v21, v208
    v_fmac_f32 v86, v22, v208
    v_fmac_f32 v87, v23, v208
    v_fmac_f32 v88, v24, v208
    v_fmac_f32 v89, v25, v208
    v_fmac_f32 v90, v26, v208
    v_fmac_f32 v91, v27, v208
    v_fmac_f32 v92, v28, v208
    v_fmac_f32 v93, v29, v208
    v_fmac_f32 v94, v30, v208
    v_fmac_f32 v95, v31, v208
    s_waitcnt lgkmcnt(0)
    s_barrier
    ds_read_b128 v[0:3], v227 offset:0
    ds_read_b128 v[4:7], v227 offset:1024
    ds_read_b128 v[8:11], v227 offset:2048
    ds_read_b128 v[12:15], v227 offset:3072
    ds_read_b128 v[16:19], v227 offset:32768
    ds_read_b128 v[20:23], v227 offset:33792
    ds_read_b128 v[24:27], v227 offset:34816
    ds_read_b128 v[28:31], v227 offset:35840
    ds_read_b128 v[32:35], v227 offset:40960
    ds_read_b128 v[36:39], v227 offset:41984
    ds_read_b128 v[40:43], v227 offset:43008
    ds_read_b128 v[44:47], v227 offset:44032
    s_waitcnt lgkmcnt(11)
    v_add_f32 v80, v80, v0
    v_add_f32 v81, v81, v1
    v_add_f32 v82, v82, v2
    v_add_f32 v83, v83, v3
    s_waitcnt lgkmcnt(10)
    v_add_f32 v84, v84, v4
    v_add_f32 v85, v85, v5
    v_add_f32 v86, v86, v6
    v_add_f32 v87, v87, v7
    s_waitcnt lgkmcnt(9)
    v_add_f32 v88, v88, v8
    v_add_f32 v89, v89, v9
    v_add_f32 v90, v90, v10
    v_add_f32 v91, v91, v11
    s_waitcnt lgkmcnt(8)
    v_add_f32 v92, v92, v12
    v_add_f32 v93, v93, v13
    v_add_f32 v94, v94, v14
    v_add_f32 v95, v95, v15
    s_waitcnt lgkmcnt(7)
    v_add_f32 v80, v80, v16
    v_add_f32 v81, v81, v17
    v_add_f32 v82, v82, v18
    v_add_f32 v83, v83, v19
    s_waitcnt lgkmcnt(6)
    v_add_f32 v84, v84, v20
    v_add_f32 v85, v85, v21
    v_add_f32 v86, v86, v22
    v_add_f32 v87, v87, v23
    s_waitcnt lgkmcnt(5)
    v_add_f32 v88, v88, v24
    v_add_f32 v89, v89, v25
    v_add_f32 v90, v90, v26
    v_add_f32 v91, v91, v27
    s_waitcnt lgkmcnt(4)
    v_add_f32 v92, v92, v28
    v_add_f32 v93, v93, v29
    v_add_f32 v94, v94, v30
    v_add_f32 v95, v95, v31
    s_waitcnt lgkmcnt(3)
    v_add_f32 v80, v80, v32
    v_add_f32 v81, v81, v33
    v_add_f32 v82, v82, v34
    v_add_f32 v83, v83, v35
    s_waitcnt lgkmcnt(2)
    v_add_f32 v84, v84, v36
    v_add_f32 v85, v85, v37
    v_add_f32 v86, v86, v38
    v_add_f32 v87, v87, v39
    s_waitcnt lgkmcnt(1)
    v_add_f32 v88, v88, v40
    v_add_f32 v89, v89, v41
    v_add_f32 v90, v90, v42
    v_add_f32 v91, v91, v43
    s_waitcnt lgkmcnt(0)
    v_add_f32 v92, v92, v44
    v_add_f32 v93, v93, v45
    v_add_f32 v94, v94, v46
    v_add_f32 v95, v95, v47
    v_cvt_pk_bf16_f32 v80, v80, v81
    v_cvt_pk_bf16_f32 v81, v82, v83
    v_cvt_pk_bf16_f32 v82, v84, v85
    v_cvt_pk_bf16_f32 v83, v86, v87
    v_cvt_pk_bf16_f32 v84, v88, v89
    v_cvt_pk_bf16_f32 v85, v90, v91
    v_cvt_pk_bf16_f32 v86, v92, v93
    v_cvt_pk_bf16_f32 v87, v94, v95
    buffer_store_dwordx4 v[80:83], v228, s[48:51], 0 offen offset:0
    buffer_store_dwordx4 v[84:87], v228, s[48:51], 0 offen offset:16
    s_branch L_fin_h0
L_red_h0_2:
    s_cmp_eq_u32 s60, 2
    s_cbranch_scc0 L_red_h0_3
    s_nop 9
    v_fmac_f32 v112, v48, v209
    v_fmac_f32 v113, v49, v209
    v_fmac_f32 v114, v50, v209
    v_fmac_f32 v115, v51, v209
    v_fmac_f32 v116, v52, v209
    v_fmac_f32 v117, v53, v209
    v_fmac_f32 v118, v54, v209
    v_fmac_f32 v119, v55, v209
    v_fmac_f32 v120, v56, v209
    v_fmac_f32 v121, v57, v209
    v_fmac_f32 v122, v58, v209
    v_fmac_f32 v123, v59, v209
    v_fmac_f32 v124, v60, v209
    v_fmac_f32 v125, v61, v209
    v_fmac_f32 v126, v62, v209
    v_fmac_f32 v127, v63, v209
    ds_write_b128 v226, v[112:115] offset:0
    ds_write_b128 v226, v[116:119] offset:1024
    ds_write_b128 v226, v[120:123] offset:2048
    ds_write_b128 v226, v[124:127] offset:3072
    v_fmac_f32 v64, v0, v208
    v_fmac_f32 v65, v1, v208
    v_fmac_f32 v66, v2, v208
    v_fmac_f32 v67, v3, v208
    v_fmac_f32 v68, v4, v208
    v_fmac_f32 v69, v5, v208
    v_fmac_f32 v70, v6, v208
    v_fmac_f32 v71, v7, v208
    v_fmac_f32 v72, v8, v208
    v_fmac_f32 v73, v9, v208
    v_fmac_f32 v74, v10, v208
    v_fmac_f32 v75, v11, v208
    v_fmac_f32 v76, v12, v208
    v_fmac_f32 v77, v13, v208
    v_fmac_f32 v78, v14, v208
    v_fmac_f32 v79, v15, v208
    ds_write_b128 v226, v[64:67] offset:4096
    ds_write_b128 v226, v[68:71] offset:5120
    ds_write_b128 v226, v[72:75] offset:6144
    ds_write_b128 v226, v[76:79] offset:7168
    v_fmac_f32 v80, v16, v208
    v_fmac_f32 v81, v17, v208
    v_fmac_f32 v82, v18, v208
    v_fmac_f32 v83, v19, v208
    v_fmac_f32 v84, v20, v208
    v_fmac_f32 v85, v21, v208
    v_fmac_f32 v86, v22, v208
    v_fmac_f32 v87, v23, v208
    v_fmac_f32 v88, v24, v208
    v_fmac_f32 v89, v25, v208
    v_fmac_f32 v90, v26, v208
    v_fmac_f32 v91, v27, v208
    v_fmac_f32 v92, v28, v208
    v_fmac_f32 v93, v29, v208
    v_fmac_f32 v94, v30, v208
    v_fmac_f32 v95, v31, v208
    ds_write_b128 v226, v[80:83] offset:8192
    ds_write_b128 v226, v[84:87] offset:9216
    ds_write_b128 v226, v[88:91] offset:10240
    ds_write_b128 v226, v[92:95] offset:11264
    v_fmac_f32 v96, v32, v209
    v_fmac_f32 v97, v33, v209
    v_fmac_f32 v98, v34, v209
    v_fmac_f32 v99, v35, v209
    v_fmac_f32 v100, v36, v209
    v_fmac_f32 v101, v37, v209
    v_fmac_f32 v102, v38, v209
    v_fmac_f32 v103, v39, v209
    v_fmac_f32 v104, v40, v209
    v_fmac_f32 v105, v41, v209
    v_fmac_f32 v106, v42, v209
    v_fmac_f32 v107, v43, v209
    v_fmac_f32 v108, v44, v209
    v_fmac_f32 v109, v45, v209
    v_fmac_f32 v110, v46, v209
    v_fmac_f32 v111, v47, v209
    s_waitcnt lgkmcnt(0)
    s_barrier
    ds_read_b128 v[0:3], v227 offset:4096
    ds_read_b128 v[4:7], v227 offset:5120
    ds_read_b128 v[8:11], v227 offset:6144
    ds_read_b128 v[12:15], v227 offset:7168
    ds_read_b128 v[16:19], v227 offset:12288
    ds_read_b128 v[20:23], v227 offset:13312
    ds_read_b128 v[24:27], v227 offset:14336
    ds_read_b128 v[28:31], v227 offset:15360
    ds_read_b128 v[32:35], v227 offset:45056
    ds_read_b128 v[36:39], v227 offset:46080
    ds_read_b128 v[40:43], v227 offset:47104
    ds_read_b128 v[44:47], v227 offset:48128
    s_waitcnt lgkmcnt(11)
    v_add_f32 v96, v96, v0
    v_add_f32 v97, v97, v1
    v_add_f32 v98, v98, v2
    v_add_f32 v99, v99, v3
    s_waitcnt lgkmcnt(10)
    v_add_f32 v100, v100, v4
    v_add_f32 v101, v101, v5
    v_add_f32 v102, v102, v6
    v_add_f32 v103, v103, v7
    s_waitcnt lgkmcnt(9)
    v_add_f32 v104, v104, v8
    v_add_f32 v105, v105, v9
    v_add_f32 v106, v106, v10
    v_add_f32 v107, v107, v11
    s_waitcnt lgkmcnt(8)
    v_add_f32 v108, v108, v12
    v_add_f32 v109, v109, v13
    v_add_f32 v110, v110, v14
    v_add_f32 v111, v111, v15
    s_waitcnt lgkmcnt(7)
    v_add_f32 v96, v96, v16
    v_add_f32 v97, v97, v17
    v_add_f32 v98, v98, v18
    v_add_f32 v99, v99, v19
    s_waitcnt lgkmcnt(6)
    v_add_f32 v100, v100, v20
    v_add_f32 v101, v101, v21
    v_add_f32 v102, v102, v22
    v_add_f32 v103, v103, v23
    s_waitcnt lgkmcnt(5)
    v_add_f32 v104, v104, v24
    v_add_f32 v105, v105, v25
    v_add_f32 v106, v106, v26
    v_add_f32 v107, v107, v27
    s_waitcnt lgkmcnt(4)
    v_add_f32 v108, v108, v28
    v_add_f32 v109, v109, v29
    v_add_f32 v110, v110, v30
    v_add_f32 v111, v111, v31
    s_waitcnt lgkmcnt(3)
    v_add_f32 v96, v96, v32
    v_add_f32 v97, v97, v33
    v_add_f32 v98, v98, v34
    v_add_f32 v99, v99, v35
    s_waitcnt lgkmcnt(2)
    v_add_f32 v100, v100, v36
    v_add_f32 v101, v101, v37
    v_add_f32 v102, v102, v38
    v_add_f32 v103, v103, v39
    s_waitcnt lgkmcnt(1)
    v_add_f32 v104, v104, v40
    v_add_f32 v105, v105, v41
    v_add_f32 v106, v106, v42
    v_add_f32 v107, v107, v43
    s_waitcnt lgkmcnt(0)
    v_add_f32 v108, v108, v44
    v_add_f32 v109, v109, v45
    v_add_f32 v110, v110, v46
    v_add_f32 v111, v111, v47
    v_cvt_pk_bf16_f32 v96, v96, v97
    v_cvt_pk_bf16_f32 v97, v98, v99
    v_cvt_pk_bf16_f32 v98, v100, v101
    v_cvt_pk_bf16_f32 v99, v102, v103
    v_cvt_pk_bf16_f32 v100, v104, v105
    v_cvt_pk_bf16_f32 v101, v106, v107
    v_cvt_pk_bf16_f32 v102, v108, v109
    v_cvt_pk_bf16_f32 v103, v110, v111
    buffer_store_dwordx4 v[96:99], v228, s[48:51], 0 offen offset:0
    buffer_store_dwordx4 v[100:103], v228, s[48:51], 0 offen offset:16
    s_branch L_fin_h0
L_red_h0_3:
    s_nop 6
    v_fmac_f32 v64, v0, v208
    v_fmac_f32 v65, v1, v208
    v_fmac_f32 v66, v2, v208
    v_fmac_f32 v67, v3, v208
    v_fmac_f32 v68, v4, v208
    v_fmac_f32 v69, v5, v208
    v_fmac_f32 v70, v6, v208
    v_fmac_f32 v71, v7, v208
    v_fmac_f32 v72, v8, v208
    v_fmac_f32 v73, v9, v208
    v_fmac_f32 v74, v10, v208
    v_fmac_f32 v75, v11, v208
    v_fmac_f32 v76, v12, v208
    v_fmac_f32 v77, v13, v208
    v_fmac_f32 v78, v14, v208
    v_fmac_f32 v79, v15, v208
    ds_write_b128 v226, v[64:67] offset:0
    ds_write_b128 v226, v[68:71] offset:1024
    ds_write_b128 v226, v[72:75] offset:2048
    ds_write_b128 v226, v[76:79] offset:3072
    v_fmac_f32 v80, v16, v208
    v_fmac_f32 v81, v17, v208
    v_fmac_f32 v82, v18, v208
    v_fmac_f32 v83, v19, v208
    v_fmac_f32 v84, v20, v208
    v_fmac_f32 v85, v21, v208
    v_fmac_f32 v86, v22, v208
    v_fmac_f32 v87, v23, v208
    v_fmac_f32 v88, v24, v208
    v_fmac_f32 v89, v25, v208
    v_fmac_f32 v90, v26, v208
    v_fmac_f32 v91, v27, v208
    v_fmac_f32 v92, v28, v208
    v_fmac_f32 v93, v29, v208
    v_fmac_f32 v94, v30, v208
    v_fmac_f32 v95, v31, v208
    ds_write_b128 v226, v[80:83] offset:4096
    ds_write_b128 v226, v[84:87] offset:5120
    ds_write_b128 v226, v[88:91] offset:6144
    ds_write_b128 v226, v[92:95] offset:7168
    v_fmac_f32 v96, v32, v209
    v_fmac_f32 v97, v33, v209
    v_fmac_f32 v98, v34, v209
    v_fmac_f32 v99, v35, v209
    v_fmac_f32 v100, v36, v209
    v_fmac_f32 v101, v37, v209
    v_fmac_f32 v102, v38, v209
    v_fmac_f32 v103, v39, v209
    v_fmac_f32 v104, v40, v209
    v_fmac_f32 v105, v41, v209
    v_fmac_f32 v106, v42, v209
    v_fmac_f32 v107, v43, v209
    v_fmac_f32 v108, v44, v209
    v_fmac_f32 v109, v45, v209
    v_fmac_f32 v110, v46, v209
    v_fmac_f32 v111, v47, v209
    ds_write_b128 v226, v[96:99] offset:8192
    ds_write_b128 v226, v[100:103] offset:9216
    ds_write_b128 v226, v[104:107] offset:10240
    ds_write_b128 v226, v[108:111] offset:11264
    v_fmac_f32 v112, v48, v209
    v_fmac_f32 v113, v49, v209
    v_fmac_f32 v114, v50, v209
    v_fmac_f32 v115, v51, v209
    v_fmac_f32 v116, v52, v209
    v_fmac_f32 v117, v53, v209
    v_fmac_f32 v118, v54, v209
    v_fmac_f32 v119, v55, v209
    v_fmac_f32 v120, v56, v209
    v_fmac_f32 v121, v57, v209
    v_fmac_f32 v122, v58, v209
    v_fmac_f32 v123, v59, v209
    v_fmac_f32 v124, v60, v209
    v_fmac_f32 v125, v61, v209
    v_fmac_f32 v126, v62, v209
    v_fmac_f32 v127, v63, v209
    s_waitcnt lgkmcnt(0)
    s_barrier
    ds_read_b128 v[0:3], v227 offset:8192
    ds_read_b128 v[4:7], v227 offset:9216
    ds_read_b128 v[8:11], v227 offset:10240
    ds_read_b128 v[12:15], v227 offset:11264
    ds_read_b128 v[16:19], v227 offset:16384
    ds_read_b128 v[20:23], v227 offset:17408
    ds_read_b128 v[24:27], v227 offset:18432
    ds_read_b128 v[28:31], v227 offset:19456
    ds_read_b128 v[32:35], v227 offset:24576
    ds_read_b128 v[36:39], v227 offset:25600
    ds_read_b128 v[40:43], v227 offset:26624
    ds_read_b128 v[44:47], v227 offset:27648
    s_waitcnt lgkmcnt(11)
    v_add_f32 v112, v112, v0
    v_add_f32 v113, v113, v1
    v_add_f32 v114, v114, v2
    v_add_f32 v115, v115, v3
    s_waitcnt lgkmcnt(10)
    v_add_f32 v116, v116, v4
    v_add_f32 v117, v117, v5
    v_add_f32 v118, v118, v6
    v_add_f32 v119, v119, v7
    s_waitcnt lgkmcnt(9)
    v_add_f32 v120, v120, v8
    v_add_f32 v121, v121, v9
    v_add_f32 v122, v122, v10
    v_add_f32 v123, v123, v11
    s_waitcnt lgkmcnt(8)
    v_add_f32 v124, v124, v12
    v_add_f32 v125, v125, v13
    v_add_f32 v126, v126, v14
    v_add_f32 v127, v127, v15
    s_waitcnt lgkmcnt(7)
    v_add_f32 v112, v112, v16
    v_add_f32 v113, v113, v17
    v_add_f32 v114, v114, v18
    v_add_f32 v115, v115, v19
    s_waitcnt lgkmcnt(6)
    v_add_f32 v116, v116, v20
    v_add_f32 v117, v117, v21
    v_add_f32 v118, v118, v22
    v_add_f32 v119, v119, v23
    s_waitcnt lgkmcnt(5)
    v_add_f32 v120, v120, v24
    v_add_f32 v121, v121, v25
    v_add_f32 v122, v122, v26
    v_add_f32 v123, v123, v27
    s_waitcnt lgkmcnt(4)
    v_add_f32 v124, v124, v28
    v_add_f32 v125, v125, v29
    v_add_f32 v126, v126, v30
    v_add_f32 v127, v127, v31
    s_waitcnt lgkmcnt(3)
    v_add_f32 v112, v112, v32
    v_add_f32 v113, v113, v33
    v_add_f32 v114, v114, v34
    v_add_f32 v115, v115, v35
    s_waitcnt lgkmcnt(2)
    v_add_f32 v116, v116, v36
    v_add_f32 v117, v117, v37
    v_add_f32 v118, v118, v38
    v_add_f32 v119, v119, v39
    s_waitcnt lgkmcnt(1)
    v_add_f32 v120, v120, v40
    v_add_f32 v121, v121, v41
    v_add_f32 v122, v122, v42
    v_add_f32 v123, v123, v43
    s_waitcnt lgkmcnt(0)
    v_add_f32 v124, v124, v44
    v_add_f32 v125, v125, v45
    v_add_f32 v126, v126, v46
    v_add_f32 v127, v127, v47
    v_cvt_pk_bf16_f32 v112, v112, v113
    v_cvt_pk_bf16_f32 v113, v114, v115
    v_cvt_pk_bf16_f32 v114, v116, v117
    v_cvt_pk_bf16_f32 v115, v118, v119
    v_cvt_pk_bf16_f32 v116, v120, v121
    v_cvt_pk_bf16_f32 v117, v122, v123
    v_cvt_pk_bf16_f32 v118, v124, v125
    v_cvt_pk_bf16_f32 v119, v126, v127
    buffer_store_dwordx4 v[112:115], v228, s[48:51], 0 offen offset:0
    buffer_store_dwordx4 v[116:119], v228, s[48:51], 0 offen offset:16
L_fin_h0:
L_end:
    s_endpgm
L_codeend:
.fill 64, 4, 0xBF800000
.section .rodata,"a"
.p2align 6
.amdhsa_kernel gated_mix__sliding_local_dilated__glu_gated_glu__prompt_kernel
  .amdhsa_next_free_vgpr 512
  .amdhsa_next_free_sgpr 102
  .amdhsa_accum_offset 256
  .amdhsa_group_segment_fixed_size 0
  .amdhsa_kernarg_size 88
  .amdhsa_user_sgpr_count 2
  .amdhsa_user_sgpr_kernarg_segment_ptr 1
  .amdhsa_system_sgpr_workgroup_id_x 1
.end_amdhsa_kernel
```
